```python
import torch

def _softmax(x, axis=-1):
    return torch.softmax(x, dim=axis)

def _gelu(x):
    return torch.nn.functional.gelu(x, approximate='tanh')

def _silu(x):
    return torch.nn.functional.silu(x)

def _sigmoid(x):
    return torch.sigmoid(x)

def _layernorm(x, axis=-1, eps=1e-05):
    m = x.mean(dim=axis, keepdim=True)
    v = x.var(dim=axis, keepdim=True, unbiased=False)
    return (x - m) / torch.sqrt(v + eps)

def _scatter_add(tgt, idx, src, axis=0):
    return tgt.clone().index_add_(axis, idx, src)

def _segment_sum(src, seg, n):
    out = torch.zeros((n,) + src.shape[1:], dtype=src.dtype)
    return out.index_add_(0, seg, src)

def _pad(x, pw):
    flat = tuple((v for pair in reversed(pw) for v in pair))
    return torch.nn.functional.pad(x, flat)
kernel_name = 'sequential_preLN__sliding_block__mixer_gmlp__prompt'

def setup_inputs():

    _w = lambda a: (lambda t: t.to(torch.bfloat16) if t.is_floating_point() else t)(torch.as_tensor(a))

    def _A_setup():
        B, S, D = (1, 2048, 512)
        return {'x': _w((lambda *s: torch.randn(*s, dtype=torch.bfloat16) * 0.05)(B, S, D)), 'wqkv': _w((lambda *s: torch.randn(*s, dtype=torch.bfloat16) * 0.05)(D, 3 * D)), 'wo': _w((lambda *s: torch.randn(*s, dtype=torch.bfloat16) * 0.05)(D, D))}
    _A_in = _A_setup()

    def _B_setup():
        B, S, D, F = (1, 2048, 512, 1792)
        Fh = F // 2
        return {'x': _w((lambda *s: torch.randn(*s, dtype=torch.bfloat16) * 0.05)(B, S, D)), 'w_in': _w((lambda *s: torch.randn(*s, dtype=torch.bfloat16) * 0.4)(D, 2 * Fh)), 'w_sp': _w(0.01 * (lambda *s: torch.randn(*s, dtype=torch.bfloat16) * 0.4)(S, S)), 'b_sp': _w(1.0 + 0.01 * (lambda *s: torch.randn(*s, dtype=torch.bfloat16) * 0.05)(S)), 'w_out': _w((lambda *s: torch.randn(*s, dtype=torch.bfloat16) * 0.05)(Fh, D))}
    _B_in = _B_setup()
    return {'A_x': _A_in['x'], 'A_wqkv': _A_in['wqkv'], 'A_wo': _A_in['wo'], 'B_x': _B_in['x'], 'B_w_in': _B_in['w_in'], 'B_w_sp': _B_in['w_sp'], 'B_b_sp': _B_in['b_sp'], 'B_w_out': _B_in['w_out']}

def reference(A_x, A_wqkv, A_wo, B_x, B_w_in, B_w_sp, B_b_sp, B_w_out):

    def _A_ref(x, wqkv, wo):
        B, S, D = x.shape
        H = 32
        Dh = D // H
        W = 256
        qkv = (lambda x, *d: x.permute(*d))((x @ wqkv).reshape(B, S, 3, H, Dh), 2, 0, 3, 1, 4)
        q, k, v = (qkv[0], qkv[1], qkv[2])
        scores = torch.einsum('bhqd,bhkd->bhqk', q, k) * Dh ** (-0.5)
        idx = torch.arange(S)
        mask = (idx[:, None] - idx[None, :] >= 0) & (idx[:, None] - idx[None, :] < W)
        scores = torch.where(mask[None, None], scores, -1000000000.0)
        p = _softmax(scores, axis=-1)
        o = torch.einsum('bhqk,bhkd->bhqd', p, v)
        return (lambda x, *d: x.permute(*d))(o, 0, 2, 1, 3).reshape(B, S, D) @ wo

    def _B_ref(x, w_in, w_sp, b_sp, w_out):
        B, S, D = x.shape
        F = w_in.shape[-1]
        Fh = F // 2
        z = _gelu(torch.einsum('bsd,df->bsf', x, w_in))
        z1 = z[..., :Fh].clone()
        z2 = _layernorm(z[..., Fh:], axis=-1)
        g = torch.einsum('ts,bsf->btf', w_sp, z2) + b_sp[None, :, None]
        return torch.einsum('bsf,fd->bsd', z1 * g, w_out)
    x = A_x
    h = x + _A_ref(_layernorm(x, axis=-1), A_wqkv, A_wo)
    h2 = h + _B_ref(_layernorm(h, axis=-1), B_w_in, B_w_sp, B_b_sp, B_w_out)
    return h2
```

```asm
; @launch kernel=k1_qkv_kernel grid=(192,1,1) block=(512,1,1) lds=163840
; @launch kernel=k2_attn_kernel grid=(1024,1,1) block=(256,1,1) lds=21504
; @launch kernel=k3_wo_kernel grid=(256,1,1) block=(256,1,1) lds=131072
; @launch kernel=k4_win_kernel grid=(224,1,1) block=(512,1,1) lds=163840
; @launch kernel=k4b_lnz_kernel grid=(256,1,1) block=(256,1,1) lds=0
; @launch kernel=k5_sp_kernel grid=(224,1,1) block=(512,1,1) lds=147456
; @launch kernel=k6_out_kernel grid=(256,1,1) block=(256,1,1) lds=131072
.amdgcn_target "amdgcn-amd-amdhsa--gfx950"
.text
.globl k1_qkv_kernel
.p2align 8
.type k1_qkv_kernel,@function
k1_qkv_kernel:
    s_cmp_ge_u32 s2, 192
    s_cbranch_scc1 L_end_1
    s_load_dwordx2 s[4:5], s[0:1], 0
    s_load_dwordx2 s[8:9], s[0:1], 8
    s_load_dwordx2 s[12:13], s[0:1], 80
    s_and_b32 s24, s2, 15
    s_lshr_b32 s25, s2, 4
    s_mul_i32 s26, s24, 128
    s_mul_i32 s27, s25, 128
    v_and_b32 v1, 63, v0
    v_lshrrev_b32 v2, 6, v0
    s_nop 0
    v_readfirstlane_b32 s28, v2
    s_waitcnt lgkmcnt(0)
    s_mov_b32 s6, 0x200000
    s_mov_b32 s7, 0x00020000
    s_mov_b32 s10, 0x180000
    s_mov_b32 s11, 0x00020000
    s_mov_b32 s14, 0x600000
    s_mov_b32 s15, 0x00020000
    s_and_b32 s29, s28, 1
    s_lshr_b32 s30, s28, 1
    v_lshrrev_b32 v5, 3, v1
    v_lshrrev_b32 v6, 4, v1
    s_lshl_b32 s31, s29, 2
    v_add_u32 v7, s31, v6
    v_and_b32 v7, 7, v7
    v_and_b32 v8, 7, v1
    v_xor_b32 v7, v7, v8
    v_mul_u32_u24 v3, 1024, v5
    v_lshl_add_u32 v3, v7, 4, v3
    v_and_b32 v8, 15, v1
    v_lshlrev_b32 v7, 2, v6
    v_xor_b32 v7, v7, v8
    v_mul_u32_u24 v4, 3072, v6
    v_lshl_add_u32 v4, v7, 4, v4
    s_lshl_b32 s31, s28, 3
    s_add_u32 s31, s31, s26
    s_mul_i32 s32, s31, 1024
    s_mul_i32 s36, s28, 12288
    s_lshl_b32 s31, s27, 1
    s_add_u32 s36, s36, s31
    s_add_u32 s37, s36, 98304
    s_lshl_b32 s45, s28, 10
    v_and_b32 v9, 31, v1
    s_mul_i32 s31, s29, 64
    v_add_u32 v9, s31, v9
    v_lshrrev_b32 v14, 5, v1
    v_bfe_u32 v15, v1, 1, 3
    v_xor_b32 v15, v15, v14
    v_lshlrev_b32 v16, 7, v9
    v_xor_b32 v17, 0, v15
    v_lshl_add_u32 v10, v17, 4, v16
    v_xor_b32 v17, 2, v15
    v_lshl_add_u32 v11, v17, 4, v16
    v_xor_b32 v17, 4, v15
    v_lshl_add_u32 v12, v17, 4, v16
    v_xor_b32 v17, 6, v15
    v_lshl_add_u32 v13, v17, 4, v16
    v_bfe_u32 v15, v1, 2, 2
    v_lshl_add_u32 v16, v14, 3, v15
    v_mul_u32_u24 v16, 256, v16
    v_bfe_u32 v17, v1, 4, 1
    v_lshlrev_b32 v17, 1, v17
    v_bfe_u32 v18, v1, 1, 1
    v_add_u32 v17, v17, v18
    s_mul_i32 s31, s30, 4
    v_add_u32 v17, s31, v17
    v_lshlrev_b32 v15, 2, v15
    v_and_b32 v18, 1, v1
    v_lshl_add_u32 v16, v18, 3, v16
    v_add_u32 v16, 16384, v16
    v_add_u32 v18, 0, v17
    v_xor_b32 v18, v18, v15
    v_lshl_add_u32 v20, v18, 4, v16
    v_mov_b32 v64, 0
    v_mov_b32 v65, 0
    v_mov_b32 v66, 0
    v_mov_b32 v67, 0
    v_mov_b32 v68, 0
    v_mov_b32 v69, 0
    v_mov_b32 v70, 0
    v_mov_b32 v71, 0
    v_mov_b32 v72, 0
    v_mov_b32 v73, 0
    v_mov_b32 v74, 0
    v_mov_b32 v75, 0
    v_mov_b32 v76, 0
    v_mov_b32 v77, 0
    v_mov_b32 v78, 0
    v_mov_b32 v79, 0
    v_mov_b32 v80, 0
    v_mov_b32 v81, 0
    v_mov_b32 v82, 0
    v_mov_b32 v83, 0
    v_mov_b32 v84, 0
    v_mov_b32 v85, 0
    v_mov_b32 v86, 0
    v_mov_b32 v87, 0
    v_mov_b32 v88, 0
    v_mov_b32 v89, 0
    v_mov_b32 v90, 0
    v_mov_b32 v91, 0
    v_mov_b32 v92, 0
    v_mov_b32 v93, 0
    v_mov_b32 v94, 0
    v_mov_b32 v95, 0
    s_cmp_ge_u32 s25, 8
    s_cbranch_scc1 L_vpath_2
    s_add_u32 m0, s45, 16384
    s_add_u32 s46, s36, 0
    buffer_load_dwordx4 v4, s[8:11], s46 offen lds
    s_add_u32 m0, s45, 24576
    s_add_u32 s46, s37, 0
    buffer_load_dwordx4 v4, s[8:11], s46 offen lds
    s_add_u32 m0, s45, 49152
    s_add_u32 s46, s36, 196608
    buffer_load_dwordx4 v4, s[8:11], s46 offen lds
    s_add_u32 m0, s45, 57344
    s_add_u32 s46, s37, 196608
    buffer_load_dwordx4 v4, s[8:11], s46 offen lds
    s_add_u32 m0, s45, 81920
    s_add_u32 s46, s36, 393216
    buffer_load_dwordx4 v4, s[8:11], s46 offen lds
    s_add_u32 m0, s45, 90112
    s_add_u32 s46, s37, 393216
    buffer_load_dwordx4 v4, s[8:11], s46 offen lds
    s_add_u32 m0, s45, 114688
    s_add_u32 s46, s36, 589824
    buffer_load_dwordx4 v4, s[8:11], s46 offen lds
    s_add_u32 m0, s45, 122880
    s_add_u32 s46, s37, 589824
    buffer_load_dwordx4 v4, s[8:11], s46 offen lds
    v_lshrrev_b32 v30, 3, v0
    v_and_b32 v31, 7, v0
    v_mul_u32_u24 v5, 1024, v30
    v_lshl_add_u32 v5, v31, 4, v5
    s_mul_i32 s46, s26, 1024
    s_add_u32 s47, s46, 65536
    buffer_load_dwordx4 v[128:131], v5, s[4:7], s46 offen offset:0
    buffer_load_dwordx4 v[132:135], v5, s[4:7], s46 offen offset:128
    buffer_load_dwordx4 v[136:139], v5, s[4:7], s46 offen offset:256
    buffer_load_dwordx4 v[140:143], v5, s[4:7], s46 offen offset:384
    buffer_load_dwordx4 v[144:147], v5, s[4:7], s46 offen offset:512
    buffer_load_dwordx4 v[148:151], v5, s[4:7], s46 offen offset:640
    buffer_load_dwordx4 v[152:155], v5, s[4:7], s46 offen offset:768
    buffer_load_dwordx4 v[156:159], v5, s[4:7], s46 offen offset:896
    buffer_load_dwordx4 v[160:163], v5, s[4:7], s47 offen offset:0
    buffer_load_dwordx4 v[164:167], v5, s[4:7], s47 offen offset:128
    buffer_load_dwordx4 v[168:171], v5, s[4:7], s47 offen offset:256
    buffer_load_dwordx4 v[172:175], v5, s[4:7], s47 offen offset:384
    buffer_load_dwordx4 v[176:179], v5, s[4:7], s47 offen offset:512
    buffer_load_dwordx4 v[180:183], v5, s[4:7], s47 offen offset:640
    buffer_load_dwordx4 v[184:187], v5, s[4:7], s47 offen offset:768
    buffer_load_dwordx4 v[188:191], v5, s[4:7], s47 offen offset:896
    v_bfe_u32 v5, v0, 4, 3
    v_xor_b32 v31, v31, v5
    v_lshlrev_b32 v30, 7, v30
    v_lshl_add_u32 v30, v31, 4, v30
    v_mov_b32 v5, 0x3f803f80
    v_mov_b32 v32, 0
    v_mov_b32 v33, 0
    v_mov_b32 v34, 0
    v_mov_b32 v35, 0
    s_waitcnt vmcnt(15)
    v_dot2_f32_bf16 v32, v128, v5, v32
    v_dot2_f32_bf16 v33, v128, v128, v33
    v_dot2_f32_bf16 v32, v129, v5, v32
    v_dot2_f32_bf16 v33, v129, v129, v33
    v_dot2_f32_bf16 v32, v130, v5, v32
    v_dot2_f32_bf16 v33, v130, v130, v33
    v_dot2_f32_bf16 v32, v131, v5, v32
    v_dot2_f32_bf16 v33, v131, v131, v33
    s_waitcnt vmcnt(14)
    v_dot2_f32_bf16 v32, v132, v5, v32
    v_dot2_f32_bf16 v33, v132, v132, v33
    v_dot2_f32_bf16 v32, v133, v5, v32
    v_dot2_f32_bf16 v33, v133, v133, v33
    v_dot2_f32_bf16 v32, v134, v5, v32
    v_dot2_f32_bf16 v33, v134, v134, v33
    v_dot2_f32_bf16 v32, v135, v5, v32
    v_dot2_f32_bf16 v33, v135, v135, v33
    s_waitcnt vmcnt(13)
    v_dot2_f32_bf16 v32, v136, v5, v32
    v_dot2_f32_bf16 v33, v136, v136, v33
    v_dot2_f32_bf16 v32, v137, v5, v32
    v_dot2_f32_bf16 v33, v137, v137, v33
    v_dot2_f32_bf16 v32, v138, v5, v32
    v_dot2_f32_bf16 v33, v138, v138, v33
    v_dot2_f32_bf16 v32, v139, v5, v32
    v_dot2_f32_bf16 v33, v139, v139, v33
    s_waitcnt vmcnt(12)
    v_dot2_f32_bf16 v32, v140, v5, v32
    v_dot2_f32_bf16 v33, v140, v140, v33
    v_dot2_f32_bf16 v32, v141, v5, v32
    v_dot2_f32_bf16 v33, v141, v141, v33
    v_dot2_f32_bf16 v32, v142, v5, v32
    v_dot2_f32_bf16 v33, v142, v142, v33
    v_dot2_f32_bf16 v32, v143, v5, v32
    v_dot2_f32_bf16 v33, v143, v143, v33
    s_waitcnt vmcnt(11)
    v_dot2_f32_bf16 v32, v144, v5, v32
    v_dot2_f32_bf16 v33, v144, v144, v33
    v_dot2_f32_bf16 v32, v145, v5, v32
    v_dot2_f32_bf16 v33, v145, v145, v33
    v_dot2_f32_bf16 v32, v146, v5, v32
    v_dot2_f32_bf16 v33, v146, v146, v33
    v_dot2_f32_bf16 v32, v147, v5, v32
    v_dot2_f32_bf16 v33, v147, v147, v33
    s_waitcnt vmcnt(10)
    v_dot2_f32_bf16 v32, v148, v5, v32
    v_dot2_f32_bf16 v33, v148, v148, v33
    v_dot2_f32_bf16 v32, v149, v5, v32
    v_dot2_f32_bf16 v33, v149, v149, v33
    v_dot2_f32_bf16 v32, v150, v5, v32
    v_dot2_f32_bf16 v33, v150, v150, v33
    v_dot2_f32_bf16 v32, v151, v5, v32
    v_dot2_f32_bf16 v33, v151, v151, v33
    s_waitcnt vmcnt(9)
    v_dot2_f32_bf16 v32, v152, v5, v32
    v_dot2_f32_bf16 v33, v152, v152, v33
    v_dot2_f32_bf16 v32, v153, v5, v32
    v_dot2_f32_bf16 v33, v153, v153, v33
    v_dot2_f32_bf16 v32, v154, v5, v32
    v_dot2_f32_bf16 v33, v154, v154, v33
    v_dot2_f32_bf16 v32, v155, v5, v32
    v_dot2_f32_bf16 v33, v155, v155, v33
    s_waitcnt vmcnt(8)
    v_dot2_f32_bf16 v32, v156, v5, v32
    v_dot2_f32_bf16 v33, v156, v156, v33
    v_dot2_f32_bf16 v32, v157, v5, v32
    v_dot2_f32_bf16 v33, v157, v157, v33
    v_dot2_f32_bf16 v32, v158, v5, v32
    v_dot2_f32_bf16 v33, v158, v158, v33
    v_dot2_f32_bf16 v32, v159, v5, v32
    v_dot2_f32_bf16 v33, v159, v159, v33
    s_waitcnt vmcnt(7)
    v_dot2_f32_bf16 v34, v160, v5, v34
    v_dot2_f32_bf16 v35, v160, v160, v35
    v_dot2_f32_bf16 v34, v161, v5, v34
    v_dot2_f32_bf16 v35, v161, v161, v35
    v_dot2_f32_bf16 v34, v162, v5, v34
    v_dot2_f32_bf16 v35, v162, v162, v35
    v_dot2_f32_bf16 v34, v163, v5, v34
    v_dot2_f32_bf16 v35, v163, v163, v35
    s_waitcnt vmcnt(6)
    v_dot2_f32_bf16 v34, v164, v5, v34
    v_dot2_f32_bf16 v35, v164, v164, v35
    v_dot2_f32_bf16 v34, v165, v5, v34
    v_dot2_f32_bf16 v35, v165, v165, v35
    v_dot2_f32_bf16 v34, v166, v5, v34
    v_dot2_f32_bf16 v35, v166, v166, v35
    v_dot2_f32_bf16 v34, v167, v5, v34
    v_dot2_f32_bf16 v35, v167, v167, v35
    s_waitcnt vmcnt(5)
    v_dot2_f32_bf16 v34, v168, v5, v34
    v_dot2_f32_bf16 v35, v168, v168, v35
    v_dot2_f32_bf16 v34, v169, v5, v34
    v_dot2_f32_bf16 v35, v169, v169, v35
    v_dot2_f32_bf16 v34, v170, v5, v34
    v_dot2_f32_bf16 v35, v170, v170, v35
    v_dot2_f32_bf16 v34, v171, v5, v34
    v_dot2_f32_bf16 v35, v171, v171, v35
    s_waitcnt vmcnt(4)
    v_dot2_f32_bf16 v34, v172, v5, v34
    v_dot2_f32_bf16 v35, v172, v172, v35
    v_dot2_f32_bf16 v34, v173, v5, v34
    v_dot2_f32_bf16 v35, v173, v173, v35
    v_dot2_f32_bf16 v34, v174, v5, v34
    v_dot2_f32_bf16 v35, v174, v174, v35
    v_dot2_f32_bf16 v34, v175, v5, v34
    v_dot2_f32_bf16 v35, v175, v175, v35
    s_waitcnt vmcnt(3)
    v_dot2_f32_bf16 v34, v176, v5, v34
    v_dot2_f32_bf16 v35, v176, v176, v35
    v_dot2_f32_bf16 v34, v177, v5, v34
    v_dot2_f32_bf16 v35, v177, v177, v35
    v_dot2_f32_bf16 v34, v178, v5, v34
    v_dot2_f32_bf16 v35, v178, v178, v35
    v_dot2_f32_bf16 v34, v179, v5, v34
    v_dot2_f32_bf16 v35, v179, v179, v35
    s_waitcnt vmcnt(2)
    v_dot2_f32_bf16 v34, v180, v5, v34
    v_dot2_f32_bf16 v35, v180, v180, v35
    v_dot2_f32_bf16 v34, v181, v5, v34
    v_dot2_f32_bf16 v35, v181, v181, v35
    v_dot2_f32_bf16 v34, v182, v5, v34
    v_dot2_f32_bf16 v35, v182, v182, v35
    v_dot2_f32_bf16 v34, v183, v5, v34
    v_dot2_f32_bf16 v35, v183, v183, v35
    s_waitcnt vmcnt(1)
    v_dot2_f32_bf16 v34, v184, v5, v34
    v_dot2_f32_bf16 v35, v184, v184, v35
    v_dot2_f32_bf16 v34, v185, v5, v34
    v_dot2_f32_bf16 v35, v185, v185, v35
    v_dot2_f32_bf16 v34, v186, v5, v34
    v_dot2_f32_bf16 v35, v186, v186, v35
    v_dot2_f32_bf16 v34, v187, v5, v34
    v_dot2_f32_bf16 v35, v187, v187, v35
    s_waitcnt vmcnt(0)
    v_dot2_f32_bf16 v34, v188, v5, v34
    v_dot2_f32_bf16 v35, v188, v188, v35
    v_dot2_f32_bf16 v34, v189, v5, v34
    v_dot2_f32_bf16 v35, v189, v189, v35
    v_dot2_f32_bf16 v34, v190, v5, v34
    v_dot2_f32_bf16 v35, v190, v190, v35
    v_dot2_f32_bf16 v34, v191, v5, v34
    v_dot2_f32_bf16 v35, v191, v191, v35
    s_nop 3
    v_add_f32_dpp v32, v32, v32 quad_perm:[1,0,3,2] row_mask:0xf bank_mask:0xf
    v_add_f32_dpp v33, v33, v33 quad_perm:[1,0,3,2] row_mask:0xf bank_mask:0xf
    v_add_f32_dpp v34, v34, v34 quad_perm:[1,0,3,2] row_mask:0xf bank_mask:0xf
    v_add_f32_dpp v35, v35, v35 quad_perm:[1,0,3,2] row_mask:0xf bank_mask:0xf
    s_nop 1
    v_add_f32_dpp v32, v32, v32 quad_perm:[2,3,0,1] row_mask:0xf bank_mask:0xf
    v_add_f32_dpp v33, v33, v33 quad_perm:[2,3,0,1] row_mask:0xf bank_mask:0xf
    v_add_f32_dpp v34, v34, v34 quad_perm:[2,3,0,1] row_mask:0xf bank_mask:0xf
    v_add_f32_dpp v35, v35, v35 quad_perm:[2,3,0,1] row_mask:0xf bank_mask:0xf
    s_nop 1
    v_add_f32_dpp v32, v32, v32 row_half_mirror row_mask:0xf bank_mask:0xf
    v_add_f32_dpp v33, v33, v33 row_half_mirror row_mask:0xf bank_mask:0xf
    v_add_f32_dpp v34, v34, v34 row_half_mirror row_mask:0xf bank_mask:0xf
    v_add_f32_dpp v35, v35, v35 row_half_mirror row_mask:0xf bank_mask:0xf
    s_nop 1
    v_mul_f32 v32, 0x3b000000, v32
    v_mul_f32 v33, 0x3b000000, v33
    v_fma_f32 v33, -v32, v32, v33
    v_max_f32 v33, 0, v33
    v_cvt_pk_bf16_f32 v36, v32, v33
    v_lshlrev_b32 v32, 16, v36
    v_and_b32 v33, 0xffff0000, v36
    v_add_f32 v33, 0x3727c5ac, v33
    v_cvt_pk_bf16_f32 v36, v33, v33
    v_lshlrev_b32 v33, 16, v36
    v_sqrt_f32 v33, v33
    s_nop 0
    v_cvt_pk_bf16_f32 v36, v33, v33
    v_lshlrev_b32 v33, 16, v36
    v_rcp_f32 v33, v33
    s_nop 0
    v_mov_b32 v120, v32
    v_mov_b32 v121, v33
    v_mul_f32 v34, 0x3b000000, v34
    v_mul_f32 v35, 0x3b000000, v35
    v_fma_f32 v35, -v34, v34, v35
    v_max_f32 v35, 0, v35
    v_cvt_pk_bf16_f32 v36, v34, v35
    v_lshlrev_b32 v34, 16, v36
    v_and_b32 v35, 0xffff0000, v36
    v_add_f32 v35, 0x3727c5ac, v35
    v_cvt_pk_bf16_f32 v36, v35, v35
    v_lshlrev_b32 v35, 16, v36
    v_sqrt_f32 v35, v35
    s_nop 0
    v_cvt_pk_bf16_f32 v36, v35, v35
    v_lshlrev_b32 v35, 16, v36
    v_rcp_f32 v35, v35
    s_nop 0
    v_mov_b32 v122, v34
    v_mov_b32 v123, v35
    v_lshlrev_b32 v124, 16, v128
    v_and_b32 v125, 0xffff0000, v128
    v_sub_f32 v124, v124, v120
    v_sub_f32 v125, v125, v120
    v_cvt_pk_bf16_f32 v128, v124, v125
    v_lshlrev_b32 v124, 16, v128
    v_and_b32 v125, 0xffff0000, v128
    v_mul_f32 v124, v124, v121
    v_mul_f32 v125, v125, v121
    v_cvt_pk_bf16_f32 v128, v124, v125
    v_lshlrev_b32 v124, 16, v129
    v_and_b32 v125, 0xffff0000, v129
    v_sub_f32 v124, v124, v120
    v_sub_f32 v125, v125, v120
    v_cvt_pk_bf16_f32 v129, v124, v125
    v_lshlrev_b32 v124, 16, v129
    v_and_b32 v125, 0xffff0000, v129
    v_mul_f32 v124, v124, v121
    v_mul_f32 v125, v125, v121
    v_cvt_pk_bf16_f32 v129, v124, v125
    v_lshlrev_b32 v124, 16, v130
    v_and_b32 v125, 0xffff0000, v130
    v_sub_f32 v124, v124, v120
    v_sub_f32 v125, v125, v120
    v_cvt_pk_bf16_f32 v130, v124, v125
    v_lshlrev_b32 v124, 16, v130
    v_and_b32 v125, 0xffff0000, v130
    v_mul_f32 v124, v124, v121
    v_mul_f32 v125, v125, v121
    v_cvt_pk_bf16_f32 v130, v124, v125
    v_lshlrev_b32 v124, 16, v131
    v_and_b32 v125, 0xffff0000, v131
    v_sub_f32 v124, v124, v120
    v_sub_f32 v125, v125, v120
    v_cvt_pk_bf16_f32 v131, v124, v125
    v_lshlrev_b32 v124, 16, v131
    v_and_b32 v125, 0xffff0000, v131
    v_mul_f32 v124, v124, v121
    v_mul_f32 v125, v125, v121
    v_cvt_pk_bf16_f32 v131, v124, v125
    v_add_u32 v31, 0, v30
    ds_write_b128 v31, v[128:131]
    v_lshlrev_b32 v124, 16, v160
    v_and_b32 v125, 0xffff0000, v160
    v_sub_f32 v124, v124, v122
    v_sub_f32 v125, v125, v122
    v_cvt_pk_bf16_f32 v160, v124, v125
    v_lshlrev_b32 v124, 16, v160
    v_and_b32 v125, 0xffff0000, v160
    v_mul_f32 v124, v124, v123
    v_mul_f32 v125, v125, v123
    v_cvt_pk_bf16_f32 v160, v124, v125
    v_lshlrev_b32 v124, 16, v161
    v_and_b32 v125, 0xffff0000, v161
    v_sub_f32 v124, v124, v122
    v_sub_f32 v125, v125, v122
    v_cvt_pk_bf16_f32 v161, v124, v125
    v_lshlrev_b32 v124, 16, v161
    v_and_b32 v125, 0xffff0000, v161
    v_mul_f32 v124, v124, v123
    v_mul_f32 v125, v125, v123
    v_cvt_pk_bf16_f32 v161, v124, v125
    v_lshlrev_b32 v124, 16, v162
    v_and_b32 v125, 0xffff0000, v162
    v_sub_f32 v124, v124, v122
    v_sub_f32 v125, v125, v122
    v_cvt_pk_bf16_f32 v162, v124, v125
    v_lshlrev_b32 v124, 16, v162
    v_and_b32 v125, 0xffff0000, v162
    v_mul_f32 v124, v124, v123
    v_mul_f32 v125, v125, v123
    v_cvt_pk_bf16_f32 v162, v124, v125
    v_lshlrev_b32 v124, 16, v163
    v_and_b32 v125, 0xffff0000, v163
    v_sub_f32 v124, v124, v122
    v_sub_f32 v125, v125, v122
    v_cvt_pk_bf16_f32 v163, v124, v125
    v_lshlrev_b32 v124, 16, v163
    v_and_b32 v125, 0xffff0000, v163
    v_mul_f32 v124, v124, v123
    v_mul_f32 v125, v125, v123
    v_cvt_pk_bf16_f32 v163, v124, v125
    v_add_u32 v31, 8192, v30
    ds_write_b128 v31, v[160:163]
    v_lshlrev_b32 v124, 16, v132
    v_and_b32 v125, 0xffff0000, v132
    v_sub_f32 v124, v124, v120
    v_sub_f32 v125, v125, v120
    v_cvt_pk_bf16_f32 v132, v124, v125
    v_lshlrev_b32 v124, 16, v132
    v_and_b32 v125, 0xffff0000, v132
    v_mul_f32 v124, v124, v121
    v_mul_f32 v125, v125, v121
    v_cvt_pk_bf16_f32 v132, v124, v125
    v_lshlrev_b32 v124, 16, v133
    v_and_b32 v125, 0xffff0000, v133
    v_sub_f32 v124, v124, v120
    v_sub_f32 v125, v125, v120
    v_cvt_pk_bf16_f32 v133, v124, v125
    v_lshlrev_b32 v124, 16, v133
    v_and_b32 v125, 0xffff0000, v133
    v_mul_f32 v124, v124, v121
    v_mul_f32 v125, v125, v121
    v_cvt_pk_bf16_f32 v133, v124, v125
    v_lshlrev_b32 v124, 16, v134
    v_and_b32 v125, 0xffff0000, v134
    v_sub_f32 v124, v124, v120
    v_sub_f32 v125, v125, v120
    v_cvt_pk_bf16_f32 v134, v124, v125
    v_lshlrev_b32 v124, 16, v134
    v_and_b32 v125, 0xffff0000, v134
    v_mul_f32 v124, v124, v121
    v_mul_f32 v125, v125, v121
    v_cvt_pk_bf16_f32 v134, v124, v125
    v_lshlrev_b32 v124, 16, v135
    v_and_b32 v125, 0xffff0000, v135
    v_sub_f32 v124, v124, v120
    v_sub_f32 v125, v125, v120
    v_cvt_pk_bf16_f32 v135, v124, v125
    v_lshlrev_b32 v124, 16, v135
    v_and_b32 v125, 0xffff0000, v135
    v_mul_f32 v124, v124, v121
    v_mul_f32 v125, v125, v121
    v_cvt_pk_bf16_f32 v135, v124, v125
    v_add_u32 v31, 32768, v30
    ds_write_b128 v31, v[132:135]
    v_lshlrev_b32 v124, 16, v164
    v_and_b32 v125, 0xffff0000, v164
    v_sub_f32 v124, v124, v122
    v_sub_f32 v125, v125, v122
    v_cvt_pk_bf16_f32 v164, v124, v125
    v_lshlrev_b32 v124, 16, v164
    v_and_b32 v125, 0xffff0000, v164
    v_mul_f32 v124, v124, v123
    v_mul_f32 v125, v125, v123
    v_cvt_pk_bf16_f32 v164, v124, v125
    v_lshlrev_b32 v124, 16, v165
    v_and_b32 v125, 0xffff0000, v165
    v_sub_f32 v124, v124, v122
    v_sub_f32 v125, v125, v122
    v_cvt_pk_bf16_f32 v165, v124, v125
    v_lshlrev_b32 v124, 16, v165
    v_and_b32 v125, 0xffff0000, v165
    v_mul_f32 v124, v124, v123
    v_mul_f32 v125, v125, v123
    v_cvt_pk_bf16_f32 v165, v124, v125
    v_lshlrev_b32 v124, 16, v166
    v_and_b32 v125, 0xffff0000, v166
    v_sub_f32 v124, v124, v122
    v_sub_f32 v125, v125, v122
    v_cvt_pk_bf16_f32 v166, v124, v125
    v_lshlrev_b32 v124, 16, v166
    v_and_b32 v125, 0xffff0000, v166
    v_mul_f32 v124, v124, v123
    v_mul_f32 v125, v125, v123
    v_cvt_pk_bf16_f32 v166, v124, v125
    v_lshlrev_b32 v124, 16, v167
    v_and_b32 v125, 0xffff0000, v167
    v_sub_f32 v124, v124, v122
    v_sub_f32 v125, v125, v122
    v_cvt_pk_bf16_f32 v167, v124, v125
    v_lshlrev_b32 v124, 16, v167
    v_and_b32 v125, 0xffff0000, v167
    v_mul_f32 v124, v124, v123
    v_mul_f32 v125, v125, v123
    v_cvt_pk_bf16_f32 v167, v124, v125
    v_add_u32 v31, 40960, v30
    ds_write_b128 v31, v[164:167]
    v_lshlrev_b32 v124, 16, v136
    v_and_b32 v125, 0xffff0000, v136
    v_sub_f32 v124, v124, v120
    v_sub_f32 v125, v125, v120
    v_cvt_pk_bf16_f32 v136, v124, v125
    v_lshlrev_b32 v124, 16, v136
    v_and_b32 v125, 0xffff0000, v136
    v_mul_f32 v124, v124, v121
    v_mul_f32 v125, v125, v121
    v_cvt_pk_bf16_f32 v136, v124, v125
    v_lshlrev_b32 v124, 16, v137
    v_and_b32 v125, 0xffff0000, v137
    v_sub_f32 v124, v124, v120
    v_sub_f32 v125, v125, v120
    v_cvt_pk_bf16_f32 v137, v124, v125
    v_lshlrev_b32 v124, 16, v137
    v_and_b32 v125, 0xffff0000, v137
    v_mul_f32 v124, v124, v121
    v_mul_f32 v125, v125, v121
    v_cvt_pk_bf16_f32 v137, v124, v125
    v_lshlrev_b32 v124, 16, v138
    v_and_b32 v125, 0xffff0000, v138
    v_sub_f32 v124, v124, v120
    v_sub_f32 v125, v125, v120
    v_cvt_pk_bf16_f32 v138, v124, v125
    v_lshlrev_b32 v124, 16, v138
    v_and_b32 v125, 0xffff0000, v138
    v_mul_f32 v124, v124, v121
    v_mul_f32 v125, v125, v121
    v_cvt_pk_bf16_f32 v138, v124, v125
    v_lshlrev_b32 v124, 16, v139
    v_and_b32 v125, 0xffff0000, v139
    v_sub_f32 v124, v124, v120
    v_sub_f32 v125, v125, v120
    v_cvt_pk_bf16_f32 v139, v124, v125
    v_lshlrev_b32 v124, 16, v139
    v_and_b32 v125, 0xffff0000, v139
    v_mul_f32 v124, v124, v121
    v_mul_f32 v125, v125, v121
    v_cvt_pk_bf16_f32 v139, v124, v125
    v_add_u32 v31, 65536, v30
    ds_write_b128 v31, v[136:139]
    v_lshlrev_b32 v124, 16, v168
    v_and_b32 v125, 0xffff0000, v168
    v_sub_f32 v124, v124, v122
    v_sub_f32 v125, v125, v122
    v_cvt_pk_bf16_f32 v168, v124, v125
    v_lshlrev_b32 v124, 16, v168
    v_and_b32 v125, 0xffff0000, v168
    v_mul_f32 v124, v124, v123
    v_mul_f32 v125, v125, v123
    v_cvt_pk_bf16_f32 v168, v124, v125
    v_lshlrev_b32 v124, 16, v169
    v_and_b32 v125, 0xffff0000, v169
    v_sub_f32 v124, v124, v122
    v_sub_f32 v125, v125, v122
    v_cvt_pk_bf16_f32 v169, v124, v125
    v_lshlrev_b32 v124, 16, v169
    v_and_b32 v125, 0xffff0000, v169
    v_mul_f32 v124, v124, v123
    v_mul_f32 v125, v125, v123
    v_cvt_pk_bf16_f32 v169, v124, v125
    v_lshlrev_b32 v124, 16, v170
    v_and_b32 v125, 0xffff0000, v170
    v_sub_f32 v124, v124, v122
    v_sub_f32 v125, v125, v122
    v_cvt_pk_bf16_f32 v170, v124, v125
    v_lshlrev_b32 v124, 16, v170
    v_and_b32 v125, 0xffff0000, v170
    v_mul_f32 v124, v124, v123
    v_mul_f32 v125, v125, v123
    v_cvt_pk_bf16_f32 v170, v124, v125
    v_lshlrev_b32 v124, 16, v171
    v_and_b32 v125, 0xffff0000, v171
    v_sub_f32 v124, v124, v122
    v_sub_f32 v125, v125, v122
    v_cvt_pk_bf16_f32 v171, v124, v125
    v_lshlrev_b32 v124, 16, v171
    v_and_b32 v125, 0xffff0000, v171
    v_mul_f32 v124, v124, v123
    v_mul_f32 v125, v125, v123
    v_cvt_pk_bf16_f32 v171, v124, v125
    v_add_u32 v31, 73728, v30
    ds_write_b128 v31, v[168:171]
    v_lshlrev_b32 v124, 16, v140
    v_and_b32 v125, 0xffff0000, v140
    v_sub_f32 v124, v124, v120
    v_sub_f32 v125, v125, v120
    v_cvt_pk_bf16_f32 v140, v124, v125
    v_lshlrev_b32 v124, 16, v140
    v_and_b32 v125, 0xffff0000, v140
    v_mul_f32 v124, v124, v121
    v_mul_f32 v125, v125, v121
    v_cvt_pk_bf16_f32 v140, v124, v125
    v_lshlrev_b32 v124, 16, v141
    v_and_b32 v125, 0xffff0000, v141
    v_sub_f32 v124, v124, v120
    v_sub_f32 v125, v125, v120
    v_cvt_pk_bf16_f32 v141, v124, v125
    v_lshlrev_b32 v124, 16, v141
    v_and_b32 v125, 0xffff0000, v141
    v_mul_f32 v124, v124, v121
    v_mul_f32 v125, v125, v121
    v_cvt_pk_bf16_f32 v141, v124, v125
    v_lshlrev_b32 v124, 16, v142
    v_and_b32 v125, 0xffff0000, v142
    v_sub_f32 v124, v124, v120
    v_sub_f32 v125, v125, v120
    v_cvt_pk_bf16_f32 v142, v124, v125
    v_lshlrev_b32 v124, 16, v142
    v_and_b32 v125, 0xffff0000, v142
    v_mul_f32 v124, v124, v121
    v_mul_f32 v125, v125, v121
    v_cvt_pk_bf16_f32 v142, v124, v125
    v_lshlrev_b32 v124, 16, v143
    v_and_b32 v125, 0xffff0000, v143
    v_sub_f32 v124, v124, v120
    v_sub_f32 v125, v125, v120
    v_cvt_pk_bf16_f32 v143, v124, v125
    v_lshlrev_b32 v124, 16, v143
    v_and_b32 v125, 0xffff0000, v143
    v_mul_f32 v124, v124, v121
    v_mul_f32 v125, v125, v121
    v_cvt_pk_bf16_f32 v143, v124, v125
    v_add_u32 v31, 98304, v30
    ds_write_b128 v31, v[140:143]
    v_lshlrev_b32 v124, 16, v172
    v_and_b32 v125, 0xffff0000, v172
    v_sub_f32 v124, v124, v122
    v_sub_f32 v125, v125, v122
    v_cvt_pk_bf16_f32 v172, v124, v125
    v_lshlrev_b32 v124, 16, v172
    v_and_b32 v125, 0xffff0000, v172
    v_mul_f32 v124, v124, v123
    v_mul_f32 v125, v125, v123
    v_cvt_pk_bf16_f32 v172, v124, v125
    v_lshlrev_b32 v124, 16, v173
    v_and_b32 v125, 0xffff0000, v173
    v_sub_f32 v124, v124, v122
    v_sub_f32 v125, v125, v122
    v_cvt_pk_bf16_f32 v173, v124, v125
    v_lshlrev_b32 v124, 16, v173
    v_and_b32 v125, 0xffff0000, v173
    v_mul_f32 v124, v124, v123
    v_mul_f32 v125, v125, v123
    v_cvt_pk_bf16_f32 v173, v124, v125
    v_lshlrev_b32 v124, 16, v174
    v_and_b32 v125, 0xffff0000, v174
    v_sub_f32 v124, v124, v122
    v_sub_f32 v125, v125, v122
    v_cvt_pk_bf16_f32 v174, v124, v125
    v_lshlrev_b32 v124, 16, v174
    v_and_b32 v125, 0xffff0000, v174
    v_mul_f32 v124, v124, v123
    v_mul_f32 v125, v125, v123
    v_cvt_pk_bf16_f32 v174, v124, v125
    v_lshlrev_b32 v124, 16, v175
    v_and_b32 v125, 0xffff0000, v175
    v_sub_f32 v124, v124, v122
    v_sub_f32 v125, v125, v122
    v_cvt_pk_bf16_f32 v175, v124, v125
    v_lshlrev_b32 v124, 16, v175
    v_and_b32 v125, 0xffff0000, v175
    v_mul_f32 v124, v124, v123
    v_mul_f32 v125, v125, v123
    v_cvt_pk_bf16_f32 v175, v124, v125
    v_add_u32 v31, 106496, v30
    ds_write_b128 v31, v[172:175]
    s_waitcnt vmcnt(6) lgkmcnt(0)
    s_barrier
    v_add_u32 v22, 0, v10
    v_add_u32 v23, 0, v11
    v_add_u32 v24, 0, v12
    v_add_u32 v25, 0, v13
    v_add_u32 v26, 0, v20
    ds_read_b128 v[32:35], v22 offset:0
    ds_read_b128 v[36:39], v22 offset:4096
    ds_read_b64_tr_b16 v[40:41], v26 offset:0
    ds_read_b64_tr_b16 v[42:43], v26 offset:1024
    ds_read_b128 v[48:51], v23 offset:0
    ds_read_b128 v[52:55], v23 offset:4096
    ds_read_b64_tr_b16 v[56:57], v26 offset:4096
    ds_read_b64_tr_b16 v[58:59], v26 offset:5120
    s_waitcnt lgkmcnt(4)
    v_mfma_f32_32x32x16_bf16 v[64:79], v[40:43], v[32:35], v[64:79]
    v_lshlrev_b32 v124, 16, v144
    v_and_b32 v125, 0xffff0000, v144
    v_sub_f32 v124, v124, v120
    v_sub_f32 v125, v125, v120
    v_cvt_pk_bf16_f32 v144, v124, v125
    v_lshlrev_b32 v124, 16, v144
    v_and_b32 v125, 0xffff0000, v144
    v_mul_f32 v124, v124, v121
    v_mul_f32 v125, v125, v121
    v_cvt_pk_bf16_f32 v144, v124, v125
    v_lshlrev_b32 v124, 16, v145
    v_and_b32 v125, 0xffff0000, v145
    v_sub_f32 v124, v124, v120
    v_sub_f32 v125, v125, v120
    v_cvt_pk_bf16_f32 v145, v124, v125
    v_lshlrev_b32 v124, 16, v145
    v_and_b32 v125, 0xffff0000, v145
    v_mul_f32 v124, v124, v121
    v_mul_f32 v125, v125, v121
    v_cvt_pk_bf16_f32 v145, v124, v125
    v_lshlrev_b32 v124, 16, v146
    v_and_b32 v125, 0xffff0000, v146
    v_sub_f32 v124, v124, v120
    v_sub_f32 v125, v125, v120
    v_cvt_pk_bf16_f32 v146, v124, v125
    v_lshlrev_b32 v124, 16, v146
    v_and_b32 v125, 0xffff0000, v146
    v_mul_f32 v124, v124, v121
    v_mul_f32 v125, v125, v121
    v_cvt_pk_bf16_f32 v146, v124, v125
    v_lshlrev_b32 v124, 16, v147
    v_and_b32 v125, 0xffff0000, v147
    v_sub_f32 v124, v124, v120
    v_sub_f32 v125, v125, v120
    v_cvt_pk_bf16_f32 v147, v124, v125
    v_lshlrev_b32 v124, 16, v147
    v_and_b32 v125, 0xffff0000, v147
    v_mul_f32 v124, v124, v121
    v_mul_f32 v125, v125, v121
    v_cvt_pk_bf16_f32 v147, v124, v125
    v_add_u32 v31, 131072, v30
    ds_write_b128 v31, v[144:147]
    v_mfma_f32_32x32x16_bf16 v[80:95], v[40:43], v[36:39], v[80:95]
    v_lshlrev_b32 v124, 16, v176
    v_and_b32 v125, 0xffff0000, v176
    v_sub_f32 v124, v124, v122
    v_sub_f32 v125, v125, v122
    v_cvt_pk_bf16_f32 v176, v124, v125
    v_lshlrev_b32 v124, 16, v176
    v_and_b32 v125, 0xffff0000, v176
    v_mul_f32 v124, v124, v123
    v_mul_f32 v125, v125, v123
    v_cvt_pk_bf16_f32 v176, v124, v125
    v_lshlrev_b32 v124, 16, v177
    v_and_b32 v125, 0xffff0000, v177
    v_sub_f32 v124, v124, v122
    v_sub_f32 v125, v125, v122
    v_cvt_pk_bf16_f32 v177, v124, v125
    v_lshlrev_b32 v124, 16, v177
    v_and_b32 v125, 0xffff0000, v177
    v_mul_f32 v124, v124, v123
    v_mul_f32 v125, v125, v123
    v_cvt_pk_bf16_f32 v177, v124, v125
    v_lshlrev_b32 v124, 16, v178
    v_and_b32 v125, 0xffff0000, v178
    v_sub_f32 v124, v124, v122
    v_sub_f32 v125, v125, v122
    v_cvt_pk_bf16_f32 v178, v124, v125
    v_lshlrev_b32 v124, 16, v178
    v_and_b32 v125, 0xffff0000, v178
    v_mul_f32 v124, v124, v123
    v_mul_f32 v125, v125, v123
    v_cvt_pk_bf16_f32 v178, v124, v125
    v_lshlrev_b32 v124, 16, v179
    v_and_b32 v125, 0xffff0000, v179
    v_sub_f32 v124, v124, v122
    v_sub_f32 v125, v125, v122
    v_cvt_pk_bf16_f32 v179, v124, v125
    v_lshlrev_b32 v124, 16, v179
    v_and_b32 v125, 0xffff0000, v179
    v_mul_f32 v124, v124, v123
    v_mul_f32 v125, v125, v123
    v_cvt_pk_bf16_f32 v179, v124, v125
    v_add_u32 v31, 139264, v30
    ds_write_b128 v31, v[176:179]
    ds_read_b128 v[32:35], v24 offset:0
    ds_read_b128 v[36:39], v24 offset:4096
    ds_read_b64_tr_b16 v[40:41], v26 offset:8192
    ds_read_b64_tr_b16 v[42:43], v26 offset:9216
    s_waitcnt lgkmcnt(4)
    v_mfma_f32_32x32x16_bf16 v[64:79], v[56:59], v[48:51], v[64:79]
    s_add_u32 m0, s45, 147456
    s_add_u32 s46, s36, 786432
    buffer_load_dwordx4 v4, s[8:11], s46 offen lds
    v_mfma_f32_32x32x16_bf16 v[80:95], v[56:59], v[52:55], v[80:95]
    s_add_u32 m0, s45, 155648
    s_add_u32 s46, s37, 786432
    buffer_load_dwordx4 v4, s[8:11], s46 offen lds
    ds_read_b128 v[48:51], v25 offset:0
    ds_read_b128 v[52:55], v25 offset:4096
    ds_read_b64_tr_b16 v[56:57], v26 offset:12288
    ds_read_b64_tr_b16 v[58:59], v26 offset:13312
    s_waitcnt lgkmcnt(4)
    v_mfma_f32_32x32x16_bf16 v[64:79], v[40:43], v[32:35], v[64:79]
    v_mfma_f32_32x32x16_bf16 v[80:95], v[40:43], v[36:39], v[80:95]
    s_waitcnt lgkmcnt(0)
    v_mfma_f32_32x32x16_bf16 v[64:79], v[56:59], v[48:51], v[64:79]
    v_mfma_f32_32x32x16_bf16 v[80:95], v[56:59], v[52:55], v[80:95]
    s_waitcnt vmcnt(6) lgkmcnt(0)
    s_barrier
    v_add_u32 v22, 32768, v10
    v_add_u32 v23, 32768, v11
    v_add_u32 v24, 32768, v12
    v_add_u32 v25, 32768, v13
    v_add_u32 v26, 32768, v20
    ds_read_b128 v[32:35], v22 offset:0
    ds_read_b128 v[36:39], v22 offset:4096
    ds_read_b64_tr_b16 v[40:41], v26 offset:0
    ds_read_b64_tr_b16 v[42:43], v26 offset:1024
    ds_read_b128 v[48:51], v23 offset:0
    ds_read_b128 v[52:55], v23 offset:4096
    ds_read_b64_tr_b16 v[56:57], v26 offset:4096
    ds_read_b64_tr_b16 v[58:59], v26 offset:5120
    s_waitcnt lgkmcnt(4)
    v_mfma_f32_32x32x16_bf16 v[64:79], v[40:43], v[32:35], v[64:79]
    v_lshlrev_b32 v124, 16, v148
    v_and_b32 v125, 0xffff0000, v148
    v_sub_f32 v124, v124, v120
    v_sub_f32 v125, v125, v120
    v_cvt_pk_bf16_f32 v148, v124, v125
    v_lshlrev_b32 v124, 16, v148
    v_and_b32 v125, 0xffff0000, v148
    v_mul_f32 v124, v124, v121
    v_mul_f32 v125, v125, v121
    v_cvt_pk_bf16_f32 v148, v124, v125
    v_lshlrev_b32 v124, 16, v149
    v_and_b32 v125, 0xffff0000, v149
    v_sub_f32 v124, v124, v120
    v_sub_f32 v125, v125, v120
    v_cvt_pk_bf16_f32 v149, v124, v125
    v_lshlrev_b32 v124, 16, v149
    v_and_b32 v125, 0xffff0000, v149
    v_mul_f32 v124, v124, v121
    v_mul_f32 v125, v125, v121
    v_cvt_pk_bf16_f32 v149, v124, v125
    v_lshlrev_b32 v124, 16, v150
    v_and_b32 v125, 0xffff0000, v150
    v_sub_f32 v124, v124, v120
    v_sub_f32 v125, v125, v120
    v_cvt_pk_bf16_f32 v150, v124, v125
    v_lshlrev_b32 v124, 16, v150
    v_and_b32 v125, 0xffff0000, v150
    v_mul_f32 v124, v124, v121
    v_mul_f32 v125, v125, v121
    v_cvt_pk_bf16_f32 v150, v124, v125
    v_lshlrev_b32 v124, 16, v151
    v_and_b32 v125, 0xffff0000, v151
    v_sub_f32 v124, v124, v120
    v_sub_f32 v125, v125, v120
    v_cvt_pk_bf16_f32 v151, v124, v125
    v_lshlrev_b32 v124, 16, v151
    v_and_b32 v125, 0xffff0000, v151
    v_mul_f32 v124, v124, v121
    v_mul_f32 v125, v125, v121
    v_cvt_pk_bf16_f32 v151, v124, v125
    v_add_u32 v31, 0, v30
    ds_write_b128 v31, v[148:151]
    v_mfma_f32_32x32x16_bf16 v[80:95], v[40:43], v[36:39], v[80:95]
    v_lshlrev_b32 v124, 16, v180
    v_and_b32 v125, 0xffff0000, v180
    v_sub_f32 v124, v124, v122
    v_sub_f32 v125, v125, v122
    v_cvt_pk_bf16_f32 v180, v124, v125
    v_lshlrev_b32 v124, 16, v180
    v_and_b32 v125, 0xffff0000, v180
    v_mul_f32 v124, v124, v123
    v_mul_f32 v125, v125, v123
    v_cvt_pk_bf16_f32 v180, v124, v125
    v_lshlrev_b32 v124, 16, v181
    v_and_b32 v125, 0xffff0000, v181
    v_sub_f32 v124, v124, v122
    v_sub_f32 v125, v125, v122
    v_cvt_pk_bf16_f32 v181, v124, v125
    v_lshlrev_b32 v124, 16, v181
    v_and_b32 v125, 0xffff0000, v181
    v_mul_f32 v124, v124, v123
    v_mul_f32 v125, v125, v123
    v_cvt_pk_bf16_f32 v181, v124, v125
    v_lshlrev_b32 v124, 16, v182
    v_and_b32 v125, 0xffff0000, v182
    v_sub_f32 v124, v124, v122
    v_sub_f32 v125, v125, v122
    v_cvt_pk_bf16_f32 v182, v124, v125
    v_lshlrev_b32 v124, 16, v182
    v_and_b32 v125, 0xffff0000, v182
    v_mul_f32 v124, v124, v123
    v_mul_f32 v125, v125, v123
    v_cvt_pk_bf16_f32 v182, v124, v125
    v_lshlrev_b32 v124, 16, v183
    v_and_b32 v125, 0xffff0000, v183
    v_sub_f32 v124, v124, v122
    v_sub_f32 v125, v125, v122
    v_cvt_pk_bf16_f32 v183, v124, v125
    v_lshlrev_b32 v124, 16, v183
    v_and_b32 v125, 0xffff0000, v183
    v_mul_f32 v124, v124, v123
    v_mul_f32 v125, v125, v123
    v_cvt_pk_bf16_f32 v183, v124, v125
    v_add_u32 v31, 8192, v30
    ds_write_b128 v31, v[180:183]
    ds_read_b128 v[32:35], v24 offset:0
    ds_read_b128 v[36:39], v24 offset:4096
    ds_read_b64_tr_b16 v[40:41], v26 offset:8192
    ds_read_b64_tr_b16 v[42:43], v26 offset:9216
    s_waitcnt lgkmcnt(4)
    v_mfma_f32_32x32x16_bf16 v[64:79], v[56:59], v[48:51], v[64:79]
    s_add_u32 m0, s45, 16384
    s_add_u32 s46, s36, 983040
    buffer_load_dwordx4 v4, s[8:11], s46 offen lds
    v_mfma_f32_32x32x16_bf16 v[80:95], v[56:59], v[52:55], v[80:95]
    s_add_u32 m0, s45, 24576
    s_add_u32 s46, s37, 983040
    buffer_load_dwordx4 v4, s[8:11], s46 offen lds
    ds_read_b128 v[48:51], v25 offset:0
    ds_read_b128 v[52:55], v25 offset:4096
    ds_read_b64_tr_b16 v[56:57], v26 offset:12288
    ds_read_b64_tr_b16 v[58:59], v26 offset:13312
    s_waitcnt lgkmcnt(4)
    v_mfma_f32_32x32x16_bf16 v[64:79], v[40:43], v[32:35], v[64:79]
    v_mfma_f32_32x32x16_bf16 v[80:95], v[40:43], v[36:39], v[80:95]
    s_waitcnt lgkmcnt(0)
    v_mfma_f32_32x32x16_bf16 v[64:79], v[56:59], v[48:51], v[64:79]
    v_mfma_f32_32x32x16_bf16 v[80:95], v[56:59], v[52:55], v[80:95]
    s_waitcnt vmcnt(6) lgkmcnt(0)
    s_barrier
    v_add_u32 v22, 65536, v10
    v_add_u32 v23, 65536, v11
    v_add_u32 v24, 65536, v12
    v_add_u32 v25, 65536, v13
    v_add_u32 v26, 65536, v20
    ds_read_b128 v[32:35], v22 offset:0
    ds_read_b128 v[36:39], v22 offset:4096
    ds_read_b64_tr_b16 v[40:41], v26 offset:0
    ds_read_b64_tr_b16 v[42:43], v26 offset:1024
    ds_read_b128 v[48:51], v23 offset:0
    ds_read_b128 v[52:55], v23 offset:4096
    ds_read_b64_tr_b16 v[56:57], v26 offset:4096
    ds_read_b64_tr_b16 v[58:59], v26 offset:5120
    s_waitcnt lgkmcnt(4)
    v_mfma_f32_32x32x16_bf16 v[64:79], v[40:43], v[32:35], v[64:79]
    v_lshlrev_b32 v124, 16, v152
    v_and_b32 v125, 0xffff0000, v152
    v_sub_f32 v124, v124, v120
    v_sub_f32 v125, v125, v120
    v_cvt_pk_bf16_f32 v152, v124, v125
    v_lshlrev_b32 v124, 16, v152
    v_and_b32 v125, 0xffff0000, v152
    v_mul_f32 v124, v124, v121
    v_mul_f32 v125, v125, v121
    v_cvt_pk_bf16_f32 v152, v124, v125
    v_lshlrev_b32 v124, 16, v153
    v_and_b32 v125, 0xffff0000, v153
    v_sub_f32 v124, v124, v120
    v_sub_f32 v125, v125, v120
    v_cvt_pk_bf16_f32 v153, v124, v125
    v_lshlrev_b32 v124, 16, v153
    v_and_b32 v125, 0xffff0000, v153
    v_mul_f32 v124, v124, v121
    v_mul_f32 v125, v125, v121
    v_cvt_pk_bf16_f32 v153, v124, v125
    v_lshlrev_b32 v124, 16, v154
    v_and_b32 v125, 0xffff0000, v154
    v_sub_f32 v124, v124, v120
    v_sub_f32 v125, v125, v120
    v_cvt_pk_bf16_f32 v154, v124, v125
    v_lshlrev_b32 v124, 16, v154
    v_and_b32 v125, 0xffff0000, v154
    v_mul_f32 v124, v124, v121
    v_mul_f32 v125, v125, v121
    v_cvt_pk_bf16_f32 v154, v124, v125
    v_lshlrev_b32 v124, 16, v155
    v_and_b32 v125, 0xffff0000, v155
    v_sub_f32 v124, v124, v120
    v_sub_f32 v125, v125, v120
    v_cvt_pk_bf16_f32 v155, v124, v125
    v_lshlrev_b32 v124, 16, v155
    v_and_b32 v125, 0xffff0000, v155
    v_mul_f32 v124, v124, v121
    v_mul_f32 v125, v125, v121
    v_cvt_pk_bf16_f32 v155, v124, v125
    v_add_u32 v31, 32768, v30
    ds_write_b128 v31, v[152:155]
    v_mfma_f32_32x32x16_bf16 v[80:95], v[40:43], v[36:39], v[80:95]
    v_lshlrev_b32 v124, 16, v184
    v_and_b32 v125, 0xffff0000, v184
    v_sub_f32 v124, v124, v122
    v_sub_f32 v125, v125, v122
    v_cvt_pk_bf16_f32 v184, v124, v125
    v_lshlrev_b32 v124, 16, v184
    v_and_b32 v125, 0xffff0000, v184
    v_mul_f32 v124, v124, v123
    v_mul_f32 v125, v125, v123
    v_cvt_pk_bf16_f32 v184, v124, v125
    v_lshlrev_b32 v124, 16, v185
    v_and_b32 v125, 0xffff0000, v185
    v_sub_f32 v124, v124, v122
    v_sub_f32 v125, v125, v122
    v_cvt_pk_bf16_f32 v185, v124, v125
    v_lshlrev_b32 v124, 16, v185
    v_and_b32 v125, 0xffff0000, v185
    v_mul_f32 v124, v124, v123
    v_mul_f32 v125, v125, v123
    v_cvt_pk_bf16_f32 v185, v124, v125
    v_lshlrev_b32 v124, 16, v186
    v_and_b32 v125, 0xffff0000, v186
    v_sub_f32 v124, v124, v122
    v_sub_f32 v125, v125, v122
    v_cvt_pk_bf16_f32 v186, v124, v125
    v_lshlrev_b32 v124, 16, v186
    v_and_b32 v125, 0xffff0000, v186
    v_mul_f32 v124, v124, v123
    v_mul_f32 v125, v125, v123
    v_cvt_pk_bf16_f32 v186, v124, v125
    v_lshlrev_b32 v124, 16, v187
    v_and_b32 v125, 0xffff0000, v187
    v_sub_f32 v124, v124, v122
    v_sub_f32 v125, v125, v122
    v_cvt_pk_bf16_f32 v187, v124, v125
    v_lshlrev_b32 v124, 16, v187
    v_and_b32 v125, 0xffff0000, v187
    v_mul_f32 v124, v124, v123
    v_mul_f32 v125, v125, v123
    v_cvt_pk_bf16_f32 v187, v124, v125
    v_add_u32 v31, 40960, v30
    ds_write_b128 v31, v[184:187]
    ds_read_b128 v[32:35], v24 offset:0
    ds_read_b128 v[36:39], v24 offset:4096
    ds_read_b64_tr_b16 v[40:41], v26 offset:8192
    ds_read_b64_tr_b16 v[42:43], v26 offset:9216
    s_waitcnt lgkmcnt(4)
    v_mfma_f32_32x32x16_bf16 v[64:79], v[56:59], v[48:51], v[64:79]
    s_add_u32 m0, s45, 49152
    s_add_u32 s46, s36, 1179648
    buffer_load_dwordx4 v4, s[8:11], s46 offen lds
    v_mfma_f32_32x32x16_bf16 v[80:95], v[56:59], v[52:55], v[80:95]
    s_add_u32 m0, s45, 57344
    s_add_u32 s46, s37, 1179648
    buffer_load_dwordx4 v4, s[8:11], s46 offen lds
    ds_read_b128 v[48:51], v25 offset:0
    ds_read_b128 v[52:55], v25 offset:4096
    ds_read_b64_tr_b16 v[56:57], v26 offset:12288
    ds_read_b64_tr_b16 v[58:59], v26 offset:13312
    s_waitcnt lgkmcnt(4)
    v_mfma_f32_32x32x16_bf16 v[64:79], v[40:43], v[32:35], v[64:79]
    v_mfma_f32_32x32x16_bf16 v[80:95], v[40:43], v[36:39], v[80:95]
    s_waitcnt lgkmcnt(0)
    v_mfma_f32_32x32x16_bf16 v[64:79], v[56:59], v[48:51], v[64:79]
    v_mfma_f32_32x32x16_bf16 v[80:95], v[56:59], v[52:55], v[80:95]
    s_waitcnt vmcnt(6) lgkmcnt(0)
    s_barrier
    v_add_u32 v22, 98304, v10
    v_add_u32 v23, 98304, v11
    v_add_u32 v24, 98304, v12
    v_add_u32 v25, 98304, v13
    v_add_u32 v26, 98304, v20
    ds_read_b128 v[32:35], v22 offset:0
    ds_read_b128 v[36:39], v22 offset:4096
    ds_read_b64_tr_b16 v[40:41], v26 offset:0
    ds_read_b64_tr_b16 v[42:43], v26 offset:1024
    ds_read_b128 v[48:51], v23 offset:0
    ds_read_b128 v[52:55], v23 offset:4096
    ds_read_b64_tr_b16 v[56:57], v26 offset:4096
    ds_read_b64_tr_b16 v[58:59], v26 offset:5120
    s_waitcnt lgkmcnt(4)
    v_mfma_f32_32x32x16_bf16 v[64:79], v[40:43], v[32:35], v[64:79]
    v_lshlrev_b32 v124, 16, v156
    v_and_b32 v125, 0xffff0000, v156
    v_sub_f32 v124, v124, v120
    v_sub_f32 v125, v125, v120
    v_cvt_pk_bf16_f32 v156, v124, v125
    v_lshlrev_b32 v124, 16, v156
    v_and_b32 v125, 0xffff0000, v156
    v_mul_f32 v124, v124, v121
    v_mul_f32 v125, v125, v121
    v_cvt_pk_bf16_f32 v156, v124, v125
    v_lshlrev_b32 v124, 16, v157
    v_and_b32 v125, 0xffff0000, v157
    v_sub_f32 v124, v124, v120
    v_sub_f32 v125, v125, v120
    v_cvt_pk_bf16_f32 v157, v124, v125
    v_lshlrev_b32 v124, 16, v157
    v_and_b32 v125, 0xffff0000, v157
    v_mul_f32 v124, v124, v121
    v_mul_f32 v125, v125, v121
    v_cvt_pk_bf16_f32 v157, v124, v125
    v_lshlrev_b32 v124, 16, v158
    v_and_b32 v125, 0xffff0000, v158
    v_sub_f32 v124, v124, v120
    v_sub_f32 v125, v125, v120
    v_cvt_pk_bf16_f32 v158, v124, v125
    v_lshlrev_b32 v124, 16, v158
    v_and_b32 v125, 0xffff0000, v158
    v_mul_f32 v124, v124, v121
    v_mul_f32 v125, v125, v121
    v_cvt_pk_bf16_f32 v158, v124, v125
    v_lshlrev_b32 v124, 16, v159
    v_and_b32 v125, 0xffff0000, v159
    v_sub_f32 v124, v124, v120
    v_sub_f32 v125, v125, v120
    v_cvt_pk_bf16_f32 v159, v124, v125
    v_lshlrev_b32 v124, 16, v159
    v_and_b32 v125, 0xffff0000, v159
    v_mul_f32 v124, v124, v121
    v_mul_f32 v125, v125, v121
    v_cvt_pk_bf16_f32 v159, v124, v125
    v_add_u32 v31, 65536, v30
    ds_write_b128 v31, v[156:159]
    v_mfma_f32_32x32x16_bf16 v[80:95], v[40:43], v[36:39], v[80:95]
    v_lshlrev_b32 v124, 16, v188
    v_and_b32 v125, 0xffff0000, v188
    v_sub_f32 v124, v124, v122
    v_sub_f32 v125, v125, v122
    v_cvt_pk_bf16_f32 v188, v124, v125
    v_lshlrev_b32 v124, 16, v188
    v_and_b32 v125, 0xffff0000, v188
    v_mul_f32 v124, v124, v123
    v_mul_f32 v125, v125, v123
    v_cvt_pk_bf16_f32 v188, v124, v125
    v_lshlrev_b32 v124, 16, v189
    v_and_b32 v125, 0xffff0000, v189
    v_sub_f32 v124, v124, v122
    v_sub_f32 v125, v125, v122
    v_cvt_pk_bf16_f32 v189, v124, v125
    v_lshlrev_b32 v124, 16, v189
    v_and_b32 v125, 0xffff0000, v189
    v_mul_f32 v124, v124, v123
    v_mul_f32 v125, v125, v123
    v_cvt_pk_bf16_f32 v189, v124, v125
    v_lshlrev_b32 v124, 16, v190
    v_and_b32 v125, 0xffff0000, v190
    v_sub_f32 v124, v124, v122
    v_sub_f32 v125, v125, v122
    v_cvt_pk_bf16_f32 v190, v124, v125
    v_lshlrev_b32 v124, 16, v190
    v_and_b32 v125, 0xffff0000, v190
    v_mul_f32 v124, v124, v123
    v_mul_f32 v125, v125, v123
    v_cvt_pk_bf16_f32 v190, v124, v125
    v_lshlrev_b32 v124, 16, v191
    v_and_b32 v125, 0xffff0000, v191
    v_sub_f32 v124, v124, v122
    v_sub_f32 v125, v125, v122
    v_cvt_pk_bf16_f32 v191, v124, v125
    v_lshlrev_b32 v124, 16, v191
    v_and_b32 v125, 0xffff0000, v191
    v_mul_f32 v124, v124, v123
    v_mul_f32 v125, v125, v123
    v_cvt_pk_bf16_f32 v191, v124, v125
    v_add_u32 v31, 73728, v30
    ds_write_b128 v31, v[188:191]
    ds_read_b128 v[32:35], v24 offset:0
    ds_read_b128 v[36:39], v24 offset:4096
    ds_read_b64_tr_b16 v[40:41], v26 offset:8192
    ds_read_b64_tr_b16 v[42:43], v26 offset:9216
    s_waitcnt lgkmcnt(4)
    v_mfma_f32_32x32x16_bf16 v[64:79], v[56:59], v[48:51], v[64:79]
    s_add_u32 m0, s45, 81920
    s_add_u32 s46, s36, 1376256
    buffer_load_dwordx4 v4, s[8:11], s46 offen lds
    v_mfma_f32_32x32x16_bf16 v[80:95], v[56:59], v[52:55], v[80:95]
    s_add_u32 m0, s45, 90112
    s_add_u32 s46, s37, 1376256
    buffer_load_dwordx4 v4, s[8:11], s46 offen lds
    ds_read_b128 v[48:51], v25 offset:0
    ds_read_b128 v[52:55], v25 offset:4096
    ds_read_b64_tr_b16 v[56:57], v26 offset:12288
    ds_read_b64_tr_b16 v[58:59], v26 offset:13312
    s_waitcnt lgkmcnt(4)
    v_mfma_f32_32x32x16_bf16 v[64:79], v[40:43], v[32:35], v[64:79]
    v_mfma_f32_32x32x16_bf16 v[80:95], v[40:43], v[36:39], v[80:95]
    s_waitcnt lgkmcnt(0)
    v_mfma_f32_32x32x16_bf16 v[64:79], v[56:59], v[48:51], v[64:79]
    v_mfma_f32_32x32x16_bf16 v[80:95], v[56:59], v[52:55], v[80:95]
    s_waitcnt vmcnt(6) lgkmcnt(0)
    s_barrier
    v_add_u32 v22, 131072, v10
    v_add_u32 v23, 131072, v11
    v_add_u32 v24, 131072, v12
    v_add_u32 v25, 131072, v13
    v_add_u32 v26, 131072, v20
    ds_read_b128 v[32:35], v22 offset:0
    ds_read_b128 v[36:39], v22 offset:4096
    ds_read_b64_tr_b16 v[40:41], v26 offset:0
    ds_read_b64_tr_b16 v[42:43], v26 offset:1024
    ds_read_b128 v[48:51], v23 offset:0
    ds_read_b128 v[52:55], v23 offset:4096
    ds_read_b64_tr_b16 v[56:57], v26 offset:4096
    ds_read_b64_tr_b16 v[58:59], v26 offset:5120
    s_waitcnt lgkmcnt(4)
    v_mfma_f32_32x32x16_bf16 v[64:79], v[40:43], v[32:35], v[64:79]
    v_mfma_f32_32x32x16_bf16 v[80:95], v[40:43], v[36:39], v[80:95]
    ds_read_b128 v[32:35], v24 offset:0
    ds_read_b128 v[36:39], v24 offset:4096
    ds_read_b64_tr_b16 v[40:41], v26 offset:8192
    ds_read_b64_tr_b16 v[42:43], v26 offset:9216
    s_waitcnt lgkmcnt(4)
    v_mfma_f32_32x32x16_bf16 v[64:79], v[56:59], v[48:51], v[64:79]
    v_mfma_f32_32x32x16_bf16 v[80:95], v[56:59], v[52:55], v[80:95]
    ds_read_b128 v[48:51], v25 offset:0
    ds_read_b128 v[52:55], v25 offset:4096
    ds_read_b64_tr_b16 v[56:57], v26 offset:12288
    ds_read_b64_tr_b16 v[58:59], v26 offset:13312
    s_waitcnt lgkmcnt(4)
    v_mfma_f32_32x32x16_bf16 v[64:79], v[40:43], v[32:35], v[64:79]
    v_mfma_f32_32x32x16_bf16 v[80:95], v[40:43], v[36:39], v[80:95]
    s_waitcnt lgkmcnt(0)
    v_mfma_f32_32x32x16_bf16 v[64:79], v[56:59], v[48:51], v[64:79]
    v_mfma_f32_32x32x16_bf16 v[80:95], v[56:59], v[52:55], v[80:95]
    s_waitcnt vmcnt(4) lgkmcnt(0)
    s_barrier
    v_add_u32 v22, 0, v10
    v_add_u32 v23, 0, v11
    v_add_u32 v24, 0, v12
    v_add_u32 v25, 0, v13
    v_add_u32 v26, 0, v20
    ds_read_b128 v[32:35], v22 offset:0
    ds_read_b128 v[36:39], v22 offset:4096
    ds_read_b64_tr_b16 v[40:41], v26 offset:0
    ds_read_b64_tr_b16 v[42:43], v26 offset:1024
    ds_read_b128 v[48:51], v23 offset:0
    ds_read_b128 v[52:55], v23 offset:4096
    ds_read_b64_tr_b16 v[56:57], v26 offset:4096
    ds_read_b64_tr_b16 v[58:59], v26 offset:5120
    s_waitcnt lgkmcnt(4)
    v_mfma_f32_32x32x16_bf16 v[64:79], v[40:43], v[32:35], v[64:79]
    v_mfma_f32_32x32x16_bf16 v[80:95], v[40:43], v[36:39], v[80:95]
    ds_read_b128 v[32:35], v24 offset:0
    ds_read_b128 v[36:39], v24 offset:4096
    ds_read_b64_tr_b16 v[40:41], v26 offset:8192
    ds_read_b64_tr_b16 v[42:43], v26 offset:9216
    s_waitcnt lgkmcnt(4)
    v_mfma_f32_32x32x16_bf16 v[64:79], v[56:59], v[48:51], v[64:79]
    v_mfma_f32_32x32x16_bf16 v[80:95], v[56:59], v[52:55], v[80:95]
    ds_read_b128 v[48:51], v25 offset:0
    ds_read_b128 v[52:55], v25 offset:4096
    ds_read_b64_tr_b16 v[56:57], v26 offset:12288
    ds_read_b64_tr_b16 v[58:59], v26 offset:13312
    s_waitcnt lgkmcnt(4)
    v_mfma_f32_32x32x16_bf16 v[64:79], v[40:43], v[32:35], v[64:79]
    v_mfma_f32_32x32x16_bf16 v[80:95], v[40:43], v[36:39], v[80:95]
    s_waitcnt lgkmcnt(0)
    v_mfma_f32_32x32x16_bf16 v[64:79], v[56:59], v[48:51], v[64:79]
    v_mfma_f32_32x32x16_bf16 v[80:95], v[56:59], v[52:55], v[80:95]
    s_waitcnt vmcnt(2) lgkmcnt(0)
    s_barrier
    v_add_u32 v22, 32768, v10
    v_add_u32 v23, 32768, v11
    v_add_u32 v24, 32768, v12
    v_add_u32 v25, 32768, v13
    v_add_u32 v26, 32768, v20
    ds_read_b128 v[32:35], v22 offset:0
    ds_read_b128 v[36:39], v22 offset:4096
    ds_read_b64_tr_b16 v[40:41], v26 offset:0
    ds_read_b64_tr_b16 v[42:43], v26 offset:1024
    ds_read_b128 v[48:51], v23 offset:0
    ds_read_b128 v[52:55], v23 offset:4096
    ds_read_b64_tr_b16 v[56:57], v26 offset:4096
    ds_read_b64_tr_b16 v[58:59], v26 offset:5120
    s_waitcnt lgkmcnt(4)
    v_mfma_f32_32x32x16_bf16 v[64:79], v[40:43], v[32:35], v[64:79]
    v_mfma_f32_32x32x16_bf16 v[80:95], v[40:43], v[36:39], v[80:95]
    ds_read_b128 v[32:35], v24 offset:0
    ds_read_b128 v[36:39], v24 offset:4096
    ds_read_b64_tr_b16 v[40:41], v26 offset:8192
    ds_read_b64_tr_b16 v[42:43], v26 offset:9216
    s_waitcnt lgkmcnt(4)
    v_mfma_f32_32x32x16_bf16 v[64:79], v[56:59], v[48:51], v[64:79]
    v_mfma_f32_32x32x16_bf16 v[80:95], v[56:59], v[52:55], v[80:95]
    ds_read_b128 v[48:51], v25 offset:0
    ds_read_b128 v[52:55], v25 offset:4096
    ds_read_b64_tr_b16 v[56:57], v26 offset:12288
    ds_read_b64_tr_b16 v[58:59], v26 offset:13312
    s_waitcnt lgkmcnt(4)
    v_mfma_f32_32x32x16_bf16 v[64:79], v[40:43], v[32:35], v[64:79]
    v_mfma_f32_32x32x16_bf16 v[80:95], v[40:43], v[36:39], v[80:95]
    s_waitcnt lgkmcnt(0)
    v_mfma_f32_32x32x16_bf16 v[64:79], v[56:59], v[48:51], v[64:79]
    v_mfma_f32_32x32x16_bf16 v[80:95], v[56:59], v[52:55], v[80:95]
    s_waitcnt vmcnt(0) lgkmcnt(0)
    s_barrier
    v_add_u32 v22, 65536, v10
    v_add_u32 v23, 65536, v11
    v_add_u32 v24, 65536, v12
    v_add_u32 v25, 65536, v13
    v_add_u32 v26, 65536, v20
    ds_read_b128 v[32:35], v22 offset:0
    ds_read_b128 v[36:39], v22 offset:4096
    ds_read_b64_tr_b16 v[40:41], v26 offset:0
    ds_read_b64_tr_b16 v[42:43], v26 offset:1024
    ds_read_b128 v[48:51], v23 offset:0
    ds_read_b128 v[52:55], v23 offset:4096
    ds_read_b64_tr_b16 v[56:57], v26 offset:4096
    ds_read_b64_tr_b16 v[58:59], v26 offset:5120
    s_waitcnt lgkmcnt(4)
    v_mfma_f32_32x32x16_bf16 v[64:79], v[40:43], v[32:35], v[64:79]
    v_mfma_f32_32x32x16_bf16 v[80:95], v[40:43], v[36:39], v[80:95]
    ds_read_b128 v[32:35], v24 offset:0
    ds_read_b128 v[36:39], v24 offset:4096
    ds_read_b64_tr_b16 v[40:41], v26 offset:8192
    ds_read_b64_tr_b16 v[42:43], v26 offset:9216
    s_waitcnt lgkmcnt(4)
    v_mfma_f32_32x32x16_bf16 v[64:79], v[56:59], v[48:51], v[64:79]
    v_mfma_f32_32x32x16_bf16 v[80:95], v[56:59], v[52:55], v[80:95]
    ds_read_b128 v[48:51], v25 offset:0
    ds_read_b128 v[52:55], v25 offset:4096
    ds_read_b64_tr_b16 v[56:57], v26 offset:12288
    ds_read_b64_tr_b16 v[58:59], v26 offset:13312
    s_waitcnt lgkmcnt(4)
    v_mfma_f32_32x32x16_bf16 v[64:79], v[40:43], v[32:35], v[64:79]
    v_mfma_f32_32x32x16_bf16 v[80:95], v[40:43], v[36:39], v[80:95]
    s_waitcnt lgkmcnt(0)
    v_mfma_f32_32x32x16_bf16 v[64:79], v[56:59], v[48:51], v[64:79]
    v_mfma_f32_32x32x16_bf16 v[80:95], v[56:59], v[52:55], v[80:95]
    s_nop 15
    v_lshlrev_b32 v17, 5, v9
    v_lshl_add_u32 v17, v14, 3, v17
    s_mul_i32 s31, s30, 131072
    v_add_u32 v17, s31, v17
    s_lshr_b32 s41, s25, 2
    s_lshl_b32 s41, s41, 21
    s_and_b32 s42, s25, 3
    s_lshl_b32 s42, s42, 19
    s_add_u32 s41, s41, s42
    s_lshl_b32 s42, s26, 5
    s_add_u32 s41, s41, s42
    v_cvt_pk_bf16_f32 v28, v64, v65
    v_cvt_pk_bf16_f32 v29, v66, v67
    s_add_u32 s42, s41, 0
    buffer_store_dwordx2 v[28:29], v17, s[12:15], s42 offen offset:0
    s_nop 1
    v_cvt_pk_bf16_f32 v28, v68, v69
    v_cvt_pk_bf16_f32 v29, v70, v71
    s_add_u32 s42, s41, 0
    buffer_store_dwordx2 v[28:29], v17, s[12:15], s42 offen offset:16
    s_nop 1
    v_cvt_pk_bf16_f32 v28, v72, v73
    v_cvt_pk_bf16_f32 v29, v74, v75
    s_add_u32 s42, s41, 65536
    buffer_store_dwordx2 v[28:29], v17, s[12:15], s42 offen offset:0
    s_nop 1
    v_cvt_pk_bf16_f32 v28, v76, v77
    v_cvt_pk_bf16_f32 v29, v78, v79
    s_add_u32 s42, s41, 65536
    buffer_store_dwordx2 v[28:29], v17, s[12:15], s42 offen offset:16
    s_nop 1
    v_cvt_pk_bf16_f32 v28, v80, v81
    v_cvt_pk_bf16_f32 v29, v82, v83
    s_add_u32 s42, s41, 1024
    buffer_store_dwordx2 v[28:29], v17, s[12:15], s42 offen offset:0
    s_nop 1
    v_cvt_pk_bf16_f32 v28, v84, v85
    v_cvt_pk_bf16_f32 v29, v86, v87
    s_add_u32 s42, s41, 1024
    buffer_store_dwordx2 v[28:29], v17, s[12:15], s42 offen offset:16
    s_nop 1
    v_cvt_pk_bf16_f32 v28, v88, v89
    v_cvt_pk_bf16_f32 v29, v90, v91
    s_add_u32 s42, s41, 66560
    buffer_store_dwordx2 v[28:29], v17, s[12:15], s42 offen offset:0
    s_nop 1
    v_cvt_pk_bf16_f32 v28, v92, v93
    v_cvt_pk_bf16_f32 v29, v94, v95
    s_add_u32 s42, s41, 66560
    buffer_store_dwordx2 v[28:29], v17, s[12:15], s42 offen offset:16
    s_nop 1
    s_branch L_end_1
L_vpath_2:
    s_add_u32 m0, s45, 16384
    s_add_u32 s46, s36, 0
    buffer_load_dwordx4 v4, s[8:11], s46 offen lds
    s_add_u32 m0, s45, 24576
    s_add_u32 s46, s37, 0
    buffer_load_dwordx4 v4, s[8:11], s46 offen lds
    s_add_u32 m0, s45, 49152
    s_add_u32 s46, s36, 196608
    buffer_load_dwordx4 v4, s[8:11], s46 offen lds
    s_add_u32 m0, s45, 57344
    s_add_u32 s46, s37, 196608
    buffer_load_dwordx4 v4, s[8:11], s46 offen lds
    s_add_u32 m0, s45, 81920
    s_add_u32 s46, s36, 393216
    buffer_load_dwordx4 v4, s[8:11], s46 offen lds
    s_add_u32 m0, s45, 90112
    s_add_u32 s46, s37, 393216
    buffer_load_dwordx4 v4, s[8:11], s46 offen lds
    s_add_u32 m0, s45, 114688
    s_add_u32 s46, s36, 589824
    buffer_load_dwordx4 v4, s[8:11], s46 offen lds
    s_add_u32 m0, s45, 122880
    s_add_u32 s46, s37, 589824
    buffer_load_dwordx4 v4, s[8:11], s46 offen lds
    v_lshrrev_b32 v30, 3, v0
    v_and_b32 v31, 7, v0
    v_mul_u32_u24 v5, 1024, v30
    v_lshl_add_u32 v5, v31, 4, v5
    s_mul_i32 s46, s26, 1024
    s_add_u32 s47, s46, 65536
    buffer_load_dwordx4 v[128:131], v5, s[4:7], s46 offen offset:0
    buffer_load_dwordx4 v[132:135], v5, s[4:7], s46 offen offset:128
    buffer_load_dwordx4 v[136:139], v5, s[4:7], s46 offen offset:256
    buffer_load_dwordx4 v[140:143], v5, s[4:7], s46 offen offset:384
    buffer_load_dwordx4 v[144:147], v5, s[4:7], s46 offen offset:512
    buffer_load_dwordx4 v[148:151], v5, s[4:7], s46 offen offset:640
    buffer_load_dwordx4 v[152:155], v5, s[4:7], s46 offen offset:768
    buffer_load_dwordx4 v[156:159], v5, s[4:7], s46 offen offset:896
    buffer_load_dwordx4 v[160:163], v5, s[4:7], s47 offen offset:0
    buffer_load_dwordx4 v[164:167], v5, s[4:7], s47 offen offset:128
    buffer_load_dwordx4 v[168:171], v5, s[4:7], s47 offen offset:256
    buffer_load_dwordx4 v[172:175], v5, s[4:7], s47 offen offset:384
    buffer_load_dwordx4 v[176:179], v5, s[4:7], s47 offen offset:512
    buffer_load_dwordx4 v[180:183], v5, s[4:7], s47 offen offset:640
    buffer_load_dwordx4 v[184:187], v5, s[4:7], s47 offen offset:768
    buffer_load_dwordx4 v[188:191], v5, s[4:7], s47 offen offset:896
    v_bfe_u32 v5, v0, 4, 3
    v_xor_b32 v31, v31, v5
    v_lshlrev_b32 v30, 7, v30
    v_lshl_add_u32 v30, v31, 4, v30
    v_mov_b32 v5, 0x3f803f80
    v_mov_b32 v32, 0
    v_mov_b32 v33, 0
    v_mov_b32 v34, 0
    v_mov_b32 v35, 0
    s_waitcnt vmcnt(15)
    v_dot2_f32_bf16 v32, v128, v5, v32
    v_dot2_f32_bf16 v33, v128, v128, v33
    v_dot2_f32_bf16 v32, v129, v5, v32
    v_dot2_f32_bf16 v33, v129, v129, v33
    v_dot2_f32_bf16 v32, v130, v5, v32
    v_dot2_f32_bf16 v33, v130, v130, v33
    v_dot2_f32_bf16 v32, v131, v5, v32
    v_dot2_f32_bf16 v33, v131, v131, v33
    s_waitcnt vmcnt(14)
    v_dot2_f32_bf16 v32, v132, v5, v32
    v_dot2_f32_bf16 v33, v132, v132, v33
    v_dot2_f32_bf16 v32, v133, v5, v32
    v_dot2_f32_bf16 v33, v133, v133, v33
    v_dot2_f32_bf16 v32, v134, v5, v32
    v_dot2_f32_bf16 v33, v134, v134, v33
    v_dot2_f32_bf16 v32, v135, v5, v32
    v_dot2_f32_bf16 v33, v135, v135, v33
    s_waitcnt vmcnt(13)
    v_dot2_f32_bf16 v32, v136, v5, v32
    v_dot2_f32_bf16 v33, v136, v136, v33
    v_dot2_f32_bf16 v32, v137, v5, v32
    v_dot2_f32_bf16 v33, v137, v137, v33
    v_dot2_f32_bf16 v32, v138, v5, v32
    v_dot2_f32_bf16 v33, v138, v138, v33
    v_dot2_f32_bf16 v32, v139, v5, v32
    v_dot2_f32_bf16 v33, v139, v139, v33
    s_waitcnt vmcnt(12)
    v_dot2_f32_bf16 v32, v140, v5, v32
    v_dot2_f32_bf16 v33, v140, v140, v33
    v_dot2_f32_bf16 v32, v141, v5, v32
    v_dot2_f32_bf16 v33, v141, v141, v33
    v_dot2_f32_bf16 v32, v142, v5, v32
    v_dot2_f32_bf16 v33, v142, v142, v33
    v_dot2_f32_bf16 v32, v143, v5, v32
    v_dot2_f32_bf16 v33, v143, v143, v33
    s_waitcnt vmcnt(11)
    v_dot2_f32_bf16 v32, v144, v5, v32
    v_dot2_f32_bf16 v33, v144, v144, v33
    v_dot2_f32_bf16 v32, v145, v5, v32
    v_dot2_f32_bf16 v33, v145, v145, v33
    v_dot2_f32_bf16 v32, v146, v5, v32
    v_dot2_f32_bf16 v33, v146, v146, v33
    v_dot2_f32_bf16 v32, v147, v5, v32
    v_dot2_f32_bf16 v33, v147, v147, v33
    s_waitcnt vmcnt(10)
    v_dot2_f32_bf16 v32, v148, v5, v32
    v_dot2_f32_bf16 v33, v148, v148, v33
    v_dot2_f32_bf16 v32, v149, v5, v32
    v_dot2_f32_bf16 v33, v149, v149, v33
    v_dot2_f32_bf16 v32, v150, v5, v32
    v_dot2_f32_bf16 v33, v150, v150, v33
    v_dot2_f32_bf16 v32, v151, v5, v32
    v_dot2_f32_bf16 v33, v151, v151, v33
    s_waitcnt vmcnt(9)
    v_dot2_f32_bf16 v32, v152, v5, v32
    v_dot2_f32_bf16 v33, v152, v152, v33
    v_dot2_f32_bf16 v32, v153, v5, v32
    v_dot2_f32_bf16 v33, v153, v153, v33
    v_dot2_f32_bf16 v32, v154, v5, v32
    v_dot2_f32_bf16 v33, v154, v154, v33
    v_dot2_f32_bf16 v32, v155, v5, v32
    v_dot2_f32_bf16 v33, v155, v155, v33
    s_waitcnt vmcnt(8)
    v_dot2_f32_bf16 v32, v156, v5, v32
    v_dot2_f32_bf16 v33, v156, v156, v33
    v_dot2_f32_bf16 v32, v157, v5, v32
    v_dot2_f32_bf16 v33, v157, v157, v33
    v_dot2_f32_bf16 v32, v158, v5, v32
    v_dot2_f32_bf16 v33, v158, v158, v33
    v_dot2_f32_bf16 v32, v159, v5, v32
    v_dot2_f32_bf16 v33, v159, v159, v33
    s_waitcnt vmcnt(7)
    v_dot2_f32_bf16 v34, v160, v5, v34
    v_dot2_f32_bf16 v35, v160, v160, v35
    v_dot2_f32_bf16 v34, v161, v5, v34
    v_dot2_f32_bf16 v35, v161, v161, v35
    v_dot2_f32_bf16 v34, v162, v5, v34
    v_dot2_f32_bf16 v35, v162, v162, v35
    v_dot2_f32_bf16 v34, v163, v5, v34
    v_dot2_f32_bf16 v35, v163, v163, v35
    s_waitcnt vmcnt(6)
    v_dot2_f32_bf16 v34, v164, v5, v34
    v_dot2_f32_bf16 v35, v164, v164, v35
    v_dot2_f32_bf16 v34, v165, v5, v34
    v_dot2_f32_bf16 v35, v165, v165, v35
    v_dot2_f32_bf16 v34, v166, v5, v34
    v_dot2_f32_bf16 v35, v166, v166, v35
    v_dot2_f32_bf16 v34, v167, v5, v34
    v_dot2_f32_bf16 v35, v167, v167, v35
    s_waitcnt vmcnt(5)
    v_dot2_f32_bf16 v34, v168, v5, v34
    v_dot2_f32_bf16 v35, v168, v168, v35
    v_dot2_f32_bf16 v34, v169, v5, v34
    v_dot2_f32_bf16 v35, v169, v169, v35
    v_dot2_f32_bf16 v34, v170, v5, v34
    v_dot2_f32_bf16 v35, v170, v170, v35
    v_dot2_f32_bf16 v34, v171, v5, v34
    v_dot2_f32_bf16 v35, v171, v171, v35
    s_waitcnt vmcnt(4)
    v_dot2_f32_bf16 v34, v172, v5, v34
    v_dot2_f32_bf16 v35, v172, v172, v35
    v_dot2_f32_bf16 v34, v173, v5, v34
    v_dot2_f32_bf16 v35, v173, v173, v35
    v_dot2_f32_bf16 v34, v174, v5, v34
    v_dot2_f32_bf16 v35, v174, v174, v35
    v_dot2_f32_bf16 v34, v175, v5, v34
    v_dot2_f32_bf16 v35, v175, v175, v35
    s_waitcnt vmcnt(3)
    v_dot2_f32_bf16 v34, v176, v5, v34
    v_dot2_f32_bf16 v35, v176, v176, v35
    v_dot2_f32_bf16 v34, v177, v5, v34
    v_dot2_f32_bf16 v35, v177, v177, v35
    v_dot2_f32_bf16 v34, v178, v5, v34
    v_dot2_f32_bf16 v35, v178, v178, v35
    v_dot2_f32_bf16 v34, v179, v5, v34
    v_dot2_f32_bf16 v35, v179, v179, v35
    s_waitcnt vmcnt(2)
    v_dot2_f32_bf16 v34, v180, v5, v34
    v_dot2_f32_bf16 v35, v180, v180, v35
    v_dot2_f32_bf16 v34, v181, v5, v34
    v_dot2_f32_bf16 v35, v181, v181, v35
    v_dot2_f32_bf16 v34, v182, v5, v34
    v_dot2_f32_bf16 v35, v182, v182, v35
    v_dot2_f32_bf16 v34, v183, v5, v34
    v_dot2_f32_bf16 v35, v183, v183, v35
    s_waitcnt vmcnt(1)
    v_dot2_f32_bf16 v34, v184, v5, v34
    v_dot2_f32_bf16 v35, v184, v184, v35
    v_dot2_f32_bf16 v34, v185, v5, v34
    v_dot2_f32_bf16 v35, v185, v185, v35
    v_dot2_f32_bf16 v34, v186, v5, v34
    v_dot2_f32_bf16 v35, v186, v186, v35
    v_dot2_f32_bf16 v34, v187, v5, v34
    v_dot2_f32_bf16 v35, v187, v187, v35
    s_waitcnt vmcnt(0)
    v_dot2_f32_bf16 v34, v188, v5, v34
    v_dot2_f32_bf16 v35, v188, v188, v35
    v_dot2_f32_bf16 v34, v189, v5, v34
    v_dot2_f32_bf16 v35, v189, v189, v35
    v_dot2_f32_bf16 v34, v190, v5, v34
    v_dot2_f32_bf16 v35, v190, v190, v35
    v_dot2_f32_bf16 v34, v191, v5, v34
    v_dot2_f32_bf16 v35, v191, v191, v35
    s_nop 3
    v_add_f32_dpp v32, v32, v32 quad_perm:[1,0,3,2] row_mask:0xf bank_mask:0xf
    v_add_f32_dpp v33, v33, v33 quad_perm:[1,0,3,2] row_mask:0xf bank_mask:0xf
    v_add_f32_dpp v34, v34, v34 quad_perm:[1,0,3,2] row_mask:0xf bank_mask:0xf
    v_add_f32_dpp v35, v35, v35 quad_perm:[1,0,3,2] row_mask:0xf bank_mask:0xf
    s_nop 1
    v_add_f32_dpp v32, v32, v32 quad_perm:[2,3,0,1] row_mask:0xf bank_mask:0xf
    v_add_f32_dpp v33, v33, v33 quad_perm:[2,3,0,1] row_mask:0xf bank_mask:0xf
    v_add_f32_dpp v34, v34, v34 quad_perm:[2,3,0,1] row_mask:0xf bank_mask:0xf
    v_add_f32_dpp v35, v35, v35 quad_perm:[2,3,0,1] row_mask:0xf bank_mask:0xf
    s_nop 1
    v_add_f32_dpp v32, v32, v32 row_half_mirror row_mask:0xf bank_mask:0xf
    v_add_f32_dpp v33, v33, v33 row_half_mirror row_mask:0xf bank_mask:0xf
    v_add_f32_dpp v34, v34, v34 row_half_mirror row_mask:0xf bank_mask:0xf
    v_add_f32_dpp v35, v35, v35 row_half_mirror row_mask:0xf bank_mask:0xf
    s_nop 1
    v_mul_f32 v32, 0x3b000000, v32
    v_mul_f32 v33, 0x3b000000, v33
    v_fma_f32 v33, -v32, v32, v33
    v_max_f32 v33, 0, v33
    v_cvt_pk_bf16_f32 v36, v32, v33
    v_lshlrev_b32 v32, 16, v36
    v_and_b32 v33, 0xffff0000, v36
    v_add_f32 v33, 0x3727c5ac, v33
    v_cvt_pk_bf16_f32 v36, v33, v33
    v_lshlrev_b32 v33, 16, v36
    v_sqrt_f32 v33, v33
    s_nop 0
    v_cvt_pk_bf16_f32 v36, v33, v33
    v_lshlrev_b32 v33, 16, v36
    v_rcp_f32 v33, v33
    s_nop 0
    v_mov_b32 v120, v32
    v_mov_b32 v121, v33
    v_mul_f32 v34, 0x3b000000, v34
    v_mul_f32 v35, 0x3b000000, v35
    v_fma_f32 v35, -v34, v34, v35
    v_max_f32 v35, 0, v35
    v_cvt_pk_bf16_f32 v36, v34, v35
    v_lshlrev_b32 v34, 16, v36
    v_and_b32 v35, 0xffff0000, v36
    v_add_f32 v35, 0x3727c5ac, v35
    v_cvt_pk_bf16_f32 v36, v35, v35
    v_lshlrev_b32 v35, 16, v36
    v_sqrt_f32 v35, v35
    s_nop 0
    v_cvt_pk_bf16_f32 v36, v35, v35
    v_lshlrev_b32 v35, 16, v36
    v_rcp_f32 v35, v35
    s_nop 0
    v_mov_b32 v122, v34
    v_mov_b32 v123, v35
    v_lshlrev_b32 v124, 16, v128
    v_and_b32 v125, 0xffff0000, v128
    v_sub_f32 v124, v124, v120
    v_sub_f32 v125, v125, v120
    v_cvt_pk_bf16_f32 v128, v124, v125
    v_lshlrev_b32 v124, 16, v128
    v_and_b32 v125, 0xffff0000, v128
    v_mul_f32 v124, v124, v121
    v_mul_f32 v125, v125, v121
    v_cvt_pk_bf16_f32 v128, v124, v125
    v_lshlrev_b32 v124, 16, v129
    v_and_b32 v125, 0xffff0000, v129
    v_sub_f32 v124, v124, v120
    v_sub_f32 v125, v125, v120
    v_cvt_pk_bf16_f32 v129, v124, v125
    v_lshlrev_b32 v124, 16, v129
    v_and_b32 v125, 0xffff0000, v129
    v_mul_f32 v124, v124, v121
    v_mul_f32 v125, v125, v121
    v_cvt_pk_bf16_f32 v129, v124, v125
    v_lshlrev_b32 v124, 16, v130
    v_and_b32 v125, 0xffff0000, v130
    v_sub_f32 v124, v124, v120
    v_sub_f32 v125, v125, v120
    v_cvt_pk_bf16_f32 v130, v124, v125
    v_lshlrev_b32 v124, 16, v130
    v_and_b32 v125, 0xffff0000, v130
    v_mul_f32 v124, v124, v121
    v_mul_f32 v125, v125, v121
    v_cvt_pk_bf16_f32 v130, v124, v125
    v_lshlrev_b32 v124, 16, v131
    v_and_b32 v125, 0xffff0000, v131
    v_sub_f32 v124, v124, v120
    v_sub_f32 v125, v125, v120
    v_cvt_pk_bf16_f32 v131, v124, v125
    v_lshlrev_b32 v124, 16, v131
    v_and_b32 v125, 0xffff0000, v131
    v_mul_f32 v124, v124, v121
    v_mul_f32 v125, v125, v121
    v_cvt_pk_bf16_f32 v131, v124, v125
    v_add_u32 v31, 0, v30
    ds_write_b128 v31, v[128:131]
    v_lshlrev_b32 v124, 16, v160
    v_and_b32 v125, 0xffff0000, v160
    v_sub_f32 v124, v124, v122
    v_sub_f32 v125, v125, v122
    v_cvt_pk_bf16_f32 v160, v124, v125
    v_lshlrev_b32 v124, 16, v160
    v_and_b32 v125, 0xffff0000, v160
    v_mul_f32 v124, v124, v123
    v_mul_f32 v125, v125, v123
    v_cvt_pk_bf16_f32 v160, v124, v125
    v_lshlrev_b32 v124, 16, v161
    v_and_b32 v125, 0xffff0000, v161
    v_sub_f32 v124, v124, v122
    v_sub_f32 v125, v125, v122
    v_cvt_pk_bf16_f32 v161, v124, v125
    v_lshlrev_b32 v124, 16, v161
    v_and_b32 v125, 0xffff0000, v161
    v_mul_f32 v124, v124, v123
    v_mul_f32 v125, v125, v123
    v_cvt_pk_bf16_f32 v161, v124, v125
    v_lshlrev_b32 v124, 16, v162
    v_and_b32 v125, 0xffff0000, v162
    v_sub_f32 v124, v124, v122
    v_sub_f32 v125, v125, v122
    v_cvt_pk_bf16_f32 v162, v124, v125
    v_lshlrev_b32 v124, 16, v162
    v_and_b32 v125, 0xffff0000, v162
    v_mul_f32 v124, v124, v123
    v_mul_f32 v125, v125, v123
    v_cvt_pk_bf16_f32 v162, v124, v125
    v_lshlrev_b32 v124, 16, v163
    v_and_b32 v125, 0xffff0000, v163
    v_sub_f32 v124, v124, v122
    v_sub_f32 v125, v125, v122
    v_cvt_pk_bf16_f32 v163, v124, v125
    v_lshlrev_b32 v124, 16, v163
    v_and_b32 v125, 0xffff0000, v163
    v_mul_f32 v124, v124, v123
    v_mul_f32 v125, v125, v123
    v_cvt_pk_bf16_f32 v163, v124, v125
    v_add_u32 v31, 8192, v30
    ds_write_b128 v31, v[160:163]
    v_lshlrev_b32 v124, 16, v132
    v_and_b32 v125, 0xffff0000, v132
    v_sub_f32 v124, v124, v120
    v_sub_f32 v125, v125, v120
    v_cvt_pk_bf16_f32 v132, v124, v125
    v_lshlrev_b32 v124, 16, v132
    v_and_b32 v125, 0xffff0000, v132
    v_mul_f32 v124, v124, v121
    v_mul_f32 v125, v125, v121
    v_cvt_pk_bf16_f32 v132, v124, v125
    v_lshlrev_b32 v124, 16, v133
    v_and_b32 v125, 0xffff0000, v133
    v_sub_f32 v124, v124, v120
    v_sub_f32 v125, v125, v120
    v_cvt_pk_bf16_f32 v133, v124, v125
    v_lshlrev_b32 v124, 16, v133
    v_and_b32 v125, 0xffff0000, v133
    v_mul_f32 v124, v124, v121
    v_mul_f32 v125, v125, v121
    v_cvt_pk_bf16_f32 v133, v124, v125
    v_lshlrev_b32 v124, 16, v134
    v_and_b32 v125, 0xffff0000, v134
    v_sub_f32 v124, v124, v120
    v_sub_f32 v125, v125, v120
    v_cvt_pk_bf16_f32 v134, v124, v125
    v_lshlrev_b32 v124, 16, v134
    v_and_b32 v125, 0xffff0000, v134
    v_mul_f32 v124, v124, v121
    v_mul_f32 v125, v125, v121
    v_cvt_pk_bf16_f32 v134, v124, v125
    v_lshlrev_b32 v124, 16, v135
    v_and_b32 v125, 0xffff0000, v135
    v_sub_f32 v124, v124, v120
    v_sub_f32 v125, v125, v120
    v_cvt_pk_bf16_f32 v135, v124, v125
    v_lshlrev_b32 v124, 16, v135
    v_and_b32 v125, 0xffff0000, v135
    v_mul_f32 v124, v124, v121
    v_mul_f32 v125, v125, v121
    v_cvt_pk_bf16_f32 v135, v124, v125
    v_add_u32 v31, 32768, v30
    ds_write_b128 v31, v[132:135]
    v_lshlrev_b32 v124, 16, v164
    v_and_b32 v125, 0xffff0000, v164
    v_sub_f32 v124, v124, v122
    v_sub_f32 v125, v125, v122
    v_cvt_pk_bf16_f32 v164, v124, v125
    v_lshlrev_b32 v124, 16, v164
    v_and_b32 v125, 0xffff0000, v164
    v_mul_f32 v124, v124, v123
    v_mul_f32 v125, v125, v123
    v_cvt_pk_bf16_f32 v164, v124, v125
    v_lshlrev_b32 v124, 16, v165
    v_and_b32 v125, 0xffff0000, v165
    v_sub_f32 v124, v124, v122
    v_sub_f32 v125, v125, v122
    v_cvt_pk_bf16_f32 v165, v124, v125
    v_lshlrev_b32 v124, 16, v165
    v_and_b32 v125, 0xffff0000, v165
    v_mul_f32 v124, v124, v123
    v_mul_f32 v125, v125, v123
    v_cvt_pk_bf16_f32 v165, v124, v125
    v_lshlrev_b32 v124, 16, v166
    v_and_b32 v125, 0xffff0000, v166
    v_sub_f32 v124, v124, v122
    v_sub_f32 v125, v125, v122
    v_cvt_pk_bf16_f32 v166, v124, v125
    v_lshlrev_b32 v124, 16, v166
    v_and_b32 v125, 0xffff0000, v166
    v_mul_f32 v124, v124, v123
    v_mul_f32 v125, v125, v123
    v_cvt_pk_bf16_f32 v166, v124, v125
    v_lshlrev_b32 v124, 16, v167
    v_and_b32 v125, 0xffff0000, v167
    v_sub_f32 v124, v124, v122
    v_sub_f32 v125, v125, v122
    v_cvt_pk_bf16_f32 v167, v124, v125
    v_lshlrev_b32 v124, 16, v167
    v_and_b32 v125, 0xffff0000, v167
    v_mul_f32 v124, v124, v123
    v_mul_f32 v125, v125, v123
    v_cvt_pk_bf16_f32 v167, v124, v125
    v_add_u32 v31, 40960, v30
    ds_write_b128 v31, v[164:167]
    v_lshlrev_b32 v124, 16, v136
    v_and_b32 v125, 0xffff0000, v136
    v_sub_f32 v124, v124, v120
    v_sub_f32 v125, v125, v120
    v_cvt_pk_bf16_f32 v136, v124, v125
    v_lshlrev_b32 v124, 16, v136
    v_and_b32 v125, 0xffff0000, v136
    v_mul_f32 v124, v124, v121
    v_mul_f32 v125, v125, v121
    v_cvt_pk_bf16_f32 v136, v124, v125
    v_lshlrev_b32 v124, 16, v137
    v_and_b32 v125, 0xffff0000, v137
    v_sub_f32 v124, v124, v120
    v_sub_f32 v125, v125, v120
    v_cvt_pk_bf16_f32 v137, v124, v125
    v_lshlrev_b32 v124, 16, v137
    v_and_b32 v125, 0xffff0000, v137
    v_mul_f32 v124, v124, v121
    v_mul_f32 v125, v125, v121
    v_cvt_pk_bf16_f32 v137, v124, v125
    v_lshlrev_b32 v124, 16, v138
    v_and_b32 v125, 0xffff0000, v138
    v_sub_f32 v124, v124, v120
    v_sub_f32 v125, v125, v120
    v_cvt_pk_bf16_f32 v138, v124, v125
    v_lshlrev_b32 v124, 16, v138
    v_and_b32 v125, 0xffff0000, v138
    v_mul_f32 v124, v124, v121
    v_mul_f32 v125, v125, v121
    v_cvt_pk_bf16_f32 v138, v124, v125
    v_lshlrev_b32 v124, 16, v139
    v_and_b32 v125, 0xffff0000, v139
    v_sub_f32 v124, v124, v120
    v_sub_f32 v125, v125, v120
    v_cvt_pk_bf16_f32 v139, v124, v125
    v_lshlrev_b32 v124, 16, v139
    v_and_b32 v125, 0xffff0000, v139
    v_mul_f32 v124, v124, v121
    v_mul_f32 v125, v125, v121
    v_cvt_pk_bf16_f32 v139, v124, v125
    v_add_u32 v31, 65536, v30
    ds_write_b128 v31, v[136:139]
    v_lshlrev_b32 v124, 16, v168
    v_and_b32 v125, 0xffff0000, v168
    v_sub_f32 v124, v124, v122
    v_sub_f32 v125, v125, v122
    v_cvt_pk_bf16_f32 v168, v124, v125
    v_lshlrev_b32 v124, 16, v168
    v_and_b32 v125, 0xffff0000, v168
    v_mul_f32 v124, v124, v123
    v_mul_f32 v125, v125, v123
    v_cvt_pk_bf16_f32 v168, v124, v125
    v_lshlrev_b32 v124, 16, v169
    v_and_b32 v125, 0xffff0000, v169
    v_sub_f32 v124, v124, v122
    v_sub_f32 v125, v125, v122
    v_cvt_pk_bf16_f32 v169, v124, v125
    v_lshlrev_b32 v124, 16, v169
    v_and_b32 v125, 0xffff0000, v169
    v_mul_f32 v124, v124, v123
    v_mul_f32 v125, v125, v123
    v_cvt_pk_bf16_f32 v169, v124, v125
    v_lshlrev_b32 v124, 16, v170
    v_and_b32 v125, 0xffff0000, v170
    v_sub_f32 v124, v124, v122
    v_sub_f32 v125, v125, v122
    v_cvt_pk_bf16_f32 v170, v124, v125
    v_lshlrev_b32 v124, 16, v170
    v_and_b32 v125, 0xffff0000, v170
    v_mul_f32 v124, v124, v123
    v_mul_f32 v125, v125, v123
    v_cvt_pk_bf16_f32 v170, v124, v125
    v_lshlrev_b32 v124, 16, v171
    v_and_b32 v125, 0xffff0000, v171
    v_sub_f32 v124, v124, v122
    v_sub_f32 v125, v125, v122
    v_cvt_pk_bf16_f32 v171, v124, v125
    v_lshlrev_b32 v124, 16, v171
    v_and_b32 v125, 0xffff0000, v171
    v_mul_f32 v124, v124, v123
    v_mul_f32 v125, v125, v123
    v_cvt_pk_bf16_f32 v171, v124, v125
    v_add_u32 v31, 73728, v30
    ds_write_b128 v31, v[168:171]
    v_lshlrev_b32 v124, 16, v140
    v_and_b32 v125, 0xffff0000, v140
    v_sub_f32 v124, v124, v120
    v_sub_f32 v125, v125, v120
    v_cvt_pk_bf16_f32 v140, v124, v125
    v_lshlrev_b32 v124, 16, v140
    v_and_b32 v125, 0xffff0000, v140
    v_mul_f32 v124, v124, v121
    v_mul_f32 v125, v125, v121
    v_cvt_pk_bf16_f32 v140, v124, v125
    v_lshlrev_b32 v124, 16, v141
    v_and_b32 v125, 0xffff0000, v141
    v_sub_f32 v124, v124, v120
    v_sub_f32 v125, v125, v120
    v_cvt_pk_bf16_f32 v141, v124, v125
    v_lshlrev_b32 v124, 16, v141
    v_and_b32 v125, 0xffff0000, v141
    v_mul_f32 v124, v124, v121
    v_mul_f32 v125, v125, v121
    v_cvt_pk_bf16_f32 v141, v124, v125
    v_lshlrev_b32 v124, 16, v142
    v_and_b32 v125, 0xffff0000, v142
    v_sub_f32 v124, v124, v120
    v_sub_f32 v125, v125, v120
    v_cvt_pk_bf16_f32 v142, v124, v125
    v_lshlrev_b32 v124, 16, v142
    v_and_b32 v125, 0xffff0000, v142
    v_mul_f32 v124, v124, v121
    v_mul_f32 v125, v125, v121
    v_cvt_pk_bf16_f32 v142, v124, v125
    v_lshlrev_b32 v124, 16, v143
    v_and_b32 v125, 0xffff0000, v143
    v_sub_f32 v124, v124, v120
    v_sub_f32 v125, v125, v120
    v_cvt_pk_bf16_f32 v143, v124, v125
    v_lshlrev_b32 v124, 16, v143
    v_and_b32 v125, 0xffff0000, v143
    v_mul_f32 v124, v124, v121
    v_mul_f32 v125, v125, v121
    v_cvt_pk_bf16_f32 v143, v124, v125
    v_add_u32 v31, 98304, v30
    ds_write_b128 v31, v[140:143]
    v_lshlrev_b32 v124, 16, v172
    v_and_b32 v125, 0xffff0000, v172
    v_sub_f32 v124, v124, v122
    v_sub_f32 v125, v125, v122
    v_cvt_pk_bf16_f32 v172, v124, v125
    v_lshlrev_b32 v124, 16, v172
    v_and_b32 v125, 0xffff0000, v172
    v_mul_f32 v124, v124, v123
    v_mul_f32 v125, v125, v123
    v_cvt_pk_bf16_f32 v172, v124, v125
    v_lshlrev_b32 v124, 16, v173
    v_and_b32 v125, 0xffff0000, v173
    v_sub_f32 v124, v124, v122
    v_sub_f32 v125, v125, v122
    v_cvt_pk_bf16_f32 v173, v124, v125
    v_lshlrev_b32 v124, 16, v173
    v_and_b32 v125, 0xffff0000, v173
    v_mul_f32 v124, v124, v123
    v_mul_f32 v125, v125, v123
    v_cvt_pk_bf16_f32 v173, v124, v125
    v_lshlrev_b32 v124, 16, v174
    v_and_b32 v125, 0xffff0000, v174
    v_sub_f32 v124, v124, v122
    v_sub_f32 v125, v125, v122
    v_cvt_pk_bf16_f32 v174, v124, v125
    v_lshlrev_b32 v124, 16, v174
    v_and_b32 v125, 0xffff0000, v174
    v_mul_f32 v124, v124, v123
    v_mul_f32 v125, v125, v123
    v_cvt_pk_bf16_f32 v174, v124, v125
    v_lshlrev_b32 v124, 16, v175
    v_and_b32 v125, 0xffff0000, v175
    v_sub_f32 v124, v124, v122
    v_sub_f32 v125, v125, v122
    v_cvt_pk_bf16_f32 v175, v124, v125
    v_lshlrev_b32 v124, 16, v175
    v_and_b32 v125, 0xffff0000, v175
    v_mul_f32 v124, v124, v123
    v_mul_f32 v125, v125, v123
    v_cvt_pk_bf16_f32 v175, v124, v125
    v_add_u32 v31, 106496, v30
    ds_write_b128 v31, v[172:175]
    s_waitcnt vmcnt(6) lgkmcnt(0)
    s_barrier
    v_add_u32 v22, 0, v10
    v_add_u32 v23, 0, v11
    v_add_u32 v24, 0, v12
    v_add_u32 v25, 0, v13
    v_add_u32 v26, 0, v20
    ds_read_b128 v[32:35], v22 offset:0
    ds_read_b128 v[36:39], v22 offset:4096
    ds_read_b64_tr_b16 v[40:41], v26 offset:0
    ds_read_b64_tr_b16 v[42:43], v26 offset:1024
    ds_read_b128 v[48:51], v23 offset:0
    ds_read_b128 v[52:55], v23 offset:4096
    ds_read_b64_tr_b16 v[56:57], v26 offset:4096
    ds_read_b64_tr_b16 v[58:59], v26 offset:5120
    s_waitcnt lgkmcnt(4)
    v_mfma_f32_32x32x16_bf16 v[64:79], v[32:35], v[40:43], v[64:79]
    v_lshlrev_b32 v124, 16, v144
    v_and_b32 v125, 0xffff0000, v144
    v_sub_f32 v124, v124, v120
    v_sub_f32 v125, v125, v120
    v_cvt_pk_bf16_f32 v144, v124, v125
    v_lshlrev_b32 v124, 16, v144
    v_and_b32 v125, 0xffff0000, v144
    v_mul_f32 v124, v124, v121
    v_mul_f32 v125, v125, v121
    v_cvt_pk_bf16_f32 v144, v124, v125
    v_lshlrev_b32 v124, 16, v145
    v_and_b32 v125, 0xffff0000, v145
    v_sub_f32 v124, v124, v120
    v_sub_f32 v125, v125, v120
    v_cvt_pk_bf16_f32 v145, v124, v125
    v_lshlrev_b32 v124, 16, v145
    v_and_b32 v125, 0xffff0000, v145
    v_mul_f32 v124, v124, v121
    v_mul_f32 v125, v125, v121
    v_cvt_pk_bf16_f32 v145, v124, v125
    v_lshlrev_b32 v124, 16, v146
    v_and_b32 v125, 0xffff0000, v146
    v_sub_f32 v124, v124, v120
    v_sub_f32 v125, v125, v120
    v_cvt_pk_bf16_f32 v146, v124, v125
    v_lshlrev_b32 v124, 16, v146
    v_and_b32 v125, 0xffff0000, v146
    v_mul_f32 v124, v124, v121
    v_mul_f32 v125, v125, v121
    v_cvt_pk_bf16_f32 v146, v124, v125
    v_lshlrev_b32 v124, 16, v147
    v_and_b32 v125, 0xffff0000, v147
    v_sub_f32 v124, v124, v120
    v_sub_f32 v125, v125, v120
    v_cvt_pk_bf16_f32 v147, v124, v125
    v_lshlrev_b32 v124, 16, v147
    v_and_b32 v125, 0xffff0000, v147
    v_mul_f32 v124, v124, v121
    v_mul_f32 v125, v125, v121
    v_cvt_pk_bf16_f32 v147, v124, v125
    v_add_u32 v31, 131072, v30
    ds_write_b128 v31, v[144:147]
    v_mfma_f32_32x32x16_bf16 v[80:95], v[36:39], v[40:43], v[80:95]
    v_lshlrev_b32 v124, 16, v176
    v_and_b32 v125, 0xffff0000, v176
    v_sub_f32 v124, v124, v122
    v_sub_f32 v125, v125, v122
    v_cvt_pk_bf16_f32 v176, v124, v125
    v_lshlrev_b32 v124, 16, v176
    v_and_b32 v125, 0xffff0000, v176
    v_mul_f32 v124, v124, v123
    v_mul_f32 v125, v125, v123
    v_cvt_pk_bf16_f32 v176, v124, v125
    v_lshlrev_b32 v124, 16, v177
    v_and_b32 v125, 0xffff0000, v177
    v_sub_f32 v124, v124, v122
    v_sub_f32 v125, v125, v122
    v_cvt_pk_bf16_f32 v177, v124, v125
    v_lshlrev_b32 v124, 16, v177
    v_and_b32 v125, 0xffff0000, v177
    v_mul_f32 v124, v124, v123
    v_mul_f32 v125, v125, v123
    v_cvt_pk_bf16_f32 v177, v124, v125
    v_lshlrev_b32 v124, 16, v178
    v_and_b32 v125, 0xffff0000, v178
    v_sub_f32 v124, v124, v122
    v_sub_f32 v125, v125, v122
    v_cvt_pk_bf16_f32 v178, v124, v125
    v_lshlrev_b32 v124, 16, v178
    v_and_b32 v125, 0xffff0000, v178
    v_mul_f32 v124, v124, v123
    v_mul_f32 v125, v125, v123
    v_cvt_pk_bf16_f32 v178, v124, v125
    v_lshlrev_b32 v124, 16, v179
    v_and_b32 v125, 0xffff0000, v179
    v_sub_f32 v124, v124, v122
    v_sub_f32 v125, v125, v122
    v_cvt_pk_bf16_f32 v179, v124, v125
    v_lshlrev_b32 v124, 16, v179
    v_and_b32 v125, 0xffff0000, v179
    v_mul_f32 v124, v124, v123
    v_mul_f32 v125, v125, v123
    v_cvt_pk_bf16_f32 v179, v124, v125
    v_add_u32 v31, 139264, v30
    ds_write_b128 v31, v[176:179]
    ds_read_b128 v[32:35], v24 offset:0
    ds_read_b128 v[36:39], v24 offset:4096
    ds_read_b64_tr_b16 v[40:41], v26 offset:8192
    ds_read_b64_tr_b16 v[42:43], v26 offset:9216
    s_waitcnt lgkmcnt(4)
    v_mfma_f32_32x32x16_bf16 v[64:79], v[48:51], v[56:59], v[64:79]
    s_add_u32 m0, s45, 147456
    s_add_u32 s46, s36, 786432
    buffer_load_dwordx4 v4, s[8:11], s46 offen lds
    v_mfma_f32_32x32x16_bf16 v[80:95], v[52:55], v[56:59], v[80:95]
    s_add_u32 m0, s45, 155648
    s_add_u32 s46, s37, 786432
    buffer_load_dwordx4 v4, s[8:11], s46 offen lds
    ds_read_b128 v[48:51], v25 offset:0
    ds_read_b128 v[52:55], v25 offset:4096
    ds_read_b64_tr_b16 v[56:57], v26 offset:12288
    ds_read_b64_tr_b16 v[58:59], v26 offset:13312
    s_waitcnt lgkmcnt(4)
    v_mfma_f32_32x32x16_bf16 v[64:79], v[32:35], v[40:43], v[64:79]
    v_mfma_f32_32x32x16_bf16 v[80:95], v[36:39], v[40:43], v[80:95]
    s_waitcnt lgkmcnt(0)
    v_mfma_f32_32x32x16_bf16 v[64:79], v[48:51], v[56:59], v[64:79]
    v_mfma_f32_32x32x16_bf16 v[80:95], v[52:55], v[56:59], v[80:95]
    s_waitcnt vmcnt(6) lgkmcnt(0)
    s_barrier
    v_add_u32 v22, 32768, v10
    v_add_u32 v23, 32768, v11
    v_add_u32 v24, 32768, v12
    v_add_u32 v25, 32768, v13
    v_add_u32 v26, 32768, v20
    ds_read_b128 v[32:35], v22 offset:0
    ds_read_b128 v[36:39], v22 offset:4096
    ds_read_b64_tr_b16 v[40:41], v26 offset:0
    ds_read_b64_tr_b16 v[42:43], v26 offset:1024
    ds_read_b128 v[48:51], v23 offset:0
    ds_read_b128 v[52:55], v23 offset:4096
    ds_read_b64_tr_b16 v[56:57], v26 offset:4096
    ds_read_b64_tr_b16 v[58:59], v26 offset:5120
    s_waitcnt lgkmcnt(4)
    v_mfma_f32_32x32x16_bf16 v[64:79], v[32:35], v[40:43], v[64:79]
    v_lshlrev_b32 v124, 16, v148
    v_and_b32 v125, 0xffff0000, v148
    v_sub_f32 v124, v124, v120
    v_sub_f32 v125, v125, v120
    v_cvt_pk_bf16_f32 v148, v124, v125
    v_lshlrev_b32 v124, 16, v148
    v_and_b32 v125, 0xffff0000, v148
    v_mul_f32 v124, v124, v121
    v_mul_f32 v125, v125, v121
    v_cvt_pk_bf16_f32 v148, v124, v125
    v_lshlrev_b32 v124, 16, v149
    v_and_b32 v125, 0xffff0000, v149
    v_sub_f32 v124, v124, v120
    v_sub_f32 v125, v125, v120
    v_cvt_pk_bf16_f32 v149, v124, v125
    v_lshlrev_b32 v124, 16, v149
    v_and_b32 v125, 0xffff0000, v149
    v_mul_f32 v124, v124, v121
    v_mul_f32 v125, v125, v121
    v_cvt_pk_bf16_f32 v149, v124, v125
    v_lshlrev_b32 v124, 16, v150
    v_and_b32 v125, 0xffff0000, v150
    v_sub_f32 v124, v124, v120
    v_sub_f32 v125, v125, v120
    v_cvt_pk_bf16_f32 v150, v124, v125
    v_lshlrev_b32 v124, 16, v150
    v_and_b32 v125, 0xffff0000, v150
    v_mul_f32 v124, v124, v121
    v_mul_f32 v125, v125, v121
    v_cvt_pk_bf16_f32 v150, v124, v125
    v_lshlrev_b32 v124, 16, v151
    v_and_b32 v125, 0xffff0000, v151
    v_sub_f32 v124, v124, v120
    v_sub_f32 v125, v125, v120
    v_cvt_pk_bf16_f32 v151, v124, v125
    v_lshlrev_b32 v124, 16, v151
    v_and_b32 v125, 0xffff0000, v151
    v_mul_f32 v124, v124, v121
    v_mul_f32 v125, v125, v121
    v_cvt_pk_bf16_f32 v151, v124, v125
    v_add_u32 v31, 0, v30
    ds_write_b128 v31, v[148:151]
    v_mfma_f32_32x32x16_bf16 v[80:95], v[36:39], v[40:43], v[80:95]
    v_lshlrev_b32 v124, 16, v180
    v_and_b32 v125, 0xffff0000, v180
    v_sub_f32 v124, v124, v122
    v_sub_f32 v125, v125, v122
    v_cvt_pk_bf16_f32 v180, v124, v125
    v_lshlrev_b32 v124, 16, v180
    v_and_b32 v125, 0xffff0000, v180
    v_mul_f32 v124, v124, v123
    v_mul_f32 v125, v125, v123
    v_cvt_pk_bf16_f32 v180, v124, v125
    v_lshlrev_b32 v124, 16, v181
    v_and_b32 v125, 0xffff0000, v181
    v_sub_f32 v124, v124, v122
    v_sub_f32 v125, v125, v122
    v_cvt_pk_bf16_f32 v181, v124, v125
    v_lshlrev_b32 v124, 16, v181
    v_and_b32 v125, 0xffff0000, v181
    v_mul_f32 v124, v124, v123
    v_mul_f32 v125, v125, v123
    v_cvt_pk_bf16_f32 v181, v124, v125
    v_lshlrev_b32 v124, 16, v182
    v_and_b32 v125, 0xffff0000, v182
    v_sub_f32 v124, v124, v122
    v_sub_f32 v125, v125, v122
    v_cvt_pk_bf16_f32 v182, v124, v125
    v_lshlrev_b32 v124, 16, v182
    v_and_b32 v125, 0xffff0000, v182
    v_mul_f32 v124, v124, v123
    v_mul_f32 v125, v125, v123
    v_cvt_pk_bf16_f32 v182, v124, v125
    v_lshlrev_b32 v124, 16, v183
    v_and_b32 v125, 0xffff0000, v183
    v_sub_f32 v124, v124, v122
    v_sub_f32 v125, v125, v122
    v_cvt_pk_bf16_f32 v183, v124, v125
    v_lshlrev_b32 v124, 16, v183
    v_and_b32 v125, 0xffff0000, v183
    v_mul_f32 v124, v124, v123
    v_mul_f32 v125, v125, v123
    v_cvt_pk_bf16_f32 v183, v124, v125
    v_add_u32 v31, 8192, v30
    ds_write_b128 v31, v[180:183]
    ds_read_b128 v[32:35], v24 offset:0
    ds_read_b128 v[36:39], v24 offset:4096
    ds_read_b64_tr_b16 v[40:41], v26 offset:8192
    ds_read_b64_tr_b16 v[42:43], v26 offset:9216
    s_waitcnt lgkmcnt(4)
    v_mfma_f32_32x32x16_bf16 v[64:79], v[48:51], v[56:59], v[64:79]
    s_add_u32 m0, s45, 16384
    s_add_u32 s46, s36, 983040
    buffer_load_dwordx4 v4, s[8:11], s46 offen lds
    v_mfma_f32_32x32x16_bf16 v[80:95], v[52:55], v[56:59], v[80:95]
    s_add_u32 m0, s45, 24576
    s_add_u32 s46, s37, 983040
    buffer_load_dwordx4 v4, s[8:11], s46 offen lds
    ds_read_b128 v[48:51], v25 offset:0
    ds_read_b128 v[52:55], v25 offset:4096
    ds_read_b64_tr_b16 v[56:57], v26 offset:12288
    ds_read_b64_tr_b16 v[58:59], v26 offset:13312
    s_waitcnt lgkmcnt(4)
    v_mfma_f32_32x32x16_bf16 v[64:79], v[32:35], v[40:43], v[64:79]
    v_mfma_f32_32x32x16_bf16 v[80:95], v[36:39], v[40:43], v[80:95]
    s_waitcnt lgkmcnt(0)
    v_mfma_f32_32x32x16_bf16 v[64:79], v[48:51], v[56:59], v[64:79]
    v_mfma_f32_32x32x16_bf16 v[80:95], v[52:55], v[56:59], v[80:95]
    s_waitcnt vmcnt(6) lgkmcnt(0)
    s_barrier
    v_add_u32 v22, 65536, v10
    v_add_u32 v23, 65536, v11
    v_add_u32 v24, 65536, v12
    v_add_u32 v25, 65536, v13
    v_add_u32 v26, 65536, v20
    ds_read_b128 v[32:35], v22 offset:0
    ds_read_b128 v[36:39], v22 offset:4096
    ds_read_b64_tr_b16 v[40:41], v26 offset:0
    ds_read_b64_tr_b16 v[42:43], v26 offset:1024
    ds_read_b128 v[48:51], v23 offset:0
    ds_read_b128 v[52:55], v23 offset:4096
    ds_read_b64_tr_b16 v[56:57], v26 offset:4096
    ds_read_b64_tr_b16 v[58:59], v26 offset:5120
    s_waitcnt lgkmcnt(4)
    v_mfma_f32_32x32x16_bf16 v[64:79], v[32:35], v[40:43], v[64:79]
    v_lshlrev_b32 v124, 16, v152
    v_and_b32 v125, 0xffff0000, v152
    v_sub_f32 v124, v124, v120
    v_sub_f32 v125, v125, v120
    v_cvt_pk_bf16_f32 v152, v124, v125
    v_lshlrev_b32 v124, 16, v152
    v_and_b32 v125, 0xffff0000, v152
    v_mul_f32 v124, v124, v121
    v_mul_f32 v125, v125, v121
    v_cvt_pk_bf16_f32 v152, v124, v125
    v_lshlrev_b32 v124, 16, v153
    v_and_b32 v125, 0xffff0000, v153
    v_sub_f32 v124, v124, v120
    v_sub_f32 v125, v125, v120
    v_cvt_pk_bf16_f32 v153, v124, v125
    v_lshlrev_b32 v124, 16, v153
    v_and_b32 v125, 0xffff0000, v153
    v_mul_f32 v124, v124, v121
    v_mul_f32 v125, v125, v121
    v_cvt_pk_bf16_f32 v153, v124, v125
    v_lshlrev_b32 v124, 16, v154
    v_and_b32 v125, 0xffff0000, v154
    v_sub_f32 v124, v124, v120
    v_sub_f32 v125, v125, v120
    v_cvt_pk_bf16_f32 v154, v124, v125
    v_lshlrev_b32 v124, 16, v154
    v_and_b32 v125, 0xffff0000, v154
    v_mul_f32 v124, v124, v121
    v_mul_f32 v125, v125, v121
    v_cvt_pk_bf16_f32 v154, v124, v125
    v_lshlrev_b32 v124, 16, v155
    v_and_b32 v125, 0xffff0000, v155
    v_sub_f32 v124, v124, v120
    v_sub_f32 v125, v125, v120
    v_cvt_pk_bf16_f32 v155, v124, v125
    v_lshlrev_b32 v124, 16, v155
    v_and_b32 v125, 0xffff0000, v155
    v_mul_f32 v124, v124, v121
    v_mul_f32 v125, v125, v121
    v_cvt_pk_bf16_f32 v155, v124, v125
    v_add_u32 v31, 32768, v30
    ds_write_b128 v31, v[152:155]
    v_mfma_f32_32x32x16_bf16 v[80:95], v[36:39], v[40:43], v[80:95]
    v_lshlrev_b32 v124, 16, v184
    v_and_b32 v125, 0xffff0000, v184
    v_sub_f32 v124, v124, v122
    v_sub_f32 v125, v125, v122
    v_cvt_pk_bf16_f32 v184, v124, v125
    v_lshlrev_b32 v124, 16, v184
    v_and_b32 v125, 0xffff0000, v184
    v_mul_f32 v124, v124, v123
    v_mul_f32 v125, v125, v123
    v_cvt_pk_bf16_f32 v184, v124, v125
    v_lshlrev_b32 v124, 16, v185
    v_and_b32 v125, 0xffff0000, v185
    v_sub_f32 v124, v124, v122
    v_sub_f32 v125, v125, v122
    v_cvt_pk_bf16_f32 v185, v124, v125
    v_lshlrev_b32 v124, 16, v185
    v_and_b32 v125, 0xffff0000, v185
    v_mul_f32 v124, v124, v123
    v_mul_f32 v125, v125, v123
    v_cvt_pk_bf16_f32 v185, v124, v125
    v_lshlrev_b32 v124, 16, v186
    v_and_b32 v125, 0xffff0000, v186
    v_sub_f32 v124, v124, v122
    v_sub_f32 v125, v125, v122
    v_cvt_pk_bf16_f32 v186, v124, v125
    v_lshlrev_b32 v124, 16, v186
    v_and_b32 v125, 0xffff0000, v186
    v_mul_f32 v124, v124, v123
    v_mul_f32 v125, v125, v123
    v_cvt_pk_bf16_f32 v186, v124, v125
    v_lshlrev_b32 v124, 16, v187
    v_and_b32 v125, 0xffff0000, v187
    v_sub_f32 v124, v124, v122
    v_sub_f32 v125, v125, v122
    v_cvt_pk_bf16_f32 v187, v124, v125
    v_lshlrev_b32 v124, 16, v187
    v_and_b32 v125, 0xffff0000, v187
    v_mul_f32 v124, v124, v123
    v_mul_f32 v125, v125, v123
    v_cvt_pk_bf16_f32 v187, v124, v125
    v_add_u32 v31, 40960, v30
    ds_write_b128 v31, v[184:187]
    ds_read_b128 v[32:35], v24 offset:0
    ds_read_b128 v[36:39], v24 offset:4096
    ds_read_b64_tr_b16 v[40:41], v26 offset:8192
    ds_read_b64_tr_b16 v[42:43], v26 offset:9216
    s_waitcnt lgkmcnt(4)
    v_mfma_f32_32x32x16_bf16 v[64:79], v[48:51], v[56:59], v[64:79]
    s_add_u32 m0, s45, 49152
    s_add_u32 s46, s36, 1179648
    buffer_load_dwordx4 v4, s[8:11], s46 offen lds
    v_mfma_f32_32x32x16_bf16 v[80:95], v[52:55], v[56:59], v[80:95]
    s_add_u32 m0, s45, 57344
    s_add_u32 s46, s37, 1179648
    buffer_load_dwordx4 v4, s[8:11], s46 offen lds
    ds_read_b128 v[48:51], v25 offset:0
    ds_read_b128 v[52:55], v25 offset:4096
    ds_read_b64_tr_b16 v[56:57], v26 offset:12288
    ds_read_b64_tr_b16 v[58:59], v26 offset:13312
    s_waitcnt lgkmcnt(4)
    v_mfma_f32_32x32x16_bf16 v[64:79], v[32:35], v[40:43], v[64:79]
    v_mfma_f32_32x32x16_bf16 v[80:95], v[36:39], v[40:43], v[80:95]
    s_waitcnt lgkmcnt(0)
    v_mfma_f32_32x32x16_bf16 v[64:79], v[48:51], v[56:59], v[64:79]
    v_mfma_f32_32x32x16_bf16 v[80:95], v[52:55], v[56:59], v[80:95]
    s_waitcnt vmcnt(6) lgkmcnt(0)
    s_barrier
    v_add_u32 v22, 98304, v10
    v_add_u32 v23, 98304, v11
    v_add_u32 v24, 98304, v12
    v_add_u32 v25, 98304, v13
    v_add_u32 v26, 98304, v20
    ds_read_b128 v[32:35], v22 offset:0
    ds_read_b128 v[36:39], v22 offset:4096
    ds_read_b64_tr_b16 v[40:41], v26 offset:0
    ds_read_b64_tr_b16 v[42:43], v26 offset:1024
    ds_read_b128 v[48:51], v23 offset:0
    ds_read_b128 v[52:55], v23 offset:4096
    ds_read_b64_tr_b16 v[56:57], v26 offset:4096
    ds_read_b64_tr_b16 v[58:59], v26 offset:5120
    s_waitcnt lgkmcnt(4)
    v_mfma_f32_32x32x16_bf16 v[64:79], v[32:35], v[40:43], v[64:79]
    v_lshlrev_b32 v124, 16, v156
    v_and_b32 v125, 0xffff0000, v156
    v_sub_f32 v124, v124, v120
    v_sub_f32 v125, v125, v120
    v_cvt_pk_bf16_f32 v156, v124, v125
    v_lshlrev_b32 v124, 16, v156
    v_and_b32 v125, 0xffff0000, v156
    v_mul_f32 v124, v124, v121
    v_mul_f32 v125, v125, v121
    v_cvt_pk_bf16_f32 v156, v124, v125
    v_lshlrev_b32 v124, 16, v157
    v_and_b32 v125, 0xffff0000, v157
    v_sub_f32 v124, v124, v120
    v_sub_f32 v125, v125, v120
    v_cvt_pk_bf16_f32 v157, v124, v125
    v_lshlrev_b32 v124, 16, v157
    v_and_b32 v125, 0xffff0000, v157
    v_mul_f32 v124, v124, v121
    v_mul_f32 v125, v125, v121
    v_cvt_pk_bf16_f32 v157, v124, v125
    v_lshlrev_b32 v124, 16, v158
    v_and_b32 v125, 0xffff0000, v158
    v_sub_f32 v124, v124, v120
    v_sub_f32 v125, v125, v120
    v_cvt_pk_bf16_f32 v158, v124, v125
    v_lshlrev_b32 v124, 16, v158
    v_and_b32 v125, 0xffff0000, v158
    v_mul_f32 v124, v124, v121
    v_mul_f32 v125, v125, v121
    v_cvt_pk_bf16_f32 v158, v124, v125
    v_lshlrev_b32 v124, 16, v159
    v_and_b32 v125, 0xffff0000, v159
    v_sub_f32 v124, v124, v120
    v_sub_f32 v125, v125, v120
    v_cvt_pk_bf16_f32 v159, v124, v125
    v_lshlrev_b32 v124, 16, v159
    v_and_b32 v125, 0xffff0000, v159
    v_mul_f32 v124, v124, v121
    v_mul_f32 v125, v125, v121
    v_cvt_pk_bf16_f32 v159, v124, v125
    v_add_u32 v31, 65536, v30
    ds_write_b128 v31, v[156:159]
    v_mfma_f32_32x32x16_bf16 v[80:95], v[36:39], v[40:43], v[80:95]
    v_lshlrev_b32 v124, 16, v188
    v_and_b32 v125, 0xffff0000, v188
    v_sub_f32 v124, v124, v122
    v_sub_f32 v125, v125, v122
    v_cvt_pk_bf16_f32 v188, v124, v125
    v_lshlrev_b32 v124, 16, v188
    v_and_b32 v125, 0xffff0000, v188
    v_mul_f32 v124, v124, v123
    v_mul_f32 v125, v125, v123
    v_cvt_pk_bf16_f32 v188, v124, v125
    v_lshlrev_b32 v124, 16, v189
    v_and_b32 v125, 0xffff0000, v189
    v_sub_f32 v124, v124, v122
    v_sub_f32 v125, v125, v122
    v_cvt_pk_bf16_f32 v189, v124, v125
    v_lshlrev_b32 v124, 16, v189
    v_and_b32 v125, 0xffff0000, v189
    v_mul_f32 v124, v124, v123
    v_mul_f32 v125, v125, v123
    v_cvt_pk_bf16_f32 v189, v124, v125
    v_lshlrev_b32 v124, 16, v190
    v_and_b32 v125, 0xffff0000, v190
    v_sub_f32 v124, v124, v122
    v_sub_f32 v125, v125, v122
    v_cvt_pk_bf16_f32 v190, v124, v125
    v_lshlrev_b32 v124, 16, v190
    v_and_b32 v125, 0xffff0000, v190
    v_mul_f32 v124, v124, v123
    v_mul_f32 v125, v125, v123
    v_cvt_pk_bf16_f32 v190, v124, v125
    v_lshlrev_b32 v124, 16, v191
    v_and_b32 v125, 0xffff0000, v191
    v_sub_f32 v124, v124, v122
    v_sub_f32 v125, v125, v122
    v_cvt_pk_bf16_f32 v191, v124, v125
    v_lshlrev_b32 v124, 16, v191
    v_and_b32 v125, 0xffff0000, v191
    v_mul_f32 v124, v124, v123
    v_mul_f32 v125, v125, v123
    v_cvt_pk_bf16_f32 v191, v124, v125
    v_add_u32 v31, 73728, v30
    ds_write_b128 v31, v[188:191]
    ds_read_b128 v[32:35], v24 offset:0
    ds_read_b128 v[36:39], v24 offset:4096
    ds_read_b64_tr_b16 v[40:41], v26 offset:8192
    ds_read_b64_tr_b16 v[42:43], v26 offset:9216
    s_waitcnt lgkmcnt(4)
    v_mfma_f32_32x32x16_bf16 v[64:79], v[48:51], v[56:59], v[64:79]
    s_add_u32 m0, s45, 81920
    s_add_u32 s46, s36, 1376256
    buffer_load_dwordx4 v4, s[8:11], s46 offen lds
    v_mfma_f32_32x32x16_bf16 v[80:95], v[52:55], v[56:59], v[80:95]
    s_add_u32 m0, s45, 90112
    s_add_u32 s46, s37, 1376256
    buffer_load_dwordx4 v4, s[8:11], s46 offen lds
    ds_read_b128 v[48:51], v25 offset:0
    ds_read_b128 v[52:55], v25 offset:4096
    ds_read_b64_tr_b16 v[56:57], v26 offset:12288
    ds_read_b64_tr_b16 v[58:59], v26 offset:13312
    s_waitcnt lgkmcnt(4)
    v_mfma_f32_32x32x16_bf16 v[64:79], v[32:35], v[40:43], v[64:79]
    v_mfma_f32_32x32x16_bf16 v[80:95], v[36:39], v[40:43], v[80:95]
    s_waitcnt lgkmcnt(0)
    v_mfma_f32_32x32x16_bf16 v[64:79], v[48:51], v[56:59], v[64:79]
    v_mfma_f32_32x32x16_bf16 v[80:95], v[52:55], v[56:59], v[80:95]
    s_waitcnt vmcnt(6) lgkmcnt(0)
    s_barrier
    v_add_u32 v22, 131072, v10
    v_add_u32 v23, 131072, v11
    v_add_u32 v24, 131072, v12
    v_add_u32 v25, 131072, v13
    v_add_u32 v26, 131072, v20
    ds_read_b128 v[32:35], v22 offset:0
    ds_read_b128 v[36:39], v22 offset:4096
    ds_read_b64_tr_b16 v[40:41], v26 offset:0
    ds_read_b64_tr_b16 v[42:43], v26 offset:1024
    ds_read_b128 v[48:51], v23 offset:0
    ds_read_b128 v[52:55], v23 offset:4096
    ds_read_b64_tr_b16 v[56:57], v26 offset:4096
    ds_read_b64_tr_b16 v[58:59], v26 offset:5120
    s_waitcnt lgkmcnt(4)
    v_mfma_f32_32x32x16_bf16 v[64:79], v[32:35], v[40:43], v[64:79]
    v_mfma_f32_32x32x16_bf16 v[80:95], v[36:39], v[40:43], v[80:95]
    ds_read_b128 v[32:35], v24 offset:0
    ds_read_b128 v[36:39], v24 offset:4096
    ds_read_b64_tr_b16 v[40:41], v26 offset:8192
    ds_read_b64_tr_b16 v[42:43], v26 offset:9216
    s_waitcnt lgkmcnt(4)
    v_mfma_f32_32x32x16_bf16 v[64:79], v[48:51], v[56:59], v[64:79]
    v_mfma_f32_32x32x16_bf16 v[80:95], v[52:55], v[56:59], v[80:95]
    ds_read_b128 v[48:51], v25 offset:0
    ds_read_b128 v[52:55], v25 offset:4096
    ds_read_b64_tr_b16 v[56:57], v26 offset:12288
    ds_read_b64_tr_b16 v[58:59], v26 offset:13312
    s_waitcnt lgkmcnt(4)
    v_mfma_f32_32x32x16_bf16 v[64:79], v[32:35], v[40:43], v[64:79]
    v_mfma_f32_32x32x16_bf16 v[80:95], v[36:39], v[40:43], v[80:95]
    s_waitcnt lgkmcnt(0)
    v_mfma_f32_32x32x16_bf16 v[64:79], v[48:51], v[56:59], v[64:79]
    v_mfma_f32_32x32x16_bf16 v[80:95], v[52:55], v[56:59], v[80:95]
    s_waitcnt vmcnt(4) lgkmcnt(0)
    s_barrier
    v_add_u32 v22, 0, v10
    v_add_u32 v23, 0, v11
    v_add_u32 v24, 0, v12
    v_add_u32 v25, 0, v13
    v_add_u32 v26, 0, v20
    ds_read_b128 v[32:35], v22 offset:0
    ds_read_b128 v[36:39], v22 offset:4096
    ds_read_b64_tr_b16 v[40:41], v26 offset:0
    ds_read_b64_tr_b16 v[42:43], v26 offset:1024
    ds_read_b128 v[48:51], v23 offset:0
    ds_read_b128 v[52:55], v23 offset:4096
    ds_read_b64_tr_b16 v[56:57], v26 offset:4096
    ds_read_b64_tr_b16 v[58:59], v26 offset:5120
    s_waitcnt lgkmcnt(4)
    v_mfma_f32_32x32x16_bf16 v[64:79], v[32:35], v[40:43], v[64:79]
    v_mfma_f32_32x32x16_bf16 v[80:95], v[36:39], v[40:43], v[80:95]
    ds_read_b128 v[32:35], v24 offset:0
    ds_read_b128 v[36:39], v24 offset:4096
    ds_read_b64_tr_b16 v[40:41], v26 offset:8192
    ds_read_b64_tr_b16 v[42:43], v26 offset:9216
    s_waitcnt lgkmcnt(4)
    v_mfma_f32_32x32x16_bf16 v[64:79], v[48:51], v[56:59], v[64:79]
    v_mfma_f32_32x32x16_bf16 v[80:95], v[52:55], v[56:59], v[80:95]
    ds_read_b128 v[48:51], v25 offset:0
    ds_read_b128 v[52:55], v25 offset:4096
    ds_read_b64_tr_b16 v[56:57], v26 offset:12288
    ds_read_b64_tr_b16 v[58:59], v26 offset:13312
    s_waitcnt lgkmcnt(4)
    v_mfma_f32_32x32x16_bf16 v[64:79], v[32:35], v[40:43], v[64:79]
    v_mfma_f32_32x32x16_bf16 v[80:95], v[36:39], v[40:43], v[80:95]
    s_waitcnt lgkmcnt(0)
    v_mfma_f32_32x32x16_bf16 v[64:79], v[48:51], v[56:59], v[64:79]
    v_mfma_f32_32x32x16_bf16 v[80:95], v[52:55], v[56:59], v[80:95]
    s_waitcnt vmcnt(2) lgkmcnt(0)
    s_barrier
    v_add_u32 v22, 32768, v10
    v_add_u32 v23, 32768, v11
    v_add_u32 v24, 32768, v12
    v_add_u32 v25, 32768, v13
    v_add_u32 v26, 32768, v20
    ds_read_b128 v[32:35], v22 offset:0
    ds_read_b128 v[36:39], v22 offset:4096
    ds_read_b64_tr_b16 v[40:41], v26 offset:0
    ds_read_b64_tr_b16 v[42:43], v26 offset:1024
    ds_read_b128 v[48:51], v23 offset:0
    ds_read_b128 v[52:55], v23 offset:4096
    ds_read_b64_tr_b16 v[56:57], v26 offset:4096
    ds_read_b64_tr_b16 v[58:59], v26 offset:5120
    s_waitcnt lgkmcnt(4)
    v_mfma_f32_32x32x16_bf16 v[64:79], v[32:35], v[40:43], v[64:79]
    v_mfma_f32_32x32x16_bf16 v[80:95], v[36:39], v[40:43], v[80:95]
    ds_read_b128 v[32:35], v24 offset:0
    ds_read_b128 v[36:39], v24 offset:4096
    ds_read_b64_tr_b16 v[40:41], v26 offset:8192
    ds_read_b64_tr_b16 v[42:43], v26 offset:9216
    s_waitcnt lgkmcnt(4)
    v_mfma_f32_32x32x16_bf16 v[64:79], v[48:51], v[56:59], v[64:79]
    v_mfma_f32_32x32x16_bf16 v[80:95], v[52:55], v[56:59], v[80:95]
    ds_read_b128 v[48:51], v25 offset:0
    ds_read_b128 v[52:55], v25 offset:4096
    ds_read_b64_tr_b16 v[56:57], v26 offset:12288
    ds_read_b64_tr_b16 v[58:59], v26 offset:13312
    s_waitcnt lgkmcnt(4)
    v_mfma_f32_32x32x16_bf16 v[64:79], v[32:35], v[40:43], v[64:79]
    v_mfma_f32_32x32x16_bf16 v[80:95], v[36:39], v[40:43], v[80:95]
    s_waitcnt lgkmcnt(0)
    v_mfma_f32_32x32x16_bf16 v[64:79], v[48:51], v[56:59], v[64:79]
    v_mfma_f32_32x32x16_bf16 v[80:95], v[52:55], v[56:59], v[80:95]
    s_waitcnt vmcnt(0) lgkmcnt(0)
    s_barrier
    v_add_u32 v22, 65536, v10
    v_add_u32 v23, 65536, v11
    v_add_u32 v24, 65536, v12
    v_add_u32 v25, 65536, v13
    v_add_u32 v26, 65536, v20
    ds_read_b128 v[32:35], v22 offset:0
    ds_read_b128 v[36:39], v22 offset:4096
    ds_read_b64_tr_b16 v[40:41], v26 offset:0
    ds_read_b64_tr_b16 v[42:43], v26 offset:1024
    ds_read_b128 v[48:51], v23 offset:0
    ds_read_b128 v[52:55], v23 offset:4096
    ds_read_b64_tr_b16 v[56:57], v26 offset:4096
    ds_read_b64_tr_b16 v[58:59], v26 offset:5120
    s_waitcnt lgkmcnt(4)
    v_mfma_f32_32x32x16_bf16 v[64:79], v[32:35], v[40:43], v[64:79]
    v_mfma_f32_32x32x16_bf16 v[80:95], v[36:39], v[40:43], v[80:95]
    ds_read_b128 v[32:35], v24 offset:0
    ds_read_b128 v[36:39], v24 offset:4096
    ds_read_b64_tr_b16 v[40:41], v26 offset:8192
    ds_read_b64_tr_b16 v[42:43], v26 offset:9216
    s_waitcnt lgkmcnt(4)
    v_mfma_f32_32x32x16_bf16 v[64:79], v[48:51], v[56:59], v[64:79]
    v_mfma_f32_32x32x16_bf16 v[80:95], v[52:55], v[56:59], v[80:95]
    ds_read_b128 v[48:51], v25 offset:0
    ds_read_b128 v[52:55], v25 offset:4096
    ds_read_b64_tr_b16 v[56:57], v26 offset:12288
    ds_read_b64_tr_b16 v[58:59], v26 offset:13312
    s_waitcnt lgkmcnt(4)
    v_mfma_f32_32x32x16_bf16 v[64:79], v[32:35], v[40:43], v[64:79]
    v_mfma_f32_32x32x16_bf16 v[80:95], v[36:39], v[40:43], v[80:95]
    s_waitcnt lgkmcnt(0)
    v_mfma_f32_32x32x16_bf16 v[64:79], v[48:51], v[56:59], v[64:79]
    v_mfma_f32_32x32x16_bf16 v[80:95], v[52:55], v[56:59], v[80:95]
    s_nop 15
    v_and_b32 v17, 31, v1
    s_mul_i32 s31, s30, 32
    v_add_u32 v17, s31, v17
    v_lshlrev_b32 v17, 12, v17
    v_lshl_add_u32 v17, v14, 3, v17
    s_lshl_b32 s31, s29, 7
    v_add_u32 v17, s31, v17
    s_sub_u32 s41, s27, 1024
    s_lshl_b32 s41, s41, 12
    s_add_u32 s41, s41, 4194304
    s_lshl_b32 s42, s26, 1
    s_add_u32 s41, s41, s42
    v_cvt_pk_bf16_f32 v28, v64, v65
    v_cvt_pk_bf16_f32 v29, v66, v67
    s_add_u32 s42, s41, 0
    buffer_store_dwordx2 v[28:29], v17, s[12:15], s42 offen offset:0
    s_nop 1
    v_cvt_pk_bf16_f32 v28, v68, v69
    v_cvt_pk_bf16_f32 v29, v70, v71
    s_add_u32 s42, s41, 0
    buffer_store_dwordx2 v[28:29], v17, s[12:15], s42 offen offset:16
    s_nop 1
    v_cvt_pk_bf16_f32 v28, v72, v73
    v_cvt_pk_bf16_f32 v29, v74, v75
    s_add_u32 s42, s41, 0
    buffer_store_dwordx2 v[28:29], v17, s[12:15], s42 offen offset:32
    s_nop 1
    v_cvt_pk_bf16_f32 v28, v76, v77
    v_cvt_pk_bf16_f32 v29, v78, v79
    s_add_u32 s42, s41, 0
    buffer_store_dwordx2 v[28:29], v17, s[12:15], s42 offen offset:48
    s_nop 1
    v_cvt_pk_bf16_f32 v28, v80, v81
    v_cvt_pk_bf16_f32 v29, v82, v83
    s_add_u32 s42, s41, 64
    buffer_store_dwordx2 v[28:29], v17, s[12:15], s42 offen offset:0
    s_nop 1
    v_cvt_pk_bf16_f32 v28, v84, v85
    v_cvt_pk_bf16_f32 v29, v86, v87
    s_add_u32 s42, s41, 64
    buffer_store_dwordx2 v[28:29], v17, s[12:15], s42 offen offset:16
    s_nop 1
    v_cvt_pk_bf16_f32 v28, v88, v89
    v_cvt_pk_bf16_f32 v29, v90, v91
    s_add_u32 s42, s41, 64
    buffer_store_dwordx2 v[28:29], v17, s[12:15], s42 offen offset:32
    s_nop 1
    v_cvt_pk_bf16_f32 v28, v92, v93
    v_cvt_pk_bf16_f32 v29, v94, v95
    s_add_u32 s42, s41, 64
    buffer_store_dwordx2 v[28:29], v17, s[12:15], s42 offen offset:48
    s_nop 1
L_end_1:
    s_endpgm
.globl k2_attn_kernel
.p2align 8
.type k2_attn_kernel,@function
k2_attn_kernel:
    s_cmp_ge_u32 s2, 1024
    s_cbranch_scc1 L_end_3
    s_load_dwordx2 s[4:5], s[0:1], 80
    s_load_dwordx2 s[44:45], s[0:1], 40
    s_load_dwordx2 s[48:49], s[0:1], 32
    s_load_dwordx2 s[52:53], s[0:1], 16
    s_load_dwordx2 s[56:57], s[0:1], 56
    s_and_b32 s24, s2, 31
    s_lshr_b32 s25, s2, 5
    v_and_b32 v1, 63, v0
    v_lshrrev_b32 v2, 6, v0
    s_nop 0
    v_readfirstlane_b32 s28, v2
    s_waitcnt lgkmcnt(0)
    s_mov_b32 s8, s4
    s_mov_b32 s9, s5
    s_mov_b32 s12, s4
    s_mov_b32 s13, s5
    s_mov_b32 s16, s4
    s_mov_b32 s17, s5
    s_lshl_b32 s26, s25, 16
    s_add_u32 s4, s4, s26
    s_addc_u32 s5, s5, 0
    s_mov_b32 s6, 0x10000
    s_mov_b32 s7, 0x00020000
    s_add_u32 s27, s26, 2097152
    s_add_u32 s8, s8, s27
    s_addc_u32 s9, s9, 0
    s_mov_b32 s10, 0x10000
    s_mov_b32 s11, 0x00020000
    s_add_u32 s27, s26, 4194304
    s_add_u32 s12, s12, s27
    s_addc_u32 s13, s13, 0
    s_mov_b32 s14, 0x10000
    s_mov_b32 s15, 0x00020000
    s_add_u32 s16, s16, 0x600000
    s_addc_u32 s17, s17, 0
    s_mov_b32 s18, 0x200000
    s_mov_b32 s19, 0x00020000
    s_lshl_b32 s29, s24, 6
    s_sub_i32 s31, s29, 256
    v_lshlrev_b32 v3, 4, v1
    s_lshl_b32 s32, s31, 5
    s_lshl_b32 s33, s28, 10
    s_add_u32 s32, s32, s33
    v_add_u32 v4, s32, v3
    s_add_u32 m0, s33, 0
    s_nop 0
    buffer_load_dwordx4 v4, s[8:11], 0 offen lds
    v_add_u32 v4, 0x1000, v4
    s_add_u32 m0, s33, 4096
    s_nop 0
    buffer_load_dwordx4 v4, s[8:11], 0 offen lds
    v_add_u32 v4, 0x1000, v4
    s_cmp_ge_u32 s28, 2
    s_cbranch_scc1 L_sk_6
    s_add_u32 m0, s33, 8192
    s_nop 0
    buffer_load_dwordx4 v4, s[8:11], 0 offen lds
    v_add_u32 v4, 0x1000, v4
L_sk_6:
    s_lshl_b32 s34, s31, 1
    s_mov_b32 s35, 104755300
    s_lshl_b32 s36, s28, 6
    v_add_u32 v5, 0, v1
    v_add_u32 v5, s36, v5
    v_mul_hi_u32 v6, v5, s35
    v_mul_u32_u24 v7, 41, v6
    v_sub_u32 v7, v5, v7
    v_lshlrev_b32 v8, 12, v6
    v_lshl_add_u32 v8, v7, 4, v8
    v_add_u32 v8, s34, v8
    v_cmp_lt_u32 vcc, 15, v6
    s_nop 1
    v_cndmask_b32 v8, v8, -1, vcc
    s_add_u32 m0, s33, 10240
    s_nop 0
    buffer_load_dwordx4 v8, s[12:15], 0 offen lds
    s_lshl_b32 s36, s28, 6
    v_add_u32 v5, 256, v1
    v_add_u32 v5, s36, v5
    v_mul_hi_u32 v6, v5, s35
    v_mul_u32_u24 v7, 41, v6
    v_sub_u32 v7, v5, v7
    v_lshlrev_b32 v8, 12, v6
    v_lshl_add_u32 v8, v7, 4, v8
    v_add_u32 v8, s34, v8
    v_cmp_lt_u32 vcc, 15, v6
    s_nop 1
    v_cndmask_b32 v8, v8, -1, vcc
    s_add_u32 m0, s33, 14336
    s_nop 0
    buffer_load_dwordx4 v8, s[12:15], 0 offen lds
    s_cmp_ge_u32 s28, 3
    s_cbranch_scc1 L_sv_9
    s_lshl_b32 s36, s28, 6
    v_add_u32 v5, 512, v1
    v_add_u32 v5, s36, v5
    v_mul_hi_u32 v6, v5, s35
    v_mul_u32_u24 v7, 41, v6
    v_sub_u32 v7, v5, v7
    v_lshlrev_b32 v8, 12, v6
    v_lshl_add_u32 v8, v7, 4, v8
    v_add_u32 v8, s34, v8
    v_cmp_lt_u32 vcc, 15, v6
    s_nop 1
    v_cndmask_b32 v8, v8, -1, vcc
    s_add_u32 m0, s33, 18432
    s_nop 0
    buffer_load_dwordx4 v8, s[12:15], 0 offen lds
L_sv_9:
    s_lshl_b32 s30, s28, 4
    s_add_u32 s29, s29, s30
    s_sub_i32 s31, s29, 256
    v_and_b32 v2, 15, v1
    v_lshrrev_b32 v3, 4, v1
    v_lshlrev_b32 v4, 5, v2
    v_lshl_add_u32 v4, v3, 3, v4
    s_lshl_b32 s30, s29, 5
    buffer_load_dwordx2 v[6:7], v4, s[4:7], s30 offen
    s_lshl_b32 s36, s28, 9
    v_add_u32 v4, s36, v4
    v_mul_u32_u24 v5, 656, v2
    v_lshl_add_u32 v5, v3, 3, v5
    s_lshl_b32 s36, s28, 5
    s_add_u32 s36, s36, 10240
    v_add_u32 v5, s36, v5
    v_mov_b32 v56, 0
    v_mov_b32 v57, 0
    v_mov_b32 v58, 0
    v_mov_b32 v59, 0
    v_mov_b32 v60, 0
    v_mov_b32 v61, 0
    v_mov_b32 v62, 0
    v_mov_b32 v63, 0
    v_mov_b32 v64, 0
    v_mov_b32 v65, 0
    v_mov_b32 v66, 0
    v_mov_b32 v67, 0
    v_mov_b32 v68, 0
    v_mov_b32 v69, 0
    v_mov_b32 v70, 0
    v_mov_b32 v71, 0
    v_mov_b32 v72, 0
    v_mov_b32 v73, 0
    v_mov_b32 v74, 0
    v_mov_b32 v75, 0
    v_mov_b32 v76, 0
    v_mov_b32 v77, 0
    v_mov_b32 v78, 0
    v_mov_b32 v79, 0
    v_mov_b32 v80, 0
    v_mov_b32 v81, 0
    v_mov_b32 v82, 0
    v_mov_b32 v83, 0
    v_mov_b32 v84, 0
    v_mov_b32 v85, 0
    v_mov_b32 v86, 0
    v_mov_b32 v87, 0
    v_mov_b32 v88, 0
    v_mov_b32 v89, 0
    v_mov_b32 v90, 0
    v_mov_b32 v91, 0
    v_mov_b32 v92, 0
    v_mov_b32 v93, 0
    v_mov_b32 v94, 0
    v_mov_b32 v95, 0
    v_mov_b32 v96, 0
    v_mov_b32 v97, 0
    v_mov_b32 v98, 0
    v_mov_b32 v99, 0
    v_mov_b32 v100, 0
    v_mov_b32 v101, 0
    v_mov_b32 v102, 0
    v_mov_b32 v103, 0
    v_mov_b32 v104, 0
    v_mov_b32 v105, 0
    v_mov_b32 v106, 0
    v_mov_b32 v107, 0
    v_mov_b32 v108, 0
    v_mov_b32 v109, 0
    v_mov_b32 v110, 0
    v_mov_b32 v111, 0
    v_mov_b32 v112, 0
    v_mov_b32 v113, 0
    v_mov_b32 v114, 0
    v_mov_b32 v115, 0
    v_mov_b32 v116, 0
    v_mov_b32 v117, 0
    v_mov_b32 v118, 0
    v_mov_b32 v119, 0
    v_mov_b32 v120, 0
    v_mov_b32 v121, 0
    v_mov_b32 v122, 0
    v_mov_b32 v123, 0
    v_mov_b32 v8, 0
    v_mov_b32 v9, 0
    v_mov_b32 v10, 0
    v_mov_b32 v11, 0
    v_mov_b32 v12, 0xff800000
    v_lshlrev_b32 v13, 2, v3
    v_sub_u32 v13, v13, v2
    s_waitcnt vmcnt(0)
    s_barrier
    ds_read_b64 v[20:21], v4 offset:0
    ds_read_b64 v[22:23], v4 offset:512
    ds_read_b64 v[24:25], v4 offset:1024
    ds_read_b64 v[26:27], v4 offset:1536
    ds_read_b64 v[28:29], v4 offset:2048
    ds_read_b64 v[30:31], v4 offset:2560
    ds_read_b64 v[32:33], v4 offset:3072
    ds_read_b64 v[34:35], v4 offset:3584
    ds_read_b64 v[36:37], v4 offset:4096
    ds_read_b64 v[38:39], v4 offset:4608
    ds_read_b64 v[40:41], v4 offset:5120
    ds_read_b64 v[42:43], v4 offset:5632
    ds_read_b64 v[44:45], v4 offset:6144
    ds_read_b64 v[46:47], v4 offset:6656
    ds_read_b64 v[48:49], v4 offset:7168
    ds_read_b64 v[50:51], v4 offset:7680
    ds_read_b64 v[52:53], v4 offset:8192
    s_waitcnt lgkmcnt(15)
    v_mfma_f32_16x16x16_bf16 v[56:59], v[20:21], v[6:7], v[56:59]
    s_waitcnt lgkmcnt(15)
    v_mfma_f32_16x16x16_bf16 v[60:63], v[22:23], v[6:7], v[60:63]
    s_waitcnt lgkmcnt(14)
    v_mfma_f32_16x16x16_bf16 v[64:67], v[24:25], v[6:7], v[64:67]
    s_waitcnt lgkmcnt(13)
    v_mfma_f32_16x16x16_bf16 v[68:71], v[26:27], v[6:7], v[68:71]
    s_waitcnt lgkmcnt(12)
    v_mfma_f32_16x16x16_bf16 v[72:75], v[28:29], v[6:7], v[72:75]
    s_waitcnt lgkmcnt(11)
    v_mfma_f32_16x16x16_bf16 v[76:79], v[30:31], v[6:7], v[76:79]
    s_waitcnt lgkmcnt(10)
    v_mfma_f32_16x16x16_bf16 v[80:83], v[32:33], v[6:7], v[80:83]
    s_waitcnt lgkmcnt(9)
    v_mfma_f32_16x16x16_bf16 v[84:87], v[34:35], v[6:7], v[84:87]
    s_waitcnt lgkmcnt(8)
    v_mfma_f32_16x16x16_bf16 v[88:91], v[36:37], v[6:7], v[88:91]
    s_waitcnt lgkmcnt(7)
    v_mfma_f32_16x16x16_bf16 v[92:95], v[38:39], v[6:7], v[92:95]
    s_waitcnt lgkmcnt(6)
    v_mfma_f32_16x16x16_bf16 v[96:99], v[40:41], v[6:7], v[96:99]
    s_waitcnt lgkmcnt(5)
    v_mfma_f32_16x16x16_bf16 v[100:103], v[42:43], v[6:7], v[100:103]
    s_waitcnt lgkmcnt(4)
    v_mfma_f32_16x16x16_bf16 v[104:107], v[44:45], v[6:7], v[104:107]
    s_waitcnt lgkmcnt(3)
    v_mfma_f32_16x16x16_bf16 v[108:111], v[46:47], v[6:7], v[108:111]
    s_waitcnt lgkmcnt(2)
    v_mfma_f32_16x16x16_bf16 v[112:115], v[48:49], v[6:7], v[112:115]
    s_waitcnt lgkmcnt(1)
    v_mfma_f32_16x16x16_bf16 v[116:119], v[50:51], v[6:7], v[116:119]
    s_waitcnt lgkmcnt(0)
    v_mfma_f32_16x16x16_bf16 v[120:123], v[52:53], v[6:7], v[120:123]
    s_nop 7
    v_cmp_gt_i32 vcc, 0, v13
    v_cmp_le_i32 s[34:35], 0, v13
    v_cmp_eq_i32 s[36:37], 0, v13
    s_nop 1
    s_or_b64 s[38:39], vcc, s[36:37]
    v_cndmask_b32 v56, v56, v12, s[38:39]
    s_andn2_b64 s[38:39], s[34:35], s[36:37]
    v_cndmask_b32 v120, v120, v12, s[38:39]
    v_cmp_gt_i32 vcc, -1, v13
    v_cmp_le_i32 s[34:35], -1, v13
    v_cmp_eq_i32 s[36:37], -1, v13
    s_nop 1
    s_or_b64 s[38:39], vcc, s[36:37]
    v_cndmask_b32 v57, v57, v12, s[38:39]
    s_andn2_b64 s[38:39], s[34:35], s[36:37]
    v_cndmask_b32 v121, v121, v12, s[38:39]
    v_cmp_gt_i32 vcc, -2, v13
    v_cmp_le_i32 s[34:35], -2, v13
    v_cmp_eq_i32 s[36:37], -2, v13
    s_nop 1
    s_or_b64 s[38:39], vcc, s[36:37]
    v_cndmask_b32 v58, v58, v12, s[38:39]
    s_andn2_b64 s[38:39], s[34:35], s[36:37]
    v_cndmask_b32 v122, v122, v12, s[38:39]
    v_cmp_gt_i32 vcc, -3, v13
    v_cmp_le_i32 s[34:35], -3, v13
    v_cmp_eq_i32 s[36:37], -3, v13
    s_nop 1
    s_or_b64 s[38:39], vcc, s[36:37]
    v_cndmask_b32 v59, v59, v12, s[38:39]
    s_andn2_b64 s[38:39], s[34:35], s[36:37]
    v_cndmask_b32 v123, v123, v12, s[38:39]
    s_add_i32 s32, s31, 0
    s_cmp_ge_i32 s32, 0
    s_cbranch_scc1 L_ok_10
    v_mov_b32 v56, v12
    v_mov_b32 v57, v12
    v_mov_b32 v58, v12
    v_mov_b32 v59, v12
L_ok_10:
    s_add_i32 s32, s31, 16
    s_cmp_ge_i32 s32, 0
    s_cbranch_scc1 L_ok_11
    v_mov_b32 v60, v12
    v_mov_b32 v61, v12
    v_mov_b32 v62, v12
    v_mov_b32 v63, v12
L_ok_11:
    s_add_i32 s32, s31, 32
    s_cmp_ge_i32 s32, 0
    s_cbranch_scc1 L_ok_12
    v_mov_b32 v64, v12
    v_mov_b32 v65, v12
    v_mov_b32 v66, v12
    v_mov_b32 v67, v12
L_ok_12:
    s_add_i32 s32, s31, 48
    s_cmp_ge_i32 s32, 0
    s_cbranch_scc1 L_ok_13
    v_mov_b32 v68, v12
    v_mov_b32 v69, v12
    v_mov_b32 v70, v12
    v_mov_b32 v71, v12
L_ok_13:
    s_add_i32 s32, s31, 64
    s_cmp_ge_i32 s32, 0
    s_cbranch_scc1 L_ok_14
    v_mov_b32 v72, v12
    v_mov_b32 v73, v12
    v_mov_b32 v74, v12
    v_mov_b32 v75, v12
L_ok_14:
    s_add_i32 s32, s31, 80
    s_cmp_ge_i32 s32, 0
    s_cbranch_scc1 L_ok_15
    v_mov_b32 v76, v12
    v_mov_b32 v77, v12
    v_mov_b32 v78, v12
    v_mov_b32 v79, v12
L_ok_15:
    s_add_i32 s32, s31, 96
    s_cmp_ge_i32 s32, 0
    s_cbranch_scc1 L_ok_16
    v_mov_b32 v80, v12
    v_mov_b32 v81, v12
    v_mov_b32 v82, v12
    v_mov_b32 v83, v12
L_ok_16:
    s_add_i32 s32, s31, 112
    s_cmp_ge_i32 s32, 0
    s_cbranch_scc1 L_ok_17
    v_mov_b32 v84, v12
    v_mov_b32 v85, v12
    v_mov_b32 v86, v12
    v_mov_b32 v87, v12
L_ok_17:
    s_add_i32 s32, s31, 128
    s_cmp_ge_i32 s32, 0
    s_cbranch_scc1 L_ok_18
    v_mov_b32 v88, v12
    v_mov_b32 v89, v12
    v_mov_b32 v90, v12
    v_mov_b32 v91, v12
L_ok_18:
    s_add_i32 s32, s31, 144
    s_cmp_ge_i32 s32, 0
    s_cbranch_scc1 L_ok_19
    v_mov_b32 v92, v12
    v_mov_b32 v93, v12
    v_mov_b32 v94, v12
    v_mov_b32 v95, v12
L_ok_19:
    s_add_i32 s32, s31, 160
    s_cmp_ge_i32 s32, 0
    s_cbranch_scc1 L_ok_20
    v_mov_b32 v96, v12
    v_mov_b32 v97, v12
    v_mov_b32 v98, v12
    v_mov_b32 v99, v12
L_ok_20:
    s_add_i32 s32, s31, 176
    s_cmp_ge_i32 s32, 0
    s_cbranch_scc1 L_ok_21
    v_mov_b32 v100, v12
    v_mov_b32 v101, v12
    v_mov_b32 v102, v12
    v_mov_b32 v103, v12
L_ok_21:
    s_add_i32 s32, s31, 192
    s_cmp_ge_i32 s32, 0
    s_cbranch_scc1 L_ok_22
    v_mov_b32 v104, v12
    v_mov_b32 v105, v12
    v_mov_b32 v106, v12
    v_mov_b32 v107, v12
L_ok_22:
    s_add_i32 s32, s31, 208
    s_cmp_ge_i32 s32, 0
    s_cbranch_scc1 L_ok_23
    v_mov_b32 v108, v12
    v_mov_b32 v109, v12
    v_mov_b32 v110, v12
    v_mov_b32 v111, v12
L_ok_23:
    s_add_i32 s32, s31, 224
    s_cmp_ge_i32 s32, 0
    s_cbranch_scc1 L_ok_24
    v_mov_b32 v112, v12
    v_mov_b32 v113, v12
    v_mov_b32 v114, v12
    v_mov_b32 v115, v12
L_ok_24:
    s_add_i32 s32, s31, 240
    s_cmp_ge_i32 s32, 0
    s_cbranch_scc1 L_ok_25
    v_mov_b32 v116, v12
    v_mov_b32 v117, v12
    v_mov_b32 v118, v12
    v_mov_b32 v119, v12
L_ok_25:
    v_max3_f32 v14, v56, v57, v58
    v_max3_f32 v15, v59, v60, v61
    v_max3_f32 v14, v14, v62, v63
    v_max3_f32 v15, v15, v64, v65
    v_max3_f32 v14, v14, v66, v67
    v_max3_f32 v15, v15, v68, v69
    v_max3_f32 v14, v14, v70, v71
    v_max3_f32 v15, v15, v72, v73
    v_max3_f32 v14, v14, v74, v75
    v_max3_f32 v15, v15, v76, v77
    v_max3_f32 v14, v14, v78, v79
    v_max3_f32 v15, v15, v80, v81
    v_max3_f32 v14, v14, v82, v83
    v_max3_f32 v15, v15, v84, v85
    v_max3_f32 v14, v14, v86, v87
    v_max3_f32 v15, v15, v88, v89
    v_max3_f32 v14, v14, v90, v91
    v_max3_f32 v15, v15, v92, v93
    v_max3_f32 v14, v14, v94, v95
    v_max3_f32 v15, v15, v96, v97
    v_max3_f32 v14, v14, v98, v99
    v_max3_f32 v15, v15, v100, v101
    v_max3_f32 v14, v14, v102, v103
    v_max3_f32 v15, v15, v104, v105
    v_max3_f32 v14, v14, v106, v107
    v_max3_f32 v15, v15, v108, v109
    v_max3_f32 v14, v14, v110, v111
    v_max3_f32 v15, v15, v112, v113
    v_max3_f32 v14, v14, v114, v115
    v_max3_f32 v15, v15, v116, v117
    v_max3_f32 v14, v14, v118, v119
    v_max3_f32 v15, v15, v120, v121
    v_max3_f32 v14, v14, v122, v123
    v_max_f32 v14, v14, v15
    v_mov_b32 v15, v14
    s_nop 1
    v_permlane32_swap_b32 v15, v14
    v_max_f32 v14, v14, v15
    v_mov_b32 v15, v14
    s_nop 1
    v_permlane16_swap_b32 v15, v14
    v_max_f32 v14, v14, v15
    s_mov_b32 s40, 0x3eb8aa3b
    v_mul_f32 v14, s40, v14
    v_mov_b32 v16, 0
    v_mov_b32 v17, 0
    v_fma_f32 v56, v56, s40, -v14
    v_fma_f32 v57, v57, s40, -v14
    v_fma_f32 v58, v58, s40, -v14
    v_fma_f32 v59, v59, s40, -v14
    v_exp_f32 v56, v56
    v_exp_f32 v57, v57
    v_exp_f32 v58, v58
    v_exp_f32 v59, v59
    ds_read_b64 v[18:19], v5 offset:0
    v_add_f32 v16, v16, v56
    v_add_f32 v17, v17, v57
    v_add_f32 v16, v16, v58
    v_add_f32 v17, v17, v59
    v_cvt_pk_bf16_f32 v20, v56, v57
    v_cvt_pk_bf16_f32 v21, v58, v59
    s_waitcnt lgkmcnt(0)
    s_nop 1
    v_mfma_f32_16x16x16_bf16 v[8:11], v[18:19], v[20:21], v[8:11]
    v_fma_f32 v60, v60, s40, -v14
    v_fma_f32 v61, v61, s40, -v14
    v_fma_f32 v62, v62, s40, -v14
    v_fma_f32 v63, v63, s40, -v14
    v_exp_f32 v60, v60
    v_exp_f32 v61, v61
    v_exp_f32 v62, v62
    v_exp_f32 v63, v63
    ds_read_b64 v[54:55], v5 offset:32
    v_add_f32 v16, v16, v60
    v_add_f32 v17, v17, v61
    v_add_f32 v16, v16, v62
    v_add_f32 v17, v17, v63
    v_cvt_pk_bf16_f32 v22, v60, v61
    v_cvt_pk_bf16_f32 v23, v62, v63
    s_waitcnt lgkmcnt(0)
    s_nop 1
    v_mfma_f32_16x16x16_bf16 v[8:11], v[54:55], v[22:23], v[8:11]
    v_fma_f32 v64, v64, s40, -v14
    v_fma_f32 v65, v65, s40, -v14
    v_fma_f32 v66, v66, s40, -v14
    v_fma_f32 v67, v67, s40, -v14
    v_exp_f32 v64, v64
    v_exp_f32 v65, v65
    v_exp_f32 v66, v66
    v_exp_f32 v67, v67
    ds_read_b64 v[18:19], v5 offset:64
    v_add_f32 v16, v16, v64
    v_add_f32 v17, v17, v65
    v_add_f32 v16, v16, v66
    v_add_f32 v17, v17, v67
    v_cvt_pk_bf16_f32 v24, v64, v65
    v_cvt_pk_bf16_f32 v25, v66, v67
    s_waitcnt lgkmcnt(0)
    s_nop 1
    v_mfma_f32_16x16x16_bf16 v[8:11], v[18:19], v[24:25], v[8:11]
    v_fma_f32 v68, v68, s40, -v14
    v_fma_f32 v69, v69, s40, -v14
    v_fma_f32 v70, v70, s40, -v14
    v_fma_f32 v71, v71, s40, -v14
    v_exp_f32 v68, v68
    v_exp_f32 v69, v69
    v_exp_f32 v70, v70
    v_exp_f32 v71, v71
    ds_read_b64 v[54:55], v5 offset:96
    v_add_f32 v16, v16, v68
    v_add_f32 v17, v17, v69
    v_add_f32 v16, v16, v70
    v_add_f32 v17, v17, v71
    v_cvt_pk_bf16_f32 v26, v68, v69
    v_cvt_pk_bf16_f32 v27, v70, v71
    s_waitcnt lgkmcnt(0)
    s_nop 1
    v_mfma_f32_16x16x16_bf16 v[8:11], v[54:55], v[26:27], v[8:11]
    v_fma_f32 v72, v72, s40, -v14
    v_fma_f32 v73, v73, s40, -v14
    v_fma_f32 v74, v74, s40, -v14
    v_fma_f32 v75, v75, s40, -v14
    v_exp_f32 v72, v72
    v_exp_f32 v73, v73
    v_exp_f32 v74, v74
    v_exp_f32 v75, v75
    ds_read_b64 v[18:19], v5 offset:128
    v_add_f32 v16, v16, v72
    v_add_f32 v17, v17, v73
    v_add_f32 v16, v16, v74
    v_add_f32 v17, v17, v75
    v_cvt_pk_bf16_f32 v28, v72, v73
    v_cvt_pk_bf16_f32 v29, v74, v75
    s_waitcnt lgkmcnt(0)
    s_nop 1
    v_mfma_f32_16x16x16_bf16 v[8:11], v[18:19], v[28:29], v[8:11]
    v_fma_f32 v76, v76, s40, -v14
    v_fma_f32 v77, v77, s40, -v14
    v_fma_f32 v78, v78, s40, -v14
    v_fma_f32 v79, v79, s40, -v14
    v_exp_f32 v76, v76
    v_exp_f32 v77, v77
    v_exp_f32 v78, v78
    v_exp_f32 v79, v79
    ds_read_b64 v[54:55], v5 offset:160
    v_add_f32 v16, v16, v76
    v_add_f32 v17, v17, v77
    v_add_f32 v16, v16, v78
    v_add_f32 v17, v17, v79
    v_cvt_pk_bf16_f32 v30, v76, v77
    v_cvt_pk_bf16_f32 v31, v78, v79
    s_waitcnt lgkmcnt(0)
    s_nop 1
    v_mfma_f32_16x16x16_bf16 v[8:11], v[54:55], v[30:31], v[8:11]
    v_fma_f32 v80, v80, s40, -v14
    v_fma_f32 v81, v81, s40, -v14
    v_fma_f32 v82, v82, s40, -v14
    v_fma_f32 v83, v83, s40, -v14
    v_exp_f32 v80, v80
    v_exp_f32 v81, v81
    v_exp_f32 v82, v82
    v_exp_f32 v83, v83
    ds_read_b64 v[18:19], v5 offset:192
    v_add_f32 v16, v16, v80
    v_add_f32 v17, v17, v81
    v_add_f32 v16, v16, v82
    v_add_f32 v17, v17, v83
    v_cvt_pk_bf16_f32 v32, v80, v81
    v_cvt_pk_bf16_f32 v33, v82, v83
    s_waitcnt lgkmcnt(0)
    s_nop 1
    v_mfma_f32_16x16x16_bf16 v[8:11], v[18:19], v[32:33], v[8:11]
    v_fma_f32 v84, v84, s40, -v14
    v_fma_f32 v85, v85, s40, -v14
    v_fma_f32 v86, v86, s40, -v14
    v_fma_f32 v87, v87, s40, -v14
    v_exp_f32 v84, v84
    v_exp_f32 v85, v85
    v_exp_f32 v86, v86
    v_exp_f32 v87, v87
    ds_read_b64 v[54:55], v5 offset:224
    v_add_f32 v16, v16, v84
    v_add_f32 v17, v17, v85
    v_add_f32 v16, v16, v86
    v_add_f32 v17, v17, v87
    v_cvt_pk_bf16_f32 v34, v84, v85
    v_cvt_pk_bf16_f32 v35, v86, v87
    s_waitcnt lgkmcnt(0)
    s_nop 1
    v_mfma_f32_16x16x16_bf16 v[8:11], v[54:55], v[34:35], v[8:11]
    v_fma_f32 v88, v88, s40, -v14
    v_fma_f32 v89, v89, s40, -v14
    v_fma_f32 v90, v90, s40, -v14
    v_fma_f32 v91, v91, s40, -v14
    v_exp_f32 v88, v88
    v_exp_f32 v89, v89
    v_exp_f32 v90, v90
    v_exp_f32 v91, v91
    ds_read_b64 v[18:19], v5 offset:256
    v_add_f32 v16, v16, v88
    v_add_f32 v17, v17, v89
    v_add_f32 v16, v16, v90
    v_add_f32 v17, v17, v91
    v_cvt_pk_bf16_f32 v36, v88, v89
    v_cvt_pk_bf16_f32 v37, v90, v91
    s_waitcnt lgkmcnt(0)
    s_nop 1
    v_mfma_f32_16x16x16_bf16 v[8:11], v[18:19], v[36:37], v[8:11]
    v_fma_f32 v92, v92, s40, -v14
    v_fma_f32 v93, v93, s40, -v14
    v_fma_f32 v94, v94, s40, -v14
    v_fma_f32 v95, v95, s40, -v14
    v_exp_f32 v92, v92
    v_exp_f32 v93, v93
    v_exp_f32 v94, v94
    v_exp_f32 v95, v95
    ds_read_b64 v[54:55], v5 offset:288
    v_add_f32 v16, v16, v92
    v_add_f32 v17, v17, v93
    v_add_f32 v16, v16, v94
    v_add_f32 v17, v17, v95
    v_cvt_pk_bf16_f32 v38, v92, v93
    v_cvt_pk_bf16_f32 v39, v94, v95
    s_waitcnt lgkmcnt(0)
    s_nop 1
    v_mfma_f32_16x16x16_bf16 v[8:11], v[54:55], v[38:39], v[8:11]
    v_fma_f32 v96, v96, s40, -v14
    v_fma_f32 v97, v97, s40, -v14
    v_fma_f32 v98, v98, s40, -v14
    v_fma_f32 v99, v99, s40, -v14
    v_exp_f32 v96, v96
    v_exp_f32 v97, v97
    v_exp_f32 v98, v98
    v_exp_f32 v99, v99
    ds_read_b64 v[18:19], v5 offset:320
    v_add_f32 v16, v16, v96
    v_add_f32 v17, v17, v97
    v_add_f32 v16, v16, v98
    v_add_f32 v17, v17, v99
    v_cvt_pk_bf16_f32 v40, v96, v97
    v_cvt_pk_bf16_f32 v41, v98, v99
    s_waitcnt lgkmcnt(0)
    s_nop 1
    v_mfma_f32_16x16x16_bf16 v[8:11], v[18:19], v[40:41], v[8:11]
    v_fma_f32 v100, v100, s40, -v14
    v_fma_f32 v101, v101, s40, -v14
    v_fma_f32 v102, v102, s40, -v14
    v_fma_f32 v103, v103, s40, -v14
    v_exp_f32 v100, v100
    v_exp_f32 v101, v101
    v_exp_f32 v102, v102
    v_exp_f32 v103, v103
    ds_read_b64 v[54:55], v5 offset:352
    v_add_f32 v16, v16, v100
    v_add_f32 v17, v17, v101
    v_add_f32 v16, v16, v102
    v_add_f32 v17, v17, v103
    v_cvt_pk_bf16_f32 v42, v100, v101
    v_cvt_pk_bf16_f32 v43, v102, v103
    s_waitcnt lgkmcnt(0)
    s_nop 1
    v_mfma_f32_16x16x16_bf16 v[8:11], v[54:55], v[42:43], v[8:11]
    v_fma_f32 v104, v104, s40, -v14
    v_fma_f32 v105, v105, s40, -v14
    v_fma_f32 v106, v106, s40, -v14
    v_fma_f32 v107, v107, s40, -v14
    v_exp_f32 v104, v104
    v_exp_f32 v105, v105
    v_exp_f32 v106, v106
    v_exp_f32 v107, v107
    ds_read_b64 v[18:19], v5 offset:384
    v_add_f32 v16, v16, v104
    v_add_f32 v17, v17, v105
    v_add_f32 v16, v16, v106
    v_add_f32 v17, v17, v107
    v_cvt_pk_bf16_f32 v44, v104, v105
    v_cvt_pk_bf16_f32 v45, v106, v107
    s_waitcnt lgkmcnt(0)
    s_nop 1
    v_mfma_f32_16x16x16_bf16 v[8:11], v[18:19], v[44:45], v[8:11]
    v_fma_f32 v108, v108, s40, -v14
    v_fma_f32 v109, v109, s40, -v14
    v_fma_f32 v110, v110, s40, -v14
    v_fma_f32 v111, v111, s40, -v14
    v_exp_f32 v108, v108
    v_exp_f32 v109, v109
    v_exp_f32 v110, v110
    v_exp_f32 v111, v111
    ds_read_b64 v[54:55], v5 offset:416
    v_add_f32 v16, v16, v108
    v_add_f32 v17, v17, v109
    v_add_f32 v16, v16, v110
    v_add_f32 v17, v17, v111
    v_cvt_pk_bf16_f32 v46, v108, v109
    v_cvt_pk_bf16_f32 v47, v110, v111
    s_waitcnt lgkmcnt(0)
    s_nop 1
    v_mfma_f32_16x16x16_bf16 v[8:11], v[54:55], v[46:47], v[8:11]
    v_fma_f32 v112, v112, s40, -v14
    v_fma_f32 v113, v113, s40, -v14
    v_fma_f32 v114, v114, s40, -v14
    v_fma_f32 v115, v115, s40, -v14
    v_exp_f32 v112, v112
    v_exp_f32 v113, v113
    v_exp_f32 v114, v114
    v_exp_f32 v115, v115
    ds_read_b64 v[18:19], v5 offset:448
    v_add_f32 v16, v16, v112
    v_add_f32 v17, v17, v113
    v_add_f32 v16, v16, v114
    v_add_f32 v17, v17, v115
    v_cvt_pk_bf16_f32 v48, v112, v113
    v_cvt_pk_bf16_f32 v49, v114, v115
    s_waitcnt lgkmcnt(0)
    s_nop 1
    v_mfma_f32_16x16x16_bf16 v[8:11], v[18:19], v[48:49], v[8:11]
    v_fma_f32 v116, v116, s40, -v14
    v_fma_f32 v117, v117, s40, -v14
    v_fma_f32 v118, v118, s40, -v14
    v_fma_f32 v119, v119, s40, -v14
    v_exp_f32 v116, v116
    v_exp_f32 v117, v117
    v_exp_f32 v118, v118
    v_exp_f32 v119, v119
    ds_read_b64 v[54:55], v5 offset:480
    v_add_f32 v16, v16, v116
    v_add_f32 v17, v17, v117
    v_add_f32 v16, v16, v118
    v_add_f32 v17, v17, v119
    v_cvt_pk_bf16_f32 v50, v116, v117
    v_cvt_pk_bf16_f32 v51, v118, v119
    s_waitcnt lgkmcnt(0)
    s_nop 1
    v_mfma_f32_16x16x16_bf16 v[8:11], v[54:55], v[50:51], v[8:11]
    v_fma_f32 v120, v120, s40, -v14
    v_fma_f32 v121, v121, s40, -v14
    v_fma_f32 v122, v122, s40, -v14
    v_fma_f32 v123, v123, s40, -v14
    v_exp_f32 v120, v120
    v_exp_f32 v121, v121
    v_exp_f32 v122, v122
    v_exp_f32 v123, v123
    ds_read_b64 v[18:19], v5 offset:512
    v_add_f32 v16, v16, v120
    v_add_f32 v17, v17, v121
    v_add_f32 v16, v16, v122
    v_add_f32 v17, v17, v123
    v_cvt_pk_bf16_f32 v52, v120, v121
    v_cvt_pk_bf16_f32 v53, v122, v123
    s_waitcnt lgkmcnt(0)
    s_nop 1
    v_mfma_f32_16x16x16_bf16 v[8:11], v[18:19], v[52:53], v[8:11]
    s_lshl_b32 s41, s2, 8
    v_add_u32 v124, s41, v0
    v_lshlrev_b32 v124, 4, v124
    s_mov_b32 s46, 8388608
    s_mov_b32 s47, 0x00020000
    s_mov_b32 s50, 1835008
    s_mov_b32 s51, 0x00020000
    s_mov_b32 s54, 524288
    s_mov_b32 s55, 0x00020000
    s_mov_b32 s58, 917504
    s_mov_b32 s59, 0x00020000
    s_mov_b32 s41, 0x400000
    buffer_load_dwordx4 v[124:127], v124, s[44:47], 0 offen
    buffer_load_dwordx4 v[124:127], v124, s[44:47], s41 offen
    buffer_load_dwordx4 v[124:127], v124, s[48:51], 0 offen
    buffer_load_dwordx4 v[124:127], v124, s[52:55], 0 offen
    buffer_load_dwordx4 v[124:127], v124, s[56:59], 0 offen
    v_add_f32 v16, v16, v17
    v_mov_b32 v15, v16
    s_nop 1
    v_permlane32_swap_b32 v15, v16
    v_add_f32 v16, v16, v15
    v_mov_b32 v15, v16
    s_nop 1
    v_permlane16_swap_b32 v15, v16
    v_add_f32 v16, v16, v15
    v_rcp_f32 v16, v16
    s_nop 7
    v_mul_f32 v8, v8, v16
    v_mul_f32 v9, v9, v16
    v_mul_f32 v10, v10, v16
    v_mul_f32 v11, v11, v16
    v_cvt_pk_bf16_f32 v8, v8, v9
    v_cvt_pk_bf16_f32 v9, v10, v11
    v_lshlrev_b32 v4, 10, v2
    v_lshl_add_u32 v4, v3, 3, v4
    s_lshl_b32 s30, s29, 10
    s_lshl_b32 s31, s25, 5
    s_add_u32 s30, s30, s31
    buffer_store_dwordx2 v[8:9], v4, s[16:19], s30 offen
L_end_3:
    s_endpgm
.globl k3_wo_kernel
.p2align 8
.type k3_wo_kernel,@function
k3_wo_kernel:
    s_cmp_ge_u32 s2, 256
    s_cbranch_scc1 L_end_26
    s_load_dwordx2 s[4:5], s[0:1], 80
    s_load_dwordx2 s[8:9], s[0:1], 16
    s_load_dwordx2 s[12:13], s[0:1], 80
    s_load_dwordx2 s[16:17], s[0:1], 0
    s_and_b32 s24, s2, 31
    s_lshr_b32 s25, s2, 5
    s_mul_i32 s26, s24, 64
    s_mul_i32 s27, s25, 64
    v_and_b32 v1, 63, v0
    v_lshrrev_b32 v2, 6, v0
    s_nop 0
    v_readfirstlane_b32 s28, v2
    s_waitcnt lgkmcnt(0)
    s_add_u32 s4, s4, 0x600000
    s_addc_u32 s5, s5, 0
    s_mov_b32 s6, 0x200000
    s_mov_b32 s7, 0x00020000
    s_mov_b32 s10, 0x80000
    s_mov_b32 s11, 0x00020000
    s_add_u32 s12, s12, 0x800000
    s_addc_u32 s13, s13, 0
    s_mov_b32 s14, 0x200000
    s_mov_b32 s15, 0x00020000
    s_mov_b32 s18, 0x200000
    s_mov_b32 s19, 0x00020000
    s_and_b32 s29, s28, 1
    s_lshr_b32 s30, s28, 1
    v_lshrrev_b32 v5, 3, v1
    v_lshrrev_b32 v6, 4, v1
    s_lshl_b32 s31, s29, 2
    v_add_u32 v7, s31, v6
    v_and_b32 v7, 7, v7
    v_and_b32 v8, 7, v1
    v_xor_b32 v7, v7, v8
    v_mul_u32_u24 v3, 1024, v5
    v_lshl_add_u32 v3, v7, 4, v3
    v_bfe_u32 v7, v1, 4, 1
    v_lshlrev_b32 v7, 2, v7
    v_xor_b32 v7, v7, v8
    v_mul_u32_u24 v4, 1024, v5
    v_lshl_add_u32 v4, v7, 4, v4
    s_lshl_b32 s31, s28, 3
    s_add_u32 s31, s31, s26
    s_mul_i32 s32, s31, 1024
    s_add_u32 s33, s32, 32768
    s_mul_i32 s36, s28, 8192
    s_lshl_b32 s31, s27, 1
    s_add_u32 s36, s36, s31
    s_add_u32 s37, s36, 32768
    s_lshl_b32 s45, s28, 10
    v_and_b32 v9, 31, v1
    s_mul_i32 s31, s29, 32
    v_add_u32 v9, s31, v9
    v_lshrrev_b32 v14, 5, v1
    v_bfe_u32 v15, v1, 1, 3
    v_xor_b32 v15, v15, v14
    v_lshlrev_b32 v16, 7, v9
    v_xor_b32 v17, 0, v15
    v_lshl_add_u32 v10, v17, 4, v16
    v_xor_b32 v17, 2, v15
    v_lshl_add_u32 v11, v17, 4, v16
    v_xor_b32 v17, 4, v15
    v_lshl_add_u32 v12, v17, 4, v16
    v_xor_b32 v17, 6, v15
    v_lshl_add_u32 v13, v17, 4, v16
    v_bfe_u32 v15, v1, 2, 2
    v_lshl_add_u32 v16, v14, 3, v15
    v_mul_u32_u24 v16, 128, v16
    v_bfe_u32 v17, v1, 4, 1
    v_lshlrev_b32 v17, 1, v17
    v_bfe_u32 v18, v1, 1, 1
    v_add_u32 v17, v17, v18
    s_mul_i32 s31, s30, 4
    v_add_u32 v17, s31, v17
    v_bfe_u32 v15, v1, 3, 1
    v_lshlrev_b32 v15, 2, v15
    v_and_b32 v18, 1, v1
    v_lshl_add_u32 v16, v18, 3, v16
    v_add_u32 v16, 8192, v16
    v_add_u32 v18, 0, v17
    v_xor_b32 v18, v18, v15
    v_lshl_add_u32 v20, v18, 4, v16
    v_mov_b32 v64, 0
    v_mov_b32 v65, 0
    v_mov_b32 v66, 0
    v_mov_b32 v67, 0
    v_mov_b32 v68, 0
    v_mov_b32 v69, 0
    v_mov_b32 v70, 0
    v_mov_b32 v71, 0
    v_mov_b32 v72, 0
    v_mov_b32 v73, 0
    v_mov_b32 v74, 0
    v_mov_b32 v75, 0
    v_mov_b32 v76, 0
    v_mov_b32 v77, 0
    v_mov_b32 v78, 0
    v_mov_b32 v79, 0
    s_add_u32 m0, s45, 0
    s_add_u32 s46, s32, 0
    buffer_load_dwordx4 v3, s[4:7], s46 offen lds
    s_add_u32 m0, s45, 4096
    s_add_u32 s46, s33, 0
    buffer_load_dwordx4 v3, s[4:7], s46 offen lds
    s_add_u32 m0, s45, 8192
    s_add_u32 s46, s36, 0
    buffer_load_dwordx4 v4, s[8:11], s46 offen lds
    s_add_u32 m0, s45, 12288
    s_add_u32 s46, s37, 0
    buffer_load_dwordx4 v4, s[8:11], s46 offen lds
    s_add_u32 m0, s45, 16384
    s_add_u32 s46, s32, 128
    buffer_load_dwordx4 v3, s[4:7], s46 offen lds
    s_add_u32 m0, s45, 20480
    s_add_u32 s46, s33, 128
    buffer_load_dwordx4 v3, s[4:7], s46 offen lds
    s_add_u32 m0, s45, 24576
    s_add_u32 s46, s36, 65536
    buffer_load_dwordx4 v4, s[8:11], s46 offen lds
    s_add_u32 m0, s45, 28672
    s_add_u32 s46, s37, 65536
    buffer_load_dwordx4 v4, s[8:11], s46 offen lds
    s_add_u32 m0, s45, 32768
    s_add_u32 s46, s32, 256
    buffer_load_dwordx4 v3, s[4:7], s46 offen lds
    s_add_u32 m0, s45, 36864
    s_add_u32 s46, s33, 256
    buffer_load_dwordx4 v3, s[4:7], s46 offen lds
    s_add_u32 m0, s45, 40960
    s_add_u32 s46, s36, 131072
    buffer_load_dwordx4 v4, s[8:11], s46 offen lds
    s_add_u32 m0, s45, 45056
    s_add_u32 s46, s37, 131072
    buffer_load_dwordx4 v4, s[8:11], s46 offen lds
    s_add_u32 m0, s45, 49152
    s_add_u32 s46, s32, 384
    buffer_load_dwordx4 v3, s[4:7], s46 offen lds
    s_add_u32 m0, s45, 53248
    s_add_u32 s46, s33, 384
    buffer_load_dwordx4 v3, s[4:7], s46 offen lds
    s_add_u32 m0, s45, 57344
    s_add_u32 s46, s36, 196608
    buffer_load_dwordx4 v4, s[8:11], s46 offen lds
    s_add_u32 m0, s45, 61440
    s_add_u32 s46, s37, 196608
    buffer_load_dwordx4 v4, s[8:11], s46 offen lds
    s_add_u32 m0, s45, 65536
    s_add_u32 s46, s32, 512
    buffer_load_dwordx4 v3, s[4:7], s46 offen lds
    s_add_u32 m0, s45, 69632
    s_add_u32 s46, s33, 512
    buffer_load_dwordx4 v3, s[4:7], s46 offen lds
    s_add_u32 m0, s45, 73728
    s_add_u32 s46, s36, 262144
    buffer_load_dwordx4 v4, s[8:11], s46 offen lds
    s_add_u32 m0, s45, 77824
    s_add_u32 s46, s37, 262144
    buffer_load_dwordx4 v4, s[8:11], s46 offen lds
    s_add_u32 m0, s45, 81920
    s_add_u32 s46, s32, 640
    buffer_load_dwordx4 v3, s[4:7], s46 offen lds
    s_add_u32 m0, s45, 86016
    s_add_u32 s46, s33, 640
    buffer_load_dwordx4 v3, s[4:7], s46 offen lds
    s_add_u32 m0, s45, 90112
    s_add_u32 s46, s36, 327680
    buffer_load_dwordx4 v4, s[8:11], s46 offen lds
    s_add_u32 m0, s45, 94208
    s_add_u32 s46, s37, 327680
    buffer_load_dwordx4 v4, s[8:11], s46 offen lds
    s_add_u32 m0, s45, 98304
    s_add_u32 s46, s32, 768
    buffer_load_dwordx4 v3, s[4:7], s46 offen lds
    s_add_u32 m0, s45, 102400
    s_add_u32 s46, s33, 768
    buffer_load_dwordx4 v3, s[4:7], s46 offen lds
    s_add_u32 m0, s45, 106496
    s_add_u32 s46, s36, 393216
    buffer_load_dwordx4 v4, s[8:11], s46 offen lds
    s_add_u32 m0, s45, 110592
    s_add_u32 s46, s37, 393216
    buffer_load_dwordx4 v4, s[8:11], s46 offen lds
    s_waitcnt vmcnt(24) lgkmcnt(0)
    s_barrier
    v_add_u32 v22, 0, v10
    v_add_u32 v23, 0, v11
    v_add_u32 v24, 0, v12
    v_add_u32 v25, 0, v13
    v_add_u32 v26, 0, v20
    ds_read_b128 v[32:35], v22 offset:0
    ds_read_b64_tr_b16 v[40:41], v26 offset:0
    ds_read_b64_tr_b16 v[42:43], v26 offset:512
    ds_read_b128 v[48:51], v23 offset:0
    ds_read_b64_tr_b16 v[56:57], v26 offset:2048
    ds_read_b64_tr_b16 v[58:59], v26 offset:2560
    s_waitcnt lgkmcnt(3)
    v_mfma_f32_32x32x16_bf16 v[64:79], v[40:43], v[32:35], v[64:79]
    s_add_u32 m0, s45, 114688
    s_add_u32 s46, s32, 896
    buffer_load_dwordx4 v3, s[4:7], s46 offen lds
    ds_read_b128 v[32:35], v24 offset:0
    ds_read_b64_tr_b16 v[40:41], v26 offset:4096
    ds_read_b64_tr_b16 v[42:43], v26 offset:4608
    s_waitcnt lgkmcnt(3)
    v_mfma_f32_32x32x16_bf16 v[64:79], v[56:59], v[48:51], v[64:79]
    s_add_u32 m0, s45, 118784
    s_add_u32 s46, s33, 896
    buffer_load_dwordx4 v3, s[4:7], s46 offen lds
    ds_read_b128 v[48:51], v25 offset:0
    ds_read_b64_tr_b16 v[56:57], v26 offset:6144
    ds_read_b64_tr_b16 v[58:59], v26 offset:6656
    s_waitcnt lgkmcnt(3)
    v_mfma_f32_32x32x16_bf16 v[64:79], v[40:43], v[32:35], v[64:79]
    s_add_u32 m0, s45, 122880
    s_add_u32 s46, s36, 458752
    buffer_load_dwordx4 v4, s[8:11], s46 offen lds
    s_waitcnt lgkmcnt(0)
    v_mfma_f32_32x32x16_bf16 v[64:79], v[56:59], v[48:51], v[64:79]
    s_add_u32 m0, s45, 126976
    s_add_u32 s46, s37, 458752
    buffer_load_dwordx4 v4, s[8:11], s46 offen lds
    s_waitcnt vmcnt(24) lgkmcnt(0)
    s_barrier
    v_add_u32 v22, 16384, v10
    v_add_u32 v23, 16384, v11
    v_add_u32 v24, 16384, v12
    v_add_u32 v25, 16384, v13
    v_add_u32 v26, 16384, v20
    ds_read_b128 v[32:35], v22 offset:0
    ds_read_b64_tr_b16 v[40:41], v26 offset:0
    ds_read_b64_tr_b16 v[42:43], v26 offset:512
    ds_read_b128 v[48:51], v23 offset:0
    ds_read_b64_tr_b16 v[56:57], v26 offset:2048
    ds_read_b64_tr_b16 v[58:59], v26 offset:2560
    s_waitcnt lgkmcnt(3)
    v_mfma_f32_32x32x16_bf16 v[64:79], v[40:43], v[32:35], v[64:79]
    ds_read_b128 v[32:35], v24 offset:0
    ds_read_b64_tr_b16 v[40:41], v26 offset:4096
    ds_read_b64_tr_b16 v[42:43], v26 offset:4608
    s_waitcnt lgkmcnt(3)
    v_mfma_f32_32x32x16_bf16 v[64:79], v[56:59], v[48:51], v[64:79]
    ds_read_b128 v[48:51], v25 offset:0
    ds_read_b64_tr_b16 v[56:57], v26 offset:6144
    ds_read_b64_tr_b16 v[58:59], v26 offset:6656
    s_waitcnt lgkmcnt(3)
    v_mfma_f32_32x32x16_bf16 v[64:79], v[40:43], v[32:35], v[64:79]
    s_waitcnt lgkmcnt(0)
    v_mfma_f32_32x32x16_bf16 v[64:79], v[56:59], v[48:51], v[64:79]
    s_waitcnt vmcnt(20) lgkmcnt(0)
    s_barrier
    v_add_u32 v22, 32768, v10
    v_add_u32 v23, 32768, v11
    v_add_u32 v24, 32768, v12
    v_add_u32 v25, 32768, v13
    v_add_u32 v26, 32768, v20
    ds_read_b128 v[32:35], v22 offset:0
    ds_read_b64_tr_b16 v[40:41], v26 offset:0
    ds_read_b64_tr_b16 v[42:43], v26 offset:512
    ds_read_b128 v[48:51], v23 offset:0
    ds_read_b64_tr_b16 v[56:57], v26 offset:2048
    ds_read_b64_tr_b16 v[58:59], v26 offset:2560
    s_waitcnt lgkmcnt(3)
    v_mfma_f32_32x32x16_bf16 v[64:79], v[40:43], v[32:35], v[64:79]
    ds_read_b128 v[32:35], v24 offset:0
    ds_read_b64_tr_b16 v[40:41], v26 offset:4096
    ds_read_b64_tr_b16 v[42:43], v26 offset:4608
    s_waitcnt lgkmcnt(3)
    v_mfma_f32_32x32x16_bf16 v[64:79], v[56:59], v[48:51], v[64:79]
    ds_read_b128 v[48:51], v25 offset:0
    ds_read_b64_tr_b16 v[56:57], v26 offset:6144
    ds_read_b64_tr_b16 v[58:59], v26 offset:6656
    s_waitcnt lgkmcnt(3)
    v_mfma_f32_32x32x16_bf16 v[64:79], v[40:43], v[32:35], v[64:79]
    s_waitcnt lgkmcnt(0)
    v_mfma_f32_32x32x16_bf16 v[64:79], v[56:59], v[48:51], v[64:79]
    s_waitcnt vmcnt(16) lgkmcnt(0)
    s_barrier
    v_add_u32 v22, 49152, v10
    v_add_u32 v23, 49152, v11
    v_add_u32 v24, 49152, v12
    v_add_u32 v25, 49152, v13
    v_add_u32 v26, 49152, v20
    ds_read_b128 v[32:35], v22 offset:0
    ds_read_b64_tr_b16 v[40:41], v26 offset:0
    ds_read_b64_tr_b16 v[42:43], v26 offset:512
    ds_read_b128 v[48:51], v23 offset:0
    ds_read_b64_tr_b16 v[56:57], v26 offset:2048
    ds_read_b64_tr_b16 v[58:59], v26 offset:2560
    s_waitcnt lgkmcnt(3)
    v_mfma_f32_32x32x16_bf16 v[64:79], v[40:43], v[32:35], v[64:79]
    ds_read_b128 v[32:35], v24 offset:0
    ds_read_b64_tr_b16 v[40:41], v26 offset:4096
    ds_read_b64_tr_b16 v[42:43], v26 offset:4608
    s_waitcnt lgkmcnt(3)
    v_mfma_f32_32x32x16_bf16 v[64:79], v[56:59], v[48:51], v[64:79]
    ds_read_b128 v[48:51], v25 offset:0
    ds_read_b64_tr_b16 v[56:57], v26 offset:6144
    ds_read_b64_tr_b16 v[58:59], v26 offset:6656
    s_waitcnt lgkmcnt(3)
    v_mfma_f32_32x32x16_bf16 v[64:79], v[40:43], v[32:35], v[64:79]
    s_waitcnt lgkmcnt(0)
    v_mfma_f32_32x32x16_bf16 v[64:79], v[56:59], v[48:51], v[64:79]
    s_waitcnt vmcnt(12) lgkmcnt(0)
    s_barrier
    v_add_u32 v22, 65536, v10
    v_add_u32 v23, 65536, v11
    v_add_u32 v24, 65536, v12
    v_add_u32 v25, 65536, v13
    v_add_u32 v26, 65536, v20
    ds_read_b128 v[32:35], v22 offset:0
    ds_read_b64_tr_b16 v[40:41], v26 offset:0
    ds_read_b64_tr_b16 v[42:43], v26 offset:512
    ds_read_b128 v[48:51], v23 offset:0
    ds_read_b64_tr_b16 v[56:57], v26 offset:2048
    ds_read_b64_tr_b16 v[58:59], v26 offset:2560
    s_waitcnt lgkmcnt(3)
    v_mfma_f32_32x32x16_bf16 v[64:79], v[40:43], v[32:35], v[64:79]
    ds_read_b128 v[32:35], v24 offset:0
    ds_read_b64_tr_b16 v[40:41], v26 offset:4096
    ds_read_b64_tr_b16 v[42:43], v26 offset:4608
    s_waitcnt lgkmcnt(3)
    v_mfma_f32_32x32x16_bf16 v[64:79], v[56:59], v[48:51], v[64:79]
    ds_read_b128 v[48:51], v25 offset:0
    ds_read_b64_tr_b16 v[56:57], v26 offset:6144
    ds_read_b64_tr_b16 v[58:59], v26 offset:6656
    s_waitcnt lgkmcnt(3)
    v_mfma_f32_32x32x16_bf16 v[64:79], v[40:43], v[32:35], v[64:79]
    s_waitcnt lgkmcnt(0)
    v_mfma_f32_32x32x16_bf16 v[64:79], v[56:59], v[48:51], v[64:79]
    s_waitcnt vmcnt(8) lgkmcnt(0)
    s_barrier
    v_add_u32 v22, 81920, v10
    v_add_u32 v23, 81920, v11
    v_add_u32 v24, 81920, v12
    v_add_u32 v25, 81920, v13
    v_add_u32 v26, 81920, v20
    ds_read_b128 v[32:35], v22 offset:0
    ds_read_b64_tr_b16 v[40:41], v26 offset:0
    ds_read_b64_tr_b16 v[42:43], v26 offset:512
    ds_read_b128 v[48:51], v23 offset:0
    ds_read_b64_tr_b16 v[56:57], v26 offset:2048
    ds_read_b64_tr_b16 v[58:59], v26 offset:2560
    s_waitcnt lgkmcnt(3)
    v_mfma_f32_32x32x16_bf16 v[64:79], v[40:43], v[32:35], v[64:79]
    ds_read_b128 v[32:35], v24 offset:0
    ds_read_b64_tr_b16 v[40:41], v26 offset:4096
    ds_read_b64_tr_b16 v[42:43], v26 offset:4608
    s_waitcnt lgkmcnt(3)
    v_mfma_f32_32x32x16_bf16 v[64:79], v[56:59], v[48:51], v[64:79]
    ds_read_b128 v[48:51], v25 offset:0
    ds_read_b64_tr_b16 v[56:57], v26 offset:6144
    ds_read_b64_tr_b16 v[58:59], v26 offset:6656
    s_waitcnt lgkmcnt(3)
    v_mfma_f32_32x32x16_bf16 v[64:79], v[40:43], v[32:35], v[64:79]
    s_waitcnt lgkmcnt(0)
    v_mfma_f32_32x32x16_bf16 v[64:79], v[56:59], v[48:51], v[64:79]
    s_waitcnt vmcnt(4) lgkmcnt(0)
    s_barrier
    v_add_u32 v22, 98304, v10
    v_add_u32 v23, 98304, v11
    v_add_u32 v24, 98304, v12
    v_add_u32 v25, 98304, v13
    v_add_u32 v26, 98304, v20
    ds_read_b128 v[32:35], v22 offset:0
    ds_read_b64_tr_b16 v[40:41], v26 offset:0
    ds_read_b64_tr_b16 v[42:43], v26 offset:512
    ds_read_b128 v[48:51], v23 offset:0
    ds_read_b64_tr_b16 v[56:57], v26 offset:2048
    ds_read_b64_tr_b16 v[58:59], v26 offset:2560
    s_waitcnt lgkmcnt(3)
    v_mfma_f32_32x32x16_bf16 v[64:79], v[40:43], v[32:35], v[64:79]
    ds_read_b128 v[32:35], v24 offset:0
    ds_read_b64_tr_b16 v[40:41], v26 offset:4096
    ds_read_b64_tr_b16 v[42:43], v26 offset:4608
    s_waitcnt lgkmcnt(3)
    v_mfma_f32_32x32x16_bf16 v[64:79], v[56:59], v[48:51], v[64:79]
    ds_read_b128 v[48:51], v25 offset:0
    ds_read_b64_tr_b16 v[56:57], v26 offset:6144
    ds_read_b64_tr_b16 v[58:59], v26 offset:6656
    s_waitcnt lgkmcnt(3)
    v_mfma_f32_32x32x16_bf16 v[64:79], v[40:43], v[32:35], v[64:79]
    s_waitcnt lgkmcnt(0)
    v_mfma_f32_32x32x16_bf16 v[64:79], v[56:59], v[48:51], v[64:79]
    s_waitcnt vmcnt(0) lgkmcnt(0)
    s_barrier
    v_mul_u32_u24 v18, 1024, v9
    v_lshl_add_u32 v18, v14, 3, v18
    s_mul_i32 s31, s30, 64
    v_add_u32 v18, s31, v18
    s_mul_i32 s43, s26, 1024
    s_lshl_b32 s42, s27, 1
    s_add_u32 s43, s43, s42
    s_add_u32 s44, s43, 0
    buffer_load_dwordx2 v[96:97], v18, s[16:19], s44 offen offset:0
    buffer_load_dwordx2 v[98:99], v18, s[16:19], s44 offen offset:16
    buffer_load_dwordx2 v[100:101], v18, s[16:19], s44 offen offset:32
    buffer_load_dwordx2 v[102:103], v18, s[16:19], s44 offen offset:48
    v_add_u32 v22, 114688, v10
    v_add_u32 v23, 114688, v11
    v_add_u32 v24, 114688, v12
    v_add_u32 v25, 114688, v13
    v_add_u32 v26, 114688, v20
    ds_read_b128 v[32:35], v22 offset:0
    ds_read_b64_tr_b16 v[40:41], v26 offset:0
    ds_read_b64_tr_b16 v[42:43], v26 offset:512
    ds_read_b128 v[48:51], v23 offset:0
    ds_read_b64_tr_b16 v[56:57], v26 offset:2048
    ds_read_b64_tr_b16 v[58:59], v26 offset:2560
    s_waitcnt lgkmcnt(3)
    v_mfma_f32_32x32x16_bf16 v[64:79], v[40:43], v[32:35], v[64:79]
    ds_read_b128 v[32:35], v24 offset:0
    ds_read_b64_tr_b16 v[40:41], v26 offset:4096
    ds_read_b64_tr_b16 v[42:43], v26 offset:4608
    s_waitcnt lgkmcnt(3)
    v_mfma_f32_32x32x16_bf16 v[64:79], v[56:59], v[48:51], v[64:79]
    ds_read_b128 v[48:51], v25 offset:0
    ds_read_b64_tr_b16 v[56:57], v26 offset:6144
    ds_read_b64_tr_b16 v[58:59], v26 offset:6656
    s_waitcnt lgkmcnt(3)
    v_mfma_f32_32x32x16_bf16 v[64:79], v[40:43], v[32:35], v[64:79]
    s_waitcnt lgkmcnt(0)
    v_mfma_f32_32x32x16_bf16 v[64:79], v[56:59], v[48:51], v[64:79]
    s_nop 15
    v_mul_u32_u24 v17, 1024, v9
    v_lshl_add_u32 v17, v14, 3, v17
    s_mul_i32 s31, s30, 64
    v_add_u32 v17, s31, v17
    s_mul_i32 s41, s26, 1024
    s_lshl_b32 s42, s27, 1
    s_add_u32 s41, s41, s42
    s_waitcnt vmcnt(0)
    s_add_u32 s42, s41, 0
    v_cvt_pk_bf16_f32 v28, v64, v65
    v_cvt_pk_bf16_f32 v29, v66, v67
    v_lshlrev_b32 v48, 16, v28
    v_and_b32 v49, 0xffff0000, v28
    v_lshlrev_b32 v50, 16, v29
    v_and_b32 v51, 0xffff0000, v29
    v_lshlrev_b32 v52, 16, v96
    v_and_b32 v53, 0xffff0000, v96
    v_lshlrev_b32 v54, 16, v97
    v_and_b32 v55, 0xffff0000, v97
    v_add_f32 v48, v48, v52
    v_add_f32 v49, v49, v53
    v_add_f32 v50, v50, v54
    v_add_f32 v51, v51, v55
    v_cvt_pk_bf16_f32 v28, v48, v49
    v_cvt_pk_bf16_f32 v29, v50, v51
    buffer_store_dwordx2 v[28:29], v17, s[12:15], s42 offen offset:0
    s_nop 1
    v_cvt_pk_bf16_f32 v28, v68, v69
    v_cvt_pk_bf16_f32 v29, v70, v71
    v_lshlrev_b32 v48, 16, v28
    v_and_b32 v49, 0xffff0000, v28
    v_lshlrev_b32 v50, 16, v29
    v_and_b32 v51, 0xffff0000, v29
    v_lshlrev_b32 v52, 16, v98
    v_and_b32 v53, 0xffff0000, v98
    v_lshlrev_b32 v54, 16, v99
    v_and_b32 v55, 0xffff0000, v99
    v_add_f32 v48, v48, v52
    v_add_f32 v49, v49, v53
    v_add_f32 v50, v50, v54
    v_add_f32 v51, v51, v55
    v_cvt_pk_bf16_f32 v28, v48, v49
    v_cvt_pk_bf16_f32 v29, v50, v51
    buffer_store_dwordx2 v[28:29], v17, s[12:15], s42 offen offset:16
    s_nop 1
    v_cvt_pk_bf16_f32 v28, v72, v73
    v_cvt_pk_bf16_f32 v29, v74, v75
    v_lshlrev_b32 v48, 16, v28
    v_and_b32 v49, 0xffff0000, v28
    v_lshlrev_b32 v50, 16, v29
    v_and_b32 v51, 0xffff0000, v29
    v_lshlrev_b32 v52, 16, v100
    v_and_b32 v53, 0xffff0000, v100
    v_lshlrev_b32 v54, 16, v101
    v_and_b32 v55, 0xffff0000, v101
    v_add_f32 v48, v48, v52
    v_add_f32 v49, v49, v53
    v_add_f32 v50, v50, v54
    v_add_f32 v51, v51, v55
    v_cvt_pk_bf16_f32 v28, v48, v49
    v_cvt_pk_bf16_f32 v29, v50, v51
    buffer_store_dwordx2 v[28:29], v17, s[12:15], s42 offen offset:32
    s_nop 1
    v_cvt_pk_bf16_f32 v28, v76, v77
    v_cvt_pk_bf16_f32 v29, v78, v79
    v_lshlrev_b32 v48, 16, v28
    v_and_b32 v49, 0xffff0000, v28
    v_lshlrev_b32 v50, 16, v29
    v_and_b32 v51, 0xffff0000, v29
    v_lshlrev_b32 v52, 16, v102
    v_and_b32 v53, 0xffff0000, v102
    v_lshlrev_b32 v54, 16, v103
    v_and_b32 v55, 0xffff0000, v103
    v_add_f32 v48, v48, v52
    v_add_f32 v49, v49, v53
    v_add_f32 v50, v50, v54
    v_add_f32 v51, v51, v55
    v_cvt_pk_bf16_f32 v28, v48, v49
    v_cvt_pk_bf16_f32 v29, v50, v51
    buffer_store_dwordx2 v[28:29], v17, s[12:15], s42 offen offset:48
    s_nop 1
L_end_26:
    s_endpgm
.globl k4_win_kernel
.p2align 8
.type k4_win_kernel,@function
k4_win_kernel:
    s_cmp_ge_u32 s2, 224
    s_cbranch_scc1 L_end_27
    s_load_dwordx2 s[4:5], s[0:1], 80
    s_load_dwordx2 s[8:9], s[0:1], 32
    s_load_dwordx2 s[12:13], s[0:1], 80
    s_and_b32 s24, s2, 15
    s_lshr_b32 s25, s2, 4
    s_mul_i32 s26, s24, 128
    s_mul_i32 s27, s25, 128
    v_and_b32 v1, 63, v0
    v_lshrrev_b32 v2, 6, v0
    s_nop 0
    v_readfirstlane_b32 s28, v2
    s_waitcnt lgkmcnt(0)
    s_add_u32 s4, s4, 0x800000
    s_addc_u32 s5, s5, 0
    s_mov_b32 s6, 0x200000
    s_mov_b32 s7, 0x00020000
    s_mov_b32 s10, 0x1c0000
    s_mov_b32 s11, 0x00020000
    s_add_u32 s12, s12, 0xa00000
    s_addc_u32 s13, s13, 0
    s_mov_b32 s14, 0x700000
    s_mov_b32 s15, 0x00020000
    s_and_b32 s29, s28, 1
    s_lshr_b32 s30, s28, 1
    v_lshrrev_b32 v5, 3, v1
    v_lshrrev_b32 v6, 4, v1
    s_lshl_b32 s31, s29, 2
    v_add_u32 v7, s31, v6
    v_and_b32 v7, 7, v7
    v_and_b32 v8, 7, v1
    v_xor_b32 v7, v7, v8
    v_mul_u32_u24 v3, 1024, v5
    v_lshl_add_u32 v3, v7, 4, v3
    v_and_b32 v8, 15, v1
    v_lshlrev_b32 v7, 2, v6
    v_xor_b32 v7, v7, v8
    v_mul_u32_u24 v4, 3584, v6
    v_lshl_add_u32 v4, v7, 4, v4
    s_lshl_b32 s31, s28, 3
    s_add_u32 s31, s31, s26
    s_mul_i32 s32, s31, 1024
    s_mul_i32 s36, s28, 14336
    s_lshl_b32 s31, s27, 1
    s_add_u32 s36, s36, s31
    s_add_u32 s37, s36, 114688
    s_lshl_b32 s45, s28, 10
    v_and_b32 v9, 31, v1
    s_mul_i32 s31, s29, 64
    v_add_u32 v9, s31, v9
    v_lshrrev_b32 v14, 5, v1
    v_bfe_u32 v15, v1, 1, 3
    v_xor_b32 v15, v15, v14
    v_lshlrev_b32 v16, 7, v9
    v_xor_b32 v17, 0, v15
    v_lshl_add_u32 v10, v17, 4, v16
    v_xor_b32 v17, 2, v15
    v_lshl_add_u32 v11, v17, 4, v16
    v_xor_b32 v17, 4, v15
    v_lshl_add_u32 v12, v17, 4, v16
    v_xor_b32 v17, 6, v15
    v_lshl_add_u32 v13, v17, 4, v16
    v_bfe_u32 v15, v1, 2, 2
    v_lshl_add_u32 v16, v14, 3, v15
    v_mul_u32_u24 v16, 256, v16
    v_bfe_u32 v17, v1, 4, 1
    v_lshlrev_b32 v17, 1, v17
    v_bfe_u32 v18, v1, 1, 1
    v_add_u32 v17, v17, v18
    s_mul_i32 s31, s30, 4
    v_add_u32 v17, s31, v17
    v_lshlrev_b32 v15, 2, v15
    v_and_b32 v18, 1, v1
    v_lshl_add_u32 v16, v18, 3, v16
    v_add_u32 v16, 16384, v16
    v_add_u32 v18, 0, v17
    v_xor_b32 v18, v18, v15
    v_lshl_add_u32 v20, v18, 4, v16
    v_mov_b32 v64, 0
    v_mov_b32 v65, 0
    v_mov_b32 v66, 0
    v_mov_b32 v67, 0
    v_mov_b32 v68, 0
    v_mov_b32 v69, 0
    v_mov_b32 v70, 0
    v_mov_b32 v71, 0
    v_mov_b32 v72, 0
    v_mov_b32 v73, 0
    v_mov_b32 v74, 0
    v_mov_b32 v75, 0
    v_mov_b32 v76, 0
    v_mov_b32 v77, 0
    v_mov_b32 v78, 0
    v_mov_b32 v79, 0
    v_mov_b32 v80, 0
    v_mov_b32 v81, 0
    v_mov_b32 v82, 0
    v_mov_b32 v83, 0
    v_mov_b32 v84, 0
    v_mov_b32 v85, 0
    v_mov_b32 v86, 0
    v_mov_b32 v87, 0
    v_mov_b32 v88, 0
    v_mov_b32 v89, 0
    v_mov_b32 v90, 0
    v_mov_b32 v91, 0
    v_mov_b32 v92, 0
    v_mov_b32 v93, 0
    v_mov_b32 v94, 0
    v_mov_b32 v95, 0
    s_add_u32 m0, s45, 16384
    s_add_u32 s46, s36, 0
    buffer_load_dwordx4 v4, s[8:11], s46 offen lds
    s_add_u32 m0, s45, 24576
    s_add_u32 s46, s37, 0
    buffer_load_dwordx4 v4, s[8:11], s46 offen lds
    s_add_u32 m0, s45, 49152
    s_add_u32 s46, s36, 229376
    buffer_load_dwordx4 v4, s[8:11], s46 offen lds
    s_add_u32 m0, s45, 57344
    s_add_u32 s46, s37, 229376
    buffer_load_dwordx4 v4, s[8:11], s46 offen lds
    s_add_u32 m0, s45, 81920
    s_add_u32 s46, s36, 458752
    buffer_load_dwordx4 v4, s[8:11], s46 offen lds
    s_add_u32 m0, s45, 90112
    s_add_u32 s46, s37, 458752
    buffer_load_dwordx4 v4, s[8:11], s46 offen lds
    s_add_u32 m0, s45, 114688
    s_add_u32 s46, s36, 688128
    buffer_load_dwordx4 v4, s[8:11], s46 offen lds
    s_add_u32 m0, s45, 122880
    s_add_u32 s46, s37, 688128
    buffer_load_dwordx4 v4, s[8:11], s46 offen lds
    v_lshrrev_b32 v30, 3, v0
    v_and_b32 v31, 7, v0
    v_mul_u32_u24 v5, 1024, v30
    v_lshl_add_u32 v5, v31, 4, v5
    s_mul_i32 s46, s26, 1024
    s_add_u32 s47, s46, 65536
    buffer_load_dwordx4 v[128:131], v5, s[4:7], s46 offen offset:0
    buffer_load_dwordx4 v[132:135], v5, s[4:7], s46 offen offset:128
    buffer_load_dwordx4 v[136:139], v5, s[4:7], s46 offen offset:256
    buffer_load_dwordx4 v[140:143], v5, s[4:7], s46 offen offset:384
    buffer_load_dwordx4 v[144:147], v5, s[4:7], s46 offen offset:512
    buffer_load_dwordx4 v[148:151], v5, s[4:7], s46 offen offset:640
    buffer_load_dwordx4 v[152:155], v5, s[4:7], s46 offen offset:768
    buffer_load_dwordx4 v[156:159], v5, s[4:7], s46 offen offset:896
    buffer_load_dwordx4 v[160:163], v5, s[4:7], s47 offen offset:0
    buffer_load_dwordx4 v[164:167], v5, s[4:7], s47 offen offset:128
    buffer_load_dwordx4 v[168:171], v5, s[4:7], s47 offen offset:256
    buffer_load_dwordx4 v[172:175], v5, s[4:7], s47 offen offset:384
    buffer_load_dwordx4 v[176:179], v5, s[4:7], s47 offen offset:512
    buffer_load_dwordx4 v[180:183], v5, s[4:7], s47 offen offset:640
    buffer_load_dwordx4 v[184:187], v5, s[4:7], s47 offen offset:768
    buffer_load_dwordx4 v[188:191], v5, s[4:7], s47 offen offset:896
    v_bfe_u32 v5, v0, 4, 3
    v_xor_b32 v31, v31, v5
    v_lshlrev_b32 v30, 7, v30
    v_lshl_add_u32 v30, v31, 4, v30
    v_mov_b32 v5, 0x3f803f80
    v_mov_b32 v32, 0
    v_mov_b32 v33, 0
    v_mov_b32 v34, 0
    v_mov_b32 v35, 0
    s_waitcnt vmcnt(15)
    v_dot2_f32_bf16 v32, v128, v5, v32
    v_dot2_f32_bf16 v33, v128, v128, v33
    v_dot2_f32_bf16 v32, v129, v5, v32
    v_dot2_f32_bf16 v33, v129, v129, v33
    v_dot2_f32_bf16 v32, v130, v5, v32
    v_dot2_f32_bf16 v33, v130, v130, v33
    v_dot2_f32_bf16 v32, v131, v5, v32
    v_dot2_f32_bf16 v33, v131, v131, v33
    s_waitcnt vmcnt(14)
    v_dot2_f32_bf16 v32, v132, v5, v32
    v_dot2_f32_bf16 v33, v132, v132, v33
    v_dot2_f32_bf16 v32, v133, v5, v32
    v_dot2_f32_bf16 v33, v133, v133, v33
    v_dot2_f32_bf16 v32, v134, v5, v32
    v_dot2_f32_bf16 v33, v134, v134, v33
    v_dot2_f32_bf16 v32, v135, v5, v32
    v_dot2_f32_bf16 v33, v135, v135, v33
    s_waitcnt vmcnt(13)
    v_dot2_f32_bf16 v32, v136, v5, v32
    v_dot2_f32_bf16 v33, v136, v136, v33
    v_dot2_f32_bf16 v32, v137, v5, v32
    v_dot2_f32_bf16 v33, v137, v137, v33
    v_dot2_f32_bf16 v32, v138, v5, v32
    v_dot2_f32_bf16 v33, v138, v138, v33
    v_dot2_f32_bf16 v32, v139, v5, v32
    v_dot2_f32_bf16 v33, v139, v139, v33
    s_waitcnt vmcnt(12)
    v_dot2_f32_bf16 v32, v140, v5, v32
    v_dot2_f32_bf16 v33, v140, v140, v33
    v_dot2_f32_bf16 v32, v141, v5, v32
    v_dot2_f32_bf16 v33, v141, v141, v33
    v_dot2_f32_bf16 v32, v142, v5, v32
    v_dot2_f32_bf16 v33, v142, v142, v33
    v_dot2_f32_bf16 v32, v143, v5, v32
    v_dot2_f32_bf16 v33, v143, v143, v33
    s_waitcnt vmcnt(11)
    v_dot2_f32_bf16 v32, v144, v5, v32
    v_dot2_f32_bf16 v33, v144, v144, v33
    v_dot2_f32_bf16 v32, v145, v5, v32
    v_dot2_f32_bf16 v33, v145, v145, v33
    v_dot2_f32_bf16 v32, v146, v5, v32
    v_dot2_f32_bf16 v33, v146, v146, v33
    v_dot2_f32_bf16 v32, v147, v5, v32
    v_dot2_f32_bf16 v33, v147, v147, v33
    s_waitcnt vmcnt(10)
    v_dot2_f32_bf16 v32, v148, v5, v32
    v_dot2_f32_bf16 v33, v148, v148, v33
    v_dot2_f32_bf16 v32, v149, v5, v32
    v_dot2_f32_bf16 v33, v149, v149, v33
    v_dot2_f32_bf16 v32, v150, v5, v32
    v_dot2_f32_bf16 v33, v150, v150, v33
    v_dot2_f32_bf16 v32, v151, v5, v32
    v_dot2_f32_bf16 v33, v151, v151, v33
    s_waitcnt vmcnt(9)
    v_dot2_f32_bf16 v32, v152, v5, v32
    v_dot2_f32_bf16 v33, v152, v152, v33
    v_dot2_f32_bf16 v32, v153, v5, v32
    v_dot2_f32_bf16 v33, v153, v153, v33
    v_dot2_f32_bf16 v32, v154, v5, v32
    v_dot2_f32_bf16 v33, v154, v154, v33
    v_dot2_f32_bf16 v32, v155, v5, v32
    v_dot2_f32_bf16 v33, v155, v155, v33
    s_waitcnt vmcnt(8)
    v_dot2_f32_bf16 v32, v156, v5, v32
    v_dot2_f32_bf16 v33, v156, v156, v33
    v_dot2_f32_bf16 v32, v157, v5, v32
    v_dot2_f32_bf16 v33, v157, v157, v33
    v_dot2_f32_bf16 v32, v158, v5, v32
    v_dot2_f32_bf16 v33, v158, v158, v33
    v_dot2_f32_bf16 v32, v159, v5, v32
    v_dot2_f32_bf16 v33, v159, v159, v33
    s_waitcnt vmcnt(7)
    v_dot2_f32_bf16 v34, v160, v5, v34
    v_dot2_f32_bf16 v35, v160, v160, v35
    v_dot2_f32_bf16 v34, v161, v5, v34
    v_dot2_f32_bf16 v35, v161, v161, v35
    v_dot2_f32_bf16 v34, v162, v5, v34
    v_dot2_f32_bf16 v35, v162, v162, v35
    v_dot2_f32_bf16 v34, v163, v5, v34
    v_dot2_f32_bf16 v35, v163, v163, v35
    s_waitcnt vmcnt(6)
    v_dot2_f32_bf16 v34, v164, v5, v34
    v_dot2_f32_bf16 v35, v164, v164, v35
    v_dot2_f32_bf16 v34, v165, v5, v34
    v_dot2_f32_bf16 v35, v165, v165, v35
    v_dot2_f32_bf16 v34, v166, v5, v34
    v_dot2_f32_bf16 v35, v166, v166, v35
    v_dot2_f32_bf16 v34, v167, v5, v34
    v_dot2_f32_bf16 v35, v167, v167, v35
    s_waitcnt vmcnt(5)
    v_dot2_f32_bf16 v34, v168, v5, v34
    v_dot2_f32_bf16 v35, v168, v168, v35
    v_dot2_f32_bf16 v34, v169, v5, v34
    v_dot2_f32_bf16 v35, v169, v169, v35
    v_dot2_f32_bf16 v34, v170, v5, v34
    v_dot2_f32_bf16 v35, v170, v170, v35
    v_dot2_f32_bf16 v34, v171, v5, v34
    v_dot2_f32_bf16 v35, v171, v171, v35
    s_waitcnt vmcnt(4)
    v_dot2_f32_bf16 v34, v172, v5, v34
    v_dot2_f32_bf16 v35, v172, v172, v35
    v_dot2_f32_bf16 v34, v173, v5, v34
    v_dot2_f32_bf16 v35, v173, v173, v35
    v_dot2_f32_bf16 v34, v174, v5, v34
    v_dot2_f32_bf16 v35, v174, v174, v35
    v_dot2_f32_bf16 v34, v175, v5, v34
    v_dot2_f32_bf16 v35, v175, v175, v35
    s_waitcnt vmcnt(3)
    v_dot2_f32_bf16 v34, v176, v5, v34
    v_dot2_f32_bf16 v35, v176, v176, v35
    v_dot2_f32_bf16 v34, v177, v5, v34
    v_dot2_f32_bf16 v35, v177, v177, v35
    v_dot2_f32_bf16 v34, v178, v5, v34
    v_dot2_f32_bf16 v35, v178, v178, v35
    v_dot2_f32_bf16 v34, v179, v5, v34
    v_dot2_f32_bf16 v35, v179, v179, v35
    s_waitcnt vmcnt(2)
    v_dot2_f32_bf16 v34, v180, v5, v34
    v_dot2_f32_bf16 v35, v180, v180, v35
    v_dot2_f32_bf16 v34, v181, v5, v34
    v_dot2_f32_bf16 v35, v181, v181, v35
    v_dot2_f32_bf16 v34, v182, v5, v34
    v_dot2_f32_bf16 v35, v182, v182, v35
    v_dot2_f32_bf16 v34, v183, v5, v34
    v_dot2_f32_bf16 v35, v183, v183, v35
    s_waitcnt vmcnt(1)
    v_dot2_f32_bf16 v34, v184, v5, v34
    v_dot2_f32_bf16 v35, v184, v184, v35
    v_dot2_f32_bf16 v34, v185, v5, v34
    v_dot2_f32_bf16 v35, v185, v185, v35
    v_dot2_f32_bf16 v34, v186, v5, v34
    v_dot2_f32_bf16 v35, v186, v186, v35
    v_dot2_f32_bf16 v34, v187, v5, v34
    v_dot2_f32_bf16 v35, v187, v187, v35
    s_waitcnt vmcnt(0)
    v_dot2_f32_bf16 v34, v188, v5, v34
    v_dot2_f32_bf16 v35, v188, v188, v35
    v_dot2_f32_bf16 v34, v189, v5, v34
    v_dot2_f32_bf16 v35, v189, v189, v35
    v_dot2_f32_bf16 v34, v190, v5, v34
    v_dot2_f32_bf16 v35, v190, v190, v35
    v_dot2_f32_bf16 v34, v191, v5, v34
    v_dot2_f32_bf16 v35, v191, v191, v35
    s_nop 3
    v_add_f32_dpp v32, v32, v32 quad_perm:[1,0,3,2] row_mask:0xf bank_mask:0xf
    v_add_f32_dpp v33, v33, v33 quad_perm:[1,0,3,2] row_mask:0xf bank_mask:0xf
    v_add_f32_dpp v34, v34, v34 quad_perm:[1,0,3,2] row_mask:0xf bank_mask:0xf
    v_add_f32_dpp v35, v35, v35 quad_perm:[1,0,3,2] row_mask:0xf bank_mask:0xf
    s_nop 1
    v_add_f32_dpp v32, v32, v32 quad_perm:[2,3,0,1] row_mask:0xf bank_mask:0xf
    v_add_f32_dpp v33, v33, v33 quad_perm:[2,3,0,1] row_mask:0xf bank_mask:0xf
    v_add_f32_dpp v34, v34, v34 quad_perm:[2,3,0,1] row_mask:0xf bank_mask:0xf
    v_add_f32_dpp v35, v35, v35 quad_perm:[2,3,0,1] row_mask:0xf bank_mask:0xf
    s_nop 1
    v_add_f32_dpp v32, v32, v32 row_half_mirror row_mask:0xf bank_mask:0xf
    v_add_f32_dpp v33, v33, v33 row_half_mirror row_mask:0xf bank_mask:0xf
    v_add_f32_dpp v34, v34, v34 row_half_mirror row_mask:0xf bank_mask:0xf
    v_add_f32_dpp v35, v35, v35 row_half_mirror row_mask:0xf bank_mask:0xf
    s_nop 1
    v_mul_f32 v32, 0x3b000000, v32
    v_mul_f32 v33, 0x3b000000, v33
    v_fma_f32 v33, -v32, v32, v33
    v_max_f32 v33, 0, v33
    v_cvt_pk_bf16_f32 v36, v32, v33
    v_lshlrev_b32 v32, 16, v36
    v_and_b32 v33, 0xffff0000, v36
    v_add_f32 v33, 0x3727c5ac, v33
    v_cvt_pk_bf16_f32 v36, v33, v33
    v_lshlrev_b32 v33, 16, v36
    v_sqrt_f32 v33, v33
    s_nop 0
    v_cvt_pk_bf16_f32 v36, v33, v33
    v_lshlrev_b32 v33, 16, v36
    v_rcp_f32 v33, v33
    s_nop 0
    v_mov_b32 v120, v32
    v_mov_b32 v121, v33
    v_mul_f32 v34, 0x3b000000, v34
    v_mul_f32 v35, 0x3b000000, v35
    v_fma_f32 v35, -v34, v34, v35
    v_max_f32 v35, 0, v35
    v_cvt_pk_bf16_f32 v36, v34, v35
    v_lshlrev_b32 v34, 16, v36
    v_and_b32 v35, 0xffff0000, v36
    v_add_f32 v35, 0x3727c5ac, v35
    v_cvt_pk_bf16_f32 v36, v35, v35
    v_lshlrev_b32 v35, 16, v36
    v_sqrt_f32 v35, v35
    s_nop 0
    v_cvt_pk_bf16_f32 v36, v35, v35
    v_lshlrev_b32 v35, 16, v36
    v_rcp_f32 v35, v35
    s_nop 0
    v_mov_b32 v122, v34
    v_mov_b32 v123, v35
    v_lshlrev_b32 v124, 16, v128
    v_and_b32 v125, 0xffff0000, v128
    v_sub_f32 v124, v124, v120
    v_sub_f32 v125, v125, v120
    v_cvt_pk_bf16_f32 v128, v124, v125
    v_lshlrev_b32 v124, 16, v128
    v_and_b32 v125, 0xffff0000, v128
    v_mul_f32 v124, v124, v121
    v_mul_f32 v125, v125, v121
    v_cvt_pk_bf16_f32 v128, v124, v125
    v_lshlrev_b32 v124, 16, v129
    v_and_b32 v125, 0xffff0000, v129
    v_sub_f32 v124, v124, v120
    v_sub_f32 v125, v125, v120
    v_cvt_pk_bf16_f32 v129, v124, v125
    v_lshlrev_b32 v124, 16, v129
    v_and_b32 v125, 0xffff0000, v129
    v_mul_f32 v124, v124, v121
    v_mul_f32 v125, v125, v121
    v_cvt_pk_bf16_f32 v129, v124, v125
    v_lshlrev_b32 v124, 16, v130
    v_and_b32 v125, 0xffff0000, v130
    v_sub_f32 v124, v124, v120
    v_sub_f32 v125, v125, v120
    v_cvt_pk_bf16_f32 v130, v124, v125
    v_lshlrev_b32 v124, 16, v130
    v_and_b32 v125, 0xffff0000, v130
    v_mul_f32 v124, v124, v121
    v_mul_f32 v125, v125, v121
    v_cvt_pk_bf16_f32 v130, v124, v125
    v_lshlrev_b32 v124, 16, v131
    v_and_b32 v125, 0xffff0000, v131
    v_sub_f32 v124, v124, v120
    v_sub_f32 v125, v125, v120
    v_cvt_pk_bf16_f32 v131, v124, v125
    v_lshlrev_b32 v124, 16, v131
    v_and_b32 v125, 0xffff0000, v131
    v_mul_f32 v124, v124, v121
    v_mul_f32 v125, v125, v121
    v_cvt_pk_bf16_f32 v131, v124, v125
    v_add_u32 v31, 0, v30
    ds_write_b128 v31, v[128:131]
    v_lshlrev_b32 v124, 16, v160
    v_and_b32 v125, 0xffff0000, v160
    v_sub_f32 v124, v124, v122
    v_sub_f32 v125, v125, v122
    v_cvt_pk_bf16_f32 v160, v124, v125
    v_lshlrev_b32 v124, 16, v160
    v_and_b32 v125, 0xffff0000, v160
    v_mul_f32 v124, v124, v123
    v_mul_f32 v125, v125, v123
    v_cvt_pk_bf16_f32 v160, v124, v125
    v_lshlrev_b32 v124, 16, v161
    v_and_b32 v125, 0xffff0000, v161
    v_sub_f32 v124, v124, v122
    v_sub_f32 v125, v125, v122
    v_cvt_pk_bf16_f32 v161, v124, v125
    v_lshlrev_b32 v124, 16, v161
    v_and_b32 v125, 0xffff0000, v161
    v_mul_f32 v124, v124, v123
    v_mul_f32 v125, v125, v123
    v_cvt_pk_bf16_f32 v161, v124, v125
    v_lshlrev_b32 v124, 16, v162
    v_and_b32 v125, 0xffff0000, v162
    v_sub_f32 v124, v124, v122
    v_sub_f32 v125, v125, v122
    v_cvt_pk_bf16_f32 v162, v124, v125
    v_lshlrev_b32 v124, 16, v162
    v_and_b32 v125, 0xffff0000, v162
    v_mul_f32 v124, v124, v123
    v_mul_f32 v125, v125, v123
    v_cvt_pk_bf16_f32 v162, v124, v125
    v_lshlrev_b32 v124, 16, v163
    v_and_b32 v125, 0xffff0000, v163
    v_sub_f32 v124, v124, v122
    v_sub_f32 v125, v125, v122
    v_cvt_pk_bf16_f32 v163, v124, v125
    v_lshlrev_b32 v124, 16, v163
    v_and_b32 v125, 0xffff0000, v163
    v_mul_f32 v124, v124, v123
    v_mul_f32 v125, v125, v123
    v_cvt_pk_bf16_f32 v163, v124, v125
    v_add_u32 v31, 8192, v30
    ds_write_b128 v31, v[160:163]
    v_lshlrev_b32 v124, 16, v132
    v_and_b32 v125, 0xffff0000, v132
    v_sub_f32 v124, v124, v120
    v_sub_f32 v125, v125, v120
    v_cvt_pk_bf16_f32 v132, v124, v125
    v_lshlrev_b32 v124, 16, v132
    v_and_b32 v125, 0xffff0000, v132
    v_mul_f32 v124, v124, v121
    v_mul_f32 v125, v125, v121
    v_cvt_pk_bf16_f32 v132, v124, v125
    v_lshlrev_b32 v124, 16, v133
    v_and_b32 v125, 0xffff0000, v133
    v_sub_f32 v124, v124, v120
    v_sub_f32 v125, v125, v120
    v_cvt_pk_bf16_f32 v133, v124, v125
    v_lshlrev_b32 v124, 16, v133
    v_and_b32 v125, 0xffff0000, v133
    v_mul_f32 v124, v124, v121
    v_mul_f32 v125, v125, v121
    v_cvt_pk_bf16_f32 v133, v124, v125
    v_lshlrev_b32 v124, 16, v134
    v_and_b32 v125, 0xffff0000, v134
    v_sub_f32 v124, v124, v120
    v_sub_f32 v125, v125, v120
    v_cvt_pk_bf16_f32 v134, v124, v125
    v_lshlrev_b32 v124, 16, v134
    v_and_b32 v125, 0xffff0000, v134
    v_mul_f32 v124, v124, v121
    v_mul_f32 v125, v125, v121
    v_cvt_pk_bf16_f32 v134, v124, v125
    v_lshlrev_b32 v124, 16, v135
    v_and_b32 v125, 0xffff0000, v135
    v_sub_f32 v124, v124, v120
    v_sub_f32 v125, v125, v120
    v_cvt_pk_bf16_f32 v135, v124, v125
    v_lshlrev_b32 v124, 16, v135
    v_and_b32 v125, 0xffff0000, v135
    v_mul_f32 v124, v124, v121
    v_mul_f32 v125, v125, v121
    v_cvt_pk_bf16_f32 v135, v124, v125
    v_add_u32 v31, 32768, v30
    ds_write_b128 v31, v[132:135]
    v_lshlrev_b32 v124, 16, v164
    v_and_b32 v125, 0xffff0000, v164
    v_sub_f32 v124, v124, v122
    v_sub_f32 v125, v125, v122
    v_cvt_pk_bf16_f32 v164, v124, v125
    v_lshlrev_b32 v124, 16, v164
    v_and_b32 v125, 0xffff0000, v164
    v_mul_f32 v124, v124, v123
    v_mul_f32 v125, v125, v123
    v_cvt_pk_bf16_f32 v164, v124, v125
    v_lshlrev_b32 v124, 16, v165
    v_and_b32 v125, 0xffff0000, v165
    v_sub_f32 v124, v124, v122
    v_sub_f32 v125, v125, v122
    v_cvt_pk_bf16_f32 v165, v124, v125
    v_lshlrev_b32 v124, 16, v165
    v_and_b32 v125, 0xffff0000, v165
    v_mul_f32 v124, v124, v123
    v_mul_f32 v125, v125, v123
    v_cvt_pk_bf16_f32 v165, v124, v125
    v_lshlrev_b32 v124, 16, v166
    v_and_b32 v125, 0xffff0000, v166
    v_sub_f32 v124, v124, v122
    v_sub_f32 v125, v125, v122
    v_cvt_pk_bf16_f32 v166, v124, v125
    v_lshlrev_b32 v124, 16, v166
    v_and_b32 v125, 0xffff0000, v166
    v_mul_f32 v124, v124, v123
    v_mul_f32 v125, v125, v123
    v_cvt_pk_bf16_f32 v166, v124, v125
    v_lshlrev_b32 v124, 16, v167
    v_and_b32 v125, 0xffff0000, v167
    v_sub_f32 v124, v124, v122
    v_sub_f32 v125, v125, v122
    v_cvt_pk_bf16_f32 v167, v124, v125
    v_lshlrev_b32 v124, 16, v167
    v_and_b32 v125, 0xffff0000, v167
    v_mul_f32 v124, v124, v123
    v_mul_f32 v125, v125, v123
    v_cvt_pk_bf16_f32 v167, v124, v125
    v_add_u32 v31, 40960, v30
    ds_write_b128 v31, v[164:167]
    v_lshlrev_b32 v124, 16, v136
    v_and_b32 v125, 0xffff0000, v136
    v_sub_f32 v124, v124, v120
    v_sub_f32 v125, v125, v120
    v_cvt_pk_bf16_f32 v136, v124, v125
    v_lshlrev_b32 v124, 16, v136
    v_and_b32 v125, 0xffff0000, v136
    v_mul_f32 v124, v124, v121
    v_mul_f32 v125, v125, v121
    v_cvt_pk_bf16_f32 v136, v124, v125
    v_lshlrev_b32 v124, 16, v137
    v_and_b32 v125, 0xffff0000, v137
    v_sub_f32 v124, v124, v120
    v_sub_f32 v125, v125, v120
    v_cvt_pk_bf16_f32 v137, v124, v125
    v_lshlrev_b32 v124, 16, v137
    v_and_b32 v125, 0xffff0000, v137
    v_mul_f32 v124, v124, v121
    v_mul_f32 v125, v125, v121
    v_cvt_pk_bf16_f32 v137, v124, v125
    v_lshlrev_b32 v124, 16, v138
    v_and_b32 v125, 0xffff0000, v138
    v_sub_f32 v124, v124, v120
    v_sub_f32 v125, v125, v120
    v_cvt_pk_bf16_f32 v138, v124, v125
    v_lshlrev_b32 v124, 16, v138
    v_and_b32 v125, 0xffff0000, v138
    v_mul_f32 v124, v124, v121
    v_mul_f32 v125, v125, v121
    v_cvt_pk_bf16_f32 v138, v124, v125
    v_lshlrev_b32 v124, 16, v139
    v_and_b32 v125, 0xffff0000, v139
    v_sub_f32 v124, v124, v120
    v_sub_f32 v125, v125, v120
    v_cvt_pk_bf16_f32 v139, v124, v125
    v_lshlrev_b32 v124, 16, v139
    v_and_b32 v125, 0xffff0000, v139
    v_mul_f32 v124, v124, v121
    v_mul_f32 v125, v125, v121
    v_cvt_pk_bf16_f32 v139, v124, v125
    v_add_u32 v31, 65536, v30
    ds_write_b128 v31, v[136:139]
    v_lshlrev_b32 v124, 16, v168
    v_and_b32 v125, 0xffff0000, v168
    v_sub_f32 v124, v124, v122
    v_sub_f32 v125, v125, v122
    v_cvt_pk_bf16_f32 v168, v124, v125
    v_lshlrev_b32 v124, 16, v168
    v_and_b32 v125, 0xffff0000, v168
    v_mul_f32 v124, v124, v123
    v_mul_f32 v125, v125, v123
    v_cvt_pk_bf16_f32 v168, v124, v125
    v_lshlrev_b32 v124, 16, v169
    v_and_b32 v125, 0xffff0000, v169
    v_sub_f32 v124, v124, v122
    v_sub_f32 v125, v125, v122
    v_cvt_pk_bf16_f32 v169, v124, v125
    v_lshlrev_b32 v124, 16, v169
    v_and_b32 v125, 0xffff0000, v169
    v_mul_f32 v124, v124, v123
    v_mul_f32 v125, v125, v123
    v_cvt_pk_bf16_f32 v169, v124, v125
    v_lshlrev_b32 v124, 16, v170
    v_and_b32 v125, 0xffff0000, v170
    v_sub_f32 v124, v124, v122
    v_sub_f32 v125, v125, v122
    v_cvt_pk_bf16_f32 v170, v124, v125
    v_lshlrev_b32 v124, 16, v170
    v_and_b32 v125, 0xffff0000, v170
    v_mul_f32 v124, v124, v123
    v_mul_f32 v125, v125, v123
    v_cvt_pk_bf16_f32 v170, v124, v125
    v_lshlrev_b32 v124, 16, v171
    v_and_b32 v125, 0xffff0000, v171
    v_sub_f32 v124, v124, v122
    v_sub_f32 v125, v125, v122
    v_cvt_pk_bf16_f32 v171, v124, v125
    v_lshlrev_b32 v124, 16, v171
    v_and_b32 v125, 0xffff0000, v171
    v_mul_f32 v124, v124, v123
    v_mul_f32 v125, v125, v123
    v_cvt_pk_bf16_f32 v171, v124, v125
    v_add_u32 v31, 73728, v30
    ds_write_b128 v31, v[168:171]
    v_lshlrev_b32 v124, 16, v140
    v_and_b32 v125, 0xffff0000, v140
    v_sub_f32 v124, v124, v120
    v_sub_f32 v125, v125, v120
    v_cvt_pk_bf16_f32 v140, v124, v125
    v_lshlrev_b32 v124, 16, v140
    v_and_b32 v125, 0xffff0000, v140
    v_mul_f32 v124, v124, v121
    v_mul_f32 v125, v125, v121
    v_cvt_pk_bf16_f32 v140, v124, v125
    v_lshlrev_b32 v124, 16, v141
    v_and_b32 v125, 0xffff0000, v141
    v_sub_f32 v124, v124, v120
    v_sub_f32 v125, v125, v120
    v_cvt_pk_bf16_f32 v141, v124, v125
    v_lshlrev_b32 v124, 16, v141
    v_and_b32 v125, 0xffff0000, v141
    v_mul_f32 v124, v124, v121
    v_mul_f32 v125, v125, v121
    v_cvt_pk_bf16_f32 v141, v124, v125
    v_lshlrev_b32 v124, 16, v142
    v_and_b32 v125, 0xffff0000, v142
    v_sub_f32 v124, v124, v120
    v_sub_f32 v125, v125, v120
    v_cvt_pk_bf16_f32 v142, v124, v125
    v_lshlrev_b32 v124, 16, v142
    v_and_b32 v125, 0xffff0000, v142
    v_mul_f32 v124, v124, v121
    v_mul_f32 v125, v125, v121
    v_cvt_pk_bf16_f32 v142, v124, v125
    v_lshlrev_b32 v124, 16, v143
    v_and_b32 v125, 0xffff0000, v143
    v_sub_f32 v124, v124, v120
    v_sub_f32 v125, v125, v120
    v_cvt_pk_bf16_f32 v143, v124, v125
    v_lshlrev_b32 v124, 16, v143
    v_and_b32 v125, 0xffff0000, v143
    v_mul_f32 v124, v124, v121
    v_mul_f32 v125, v125, v121
    v_cvt_pk_bf16_f32 v143, v124, v125
    v_add_u32 v31, 98304, v30
    ds_write_b128 v31, v[140:143]
    v_lshlrev_b32 v124, 16, v172
    v_and_b32 v125, 0xffff0000, v172
    v_sub_f32 v124, v124, v122
    v_sub_f32 v125, v125, v122
    v_cvt_pk_bf16_f32 v172, v124, v125
    v_lshlrev_b32 v124, 16, v172
    v_and_b32 v125, 0xffff0000, v172
    v_mul_f32 v124, v124, v123
    v_mul_f32 v125, v125, v123
    v_cvt_pk_bf16_f32 v172, v124, v125
    v_lshlrev_b32 v124, 16, v173
    v_and_b32 v125, 0xffff0000, v173
    v_sub_f32 v124, v124, v122
    v_sub_f32 v125, v125, v122
    v_cvt_pk_bf16_f32 v173, v124, v125
    v_lshlrev_b32 v124, 16, v173
    v_and_b32 v125, 0xffff0000, v173
    v_mul_f32 v124, v124, v123
    v_mul_f32 v125, v125, v123
    v_cvt_pk_bf16_f32 v173, v124, v125
    v_lshlrev_b32 v124, 16, v174
    v_and_b32 v125, 0xffff0000, v174
    v_sub_f32 v124, v124, v122
    v_sub_f32 v125, v125, v122
    v_cvt_pk_bf16_f32 v174, v124, v125
    v_lshlrev_b32 v124, 16, v174
    v_and_b32 v125, 0xffff0000, v174
    v_mul_f32 v124, v124, v123
    v_mul_f32 v125, v125, v123
    v_cvt_pk_bf16_f32 v174, v124, v125
    v_lshlrev_b32 v124, 16, v175
    v_and_b32 v125, 0xffff0000, v175
    v_sub_f32 v124, v124, v122
    v_sub_f32 v125, v125, v122
    v_cvt_pk_bf16_f32 v175, v124, v125
    v_lshlrev_b32 v124, 16, v175
    v_and_b32 v125, 0xffff0000, v175
    v_mul_f32 v124, v124, v123
    v_mul_f32 v125, v125, v123
    v_cvt_pk_bf16_f32 v175, v124, v125
    v_add_u32 v31, 106496, v30
    ds_write_b128 v31, v[172:175]
    s_waitcnt vmcnt(6) lgkmcnt(0)
    s_barrier
    v_add_u32 v22, 0, v10
    v_add_u32 v23, 0, v11
    v_add_u32 v24, 0, v12
    v_add_u32 v25, 0, v13
    v_add_u32 v26, 0, v20
    ds_read_b128 v[32:35], v22 offset:0
    ds_read_b128 v[36:39], v22 offset:4096
    ds_read_b64_tr_b16 v[40:41], v26 offset:0
    ds_read_b64_tr_b16 v[42:43], v26 offset:1024
    ds_read_b128 v[48:51], v23 offset:0
    ds_read_b128 v[52:55], v23 offset:4096
    ds_read_b64_tr_b16 v[56:57], v26 offset:4096
    ds_read_b64_tr_b16 v[58:59], v26 offset:5120
    s_waitcnt lgkmcnt(4)
    v_mfma_f32_32x32x16_bf16 v[64:79], v[40:43], v[32:35], v[64:79]
    v_lshlrev_b32 v124, 16, v144
    v_and_b32 v125, 0xffff0000, v144
    v_sub_f32 v124, v124, v120
    v_sub_f32 v125, v125, v120
    v_cvt_pk_bf16_f32 v144, v124, v125
    v_lshlrev_b32 v124, 16, v144
    v_and_b32 v125, 0xffff0000, v144
    v_mul_f32 v124, v124, v121
    v_mul_f32 v125, v125, v121
    v_cvt_pk_bf16_f32 v144, v124, v125
    v_lshlrev_b32 v124, 16, v145
    v_and_b32 v125, 0xffff0000, v145
    v_sub_f32 v124, v124, v120
    v_sub_f32 v125, v125, v120
    v_cvt_pk_bf16_f32 v145, v124, v125
    v_lshlrev_b32 v124, 16, v145
    v_and_b32 v125, 0xffff0000, v145
    v_mul_f32 v124, v124, v121
    v_mul_f32 v125, v125, v121
    v_cvt_pk_bf16_f32 v145, v124, v125
    v_lshlrev_b32 v124, 16, v146
    v_and_b32 v125, 0xffff0000, v146
    v_sub_f32 v124, v124, v120
    v_sub_f32 v125, v125, v120
    v_cvt_pk_bf16_f32 v146, v124, v125
    v_lshlrev_b32 v124, 16, v146
    v_and_b32 v125, 0xffff0000, v146
    v_mul_f32 v124, v124, v121
    v_mul_f32 v125, v125, v121
    v_cvt_pk_bf16_f32 v146, v124, v125
    v_lshlrev_b32 v124, 16, v147
    v_and_b32 v125, 0xffff0000, v147
    v_sub_f32 v124, v124, v120
    v_sub_f32 v125, v125, v120
    v_cvt_pk_bf16_f32 v147, v124, v125
    v_lshlrev_b32 v124, 16, v147
    v_and_b32 v125, 0xffff0000, v147
    v_mul_f32 v124, v124, v121
    v_mul_f32 v125, v125, v121
    v_cvt_pk_bf16_f32 v147, v124, v125
    v_add_u32 v31, 131072, v30
    ds_write_b128 v31, v[144:147]
    v_mfma_f32_32x32x16_bf16 v[80:95], v[40:43], v[36:39], v[80:95]
    v_lshlrev_b32 v124, 16, v176
    v_and_b32 v125, 0xffff0000, v176
    v_sub_f32 v124, v124, v122
    v_sub_f32 v125, v125, v122
    v_cvt_pk_bf16_f32 v176, v124, v125
    v_lshlrev_b32 v124, 16, v176
    v_and_b32 v125, 0xffff0000, v176
    v_mul_f32 v124, v124, v123
    v_mul_f32 v125, v125, v123
    v_cvt_pk_bf16_f32 v176, v124, v125
    v_lshlrev_b32 v124, 16, v177
    v_and_b32 v125, 0xffff0000, v177
    v_sub_f32 v124, v124, v122
    v_sub_f32 v125, v125, v122
    v_cvt_pk_bf16_f32 v177, v124, v125
    v_lshlrev_b32 v124, 16, v177
    v_and_b32 v125, 0xffff0000, v177
    v_mul_f32 v124, v124, v123
    v_mul_f32 v125, v125, v123
    v_cvt_pk_bf16_f32 v177, v124, v125
    v_lshlrev_b32 v124, 16, v178
    v_and_b32 v125, 0xffff0000, v178
    v_sub_f32 v124, v124, v122
    v_sub_f32 v125, v125, v122
    v_cvt_pk_bf16_f32 v178, v124, v125
    v_lshlrev_b32 v124, 16, v178
    v_and_b32 v125, 0xffff0000, v178
    v_mul_f32 v124, v124, v123
    v_mul_f32 v125, v125, v123
    v_cvt_pk_bf16_f32 v178, v124, v125
    v_lshlrev_b32 v124, 16, v179
    v_and_b32 v125, 0xffff0000, v179
    v_sub_f32 v124, v124, v122
    v_sub_f32 v125, v125, v122
    v_cvt_pk_bf16_f32 v179, v124, v125
    v_lshlrev_b32 v124, 16, v179
    v_and_b32 v125, 0xffff0000, v179
    v_mul_f32 v124, v124, v123
    v_mul_f32 v125, v125, v123
    v_cvt_pk_bf16_f32 v179, v124, v125
    v_add_u32 v31, 139264, v30
    ds_write_b128 v31, v[176:179]
    ds_read_b128 v[32:35], v24 offset:0
    ds_read_b128 v[36:39], v24 offset:4096
    ds_read_b64_tr_b16 v[40:41], v26 offset:8192
    ds_read_b64_tr_b16 v[42:43], v26 offset:9216
    s_waitcnt lgkmcnt(4)
    v_mfma_f32_32x32x16_bf16 v[64:79], v[56:59], v[48:51], v[64:79]
    s_add_u32 m0, s45, 147456
    s_add_u32 s46, s36, 917504
    buffer_load_dwordx4 v4, s[8:11], s46 offen lds
    v_mfma_f32_32x32x16_bf16 v[80:95], v[56:59], v[52:55], v[80:95]
    s_add_u32 m0, s45, 155648
    s_add_u32 s46, s37, 917504
    buffer_load_dwordx4 v4, s[8:11], s46 offen lds
    ds_read_b128 v[48:51], v25 offset:0
    ds_read_b128 v[52:55], v25 offset:4096
    ds_read_b64_tr_b16 v[56:57], v26 offset:12288
    ds_read_b64_tr_b16 v[58:59], v26 offset:13312
    s_waitcnt lgkmcnt(4)
    v_mfma_f32_32x32x16_bf16 v[64:79], v[40:43], v[32:35], v[64:79]
    v_mfma_f32_32x32x16_bf16 v[80:95], v[40:43], v[36:39], v[80:95]
    s_waitcnt lgkmcnt(0)
    v_mfma_f32_32x32x16_bf16 v[64:79], v[56:59], v[48:51], v[64:79]
    v_mfma_f32_32x32x16_bf16 v[80:95], v[56:59], v[52:55], v[80:95]
    s_waitcnt vmcnt(6) lgkmcnt(0)
    s_barrier
    v_add_u32 v22, 32768, v10
    v_add_u32 v23, 32768, v11
    v_add_u32 v24, 32768, v12
    v_add_u32 v25, 32768, v13
    v_add_u32 v26, 32768, v20
    ds_read_b128 v[32:35], v22 offset:0
    ds_read_b128 v[36:39], v22 offset:4096
    ds_read_b64_tr_b16 v[40:41], v26 offset:0
    ds_read_b64_tr_b16 v[42:43], v26 offset:1024
    ds_read_b128 v[48:51], v23 offset:0
    ds_read_b128 v[52:55], v23 offset:4096
    ds_read_b64_tr_b16 v[56:57], v26 offset:4096
    ds_read_b64_tr_b16 v[58:59], v26 offset:5120
    s_waitcnt lgkmcnt(4)
    v_mfma_f32_32x32x16_bf16 v[64:79], v[40:43], v[32:35], v[64:79]
    v_lshlrev_b32 v124, 16, v148
    v_and_b32 v125, 0xffff0000, v148
    v_sub_f32 v124, v124, v120
    v_sub_f32 v125, v125, v120
    v_cvt_pk_bf16_f32 v148, v124, v125
    v_lshlrev_b32 v124, 16, v148
    v_and_b32 v125, 0xffff0000, v148
    v_mul_f32 v124, v124, v121
    v_mul_f32 v125, v125, v121
    v_cvt_pk_bf16_f32 v148, v124, v125
    v_lshlrev_b32 v124, 16, v149
    v_and_b32 v125, 0xffff0000, v149
    v_sub_f32 v124, v124, v120
    v_sub_f32 v125, v125, v120
    v_cvt_pk_bf16_f32 v149, v124, v125
    v_lshlrev_b32 v124, 16, v149
    v_and_b32 v125, 0xffff0000, v149
    v_mul_f32 v124, v124, v121
    v_mul_f32 v125, v125, v121
    v_cvt_pk_bf16_f32 v149, v124, v125
    v_lshlrev_b32 v124, 16, v150
    v_and_b32 v125, 0xffff0000, v150
    v_sub_f32 v124, v124, v120
    v_sub_f32 v125, v125, v120
    v_cvt_pk_bf16_f32 v150, v124, v125
    v_lshlrev_b32 v124, 16, v150
    v_and_b32 v125, 0xffff0000, v150
    v_mul_f32 v124, v124, v121
    v_mul_f32 v125, v125, v121
    v_cvt_pk_bf16_f32 v150, v124, v125
    v_lshlrev_b32 v124, 16, v151
    v_and_b32 v125, 0xffff0000, v151
    v_sub_f32 v124, v124, v120
    v_sub_f32 v125, v125, v120
    v_cvt_pk_bf16_f32 v151, v124, v125
    v_lshlrev_b32 v124, 16, v151
    v_and_b32 v125, 0xffff0000, v151
    v_mul_f32 v124, v124, v121
    v_mul_f32 v125, v125, v121
    v_cvt_pk_bf16_f32 v151, v124, v125
    v_add_u32 v31, 0, v30
    ds_write_b128 v31, v[148:151]
    v_mfma_f32_32x32x16_bf16 v[80:95], v[40:43], v[36:39], v[80:95]
    v_lshlrev_b32 v124, 16, v180
    v_and_b32 v125, 0xffff0000, v180
    v_sub_f32 v124, v124, v122
    v_sub_f32 v125, v125, v122
    v_cvt_pk_bf16_f32 v180, v124, v125
    v_lshlrev_b32 v124, 16, v180
    v_and_b32 v125, 0xffff0000, v180
    v_mul_f32 v124, v124, v123
    v_mul_f32 v125, v125, v123
    v_cvt_pk_bf16_f32 v180, v124, v125
    v_lshlrev_b32 v124, 16, v181
    v_and_b32 v125, 0xffff0000, v181
    v_sub_f32 v124, v124, v122
    v_sub_f32 v125, v125, v122
    v_cvt_pk_bf16_f32 v181, v124, v125
    v_lshlrev_b32 v124, 16, v181
    v_and_b32 v125, 0xffff0000, v181
    v_mul_f32 v124, v124, v123
    v_mul_f32 v125, v125, v123
    v_cvt_pk_bf16_f32 v181, v124, v125
    v_lshlrev_b32 v124, 16, v182
    v_and_b32 v125, 0xffff0000, v182
    v_sub_f32 v124, v124, v122
    v_sub_f32 v125, v125, v122
    v_cvt_pk_bf16_f32 v182, v124, v125
    v_lshlrev_b32 v124, 16, v182
    v_and_b32 v125, 0xffff0000, v182
    v_mul_f32 v124, v124, v123
    v_mul_f32 v125, v125, v123
    v_cvt_pk_bf16_f32 v182, v124, v125
    v_lshlrev_b32 v124, 16, v183
    v_and_b32 v125, 0xffff0000, v183
    v_sub_f32 v124, v124, v122
    v_sub_f32 v125, v125, v122
    v_cvt_pk_bf16_f32 v183, v124, v125
    v_lshlrev_b32 v124, 16, v183
    v_and_b32 v125, 0xffff0000, v183
    v_mul_f32 v124, v124, v123
    v_mul_f32 v125, v125, v123
    v_cvt_pk_bf16_f32 v183, v124, v125
    v_add_u32 v31, 8192, v30
    ds_write_b128 v31, v[180:183]
    ds_read_b128 v[32:35], v24 offset:0
    ds_read_b128 v[36:39], v24 offset:4096
    ds_read_b64_tr_b16 v[40:41], v26 offset:8192
    ds_read_b64_tr_b16 v[42:43], v26 offset:9216
    s_waitcnt lgkmcnt(4)
    v_mfma_f32_32x32x16_bf16 v[64:79], v[56:59], v[48:51], v[64:79]
    s_add_u32 m0, s45, 16384
    s_add_u32 s46, s36, 1146880
    buffer_load_dwordx4 v4, s[8:11], s46 offen lds
    v_mfma_f32_32x32x16_bf16 v[80:95], v[56:59], v[52:55], v[80:95]
    s_add_u32 m0, s45, 24576
    s_add_u32 s46, s37, 1146880
    buffer_load_dwordx4 v4, s[8:11], s46 offen lds
    ds_read_b128 v[48:51], v25 offset:0
    ds_read_b128 v[52:55], v25 offset:4096
    ds_read_b64_tr_b16 v[56:57], v26 offset:12288
    ds_read_b64_tr_b16 v[58:59], v26 offset:13312
    s_waitcnt lgkmcnt(4)
    v_mfma_f32_32x32x16_bf16 v[64:79], v[40:43], v[32:35], v[64:79]
    v_mfma_f32_32x32x16_bf16 v[80:95], v[40:43], v[36:39], v[80:95]
    s_waitcnt lgkmcnt(0)
    v_mfma_f32_32x32x16_bf16 v[64:79], v[56:59], v[48:51], v[64:79]
    v_mfma_f32_32x32x16_bf16 v[80:95], v[56:59], v[52:55], v[80:95]
    s_waitcnt vmcnt(6) lgkmcnt(0)
    s_barrier
    v_add_u32 v22, 65536, v10
    v_add_u32 v23, 65536, v11
    v_add_u32 v24, 65536, v12
    v_add_u32 v25, 65536, v13
    v_add_u32 v26, 65536, v20
    ds_read_b128 v[32:35], v22 offset:0
    ds_read_b128 v[36:39], v22 offset:4096
    ds_read_b64_tr_b16 v[40:41], v26 offset:0
    ds_read_b64_tr_b16 v[42:43], v26 offset:1024
    ds_read_b128 v[48:51], v23 offset:0
    ds_read_b128 v[52:55], v23 offset:4096
    ds_read_b64_tr_b16 v[56:57], v26 offset:4096
    ds_read_b64_tr_b16 v[58:59], v26 offset:5120
    s_waitcnt lgkmcnt(4)
    v_mfma_f32_32x32x16_bf16 v[64:79], v[40:43], v[32:35], v[64:79]
    v_lshlrev_b32 v124, 16, v152
    v_and_b32 v125, 0xffff0000, v152
    v_sub_f32 v124, v124, v120
    v_sub_f32 v125, v125, v120
    v_cvt_pk_bf16_f32 v152, v124, v125
    v_lshlrev_b32 v124, 16, v152
    v_and_b32 v125, 0xffff0000, v152
    v_mul_f32 v124, v124, v121
    v_mul_f32 v125, v125, v121
    v_cvt_pk_bf16_f32 v152, v124, v125
    v_lshlrev_b32 v124, 16, v153
    v_and_b32 v125, 0xffff0000, v153
    v_sub_f32 v124, v124, v120
    v_sub_f32 v125, v125, v120
    v_cvt_pk_bf16_f32 v153, v124, v125
    v_lshlrev_b32 v124, 16, v153
    v_and_b32 v125, 0xffff0000, v153
    v_mul_f32 v124, v124, v121
    v_mul_f32 v125, v125, v121
    v_cvt_pk_bf16_f32 v153, v124, v125
    v_lshlrev_b32 v124, 16, v154
    v_and_b32 v125, 0xffff0000, v154
    v_sub_f32 v124, v124, v120
    v_sub_f32 v125, v125, v120
    v_cvt_pk_bf16_f32 v154, v124, v125
    v_lshlrev_b32 v124, 16, v154
    v_and_b32 v125, 0xffff0000, v154
    v_mul_f32 v124, v124, v121
    v_mul_f32 v125, v125, v121
    v_cvt_pk_bf16_f32 v154, v124, v125
    v_lshlrev_b32 v124, 16, v155
    v_and_b32 v125, 0xffff0000, v155
    v_sub_f32 v124, v124, v120
    v_sub_f32 v125, v125, v120
    v_cvt_pk_bf16_f32 v155, v124, v125
    v_lshlrev_b32 v124, 16, v155
    v_and_b32 v125, 0xffff0000, v155
    v_mul_f32 v124, v124, v121
    v_mul_f32 v125, v125, v121
    v_cvt_pk_bf16_f32 v155, v124, v125
    v_add_u32 v31, 32768, v30
    ds_write_b128 v31, v[152:155]
    v_mfma_f32_32x32x16_bf16 v[80:95], v[40:43], v[36:39], v[80:95]
    v_lshlrev_b32 v124, 16, v184
    v_and_b32 v125, 0xffff0000, v184
    v_sub_f32 v124, v124, v122
    v_sub_f32 v125, v125, v122
    v_cvt_pk_bf16_f32 v184, v124, v125
    v_lshlrev_b32 v124, 16, v184
    v_and_b32 v125, 0xffff0000, v184
    v_mul_f32 v124, v124, v123
    v_mul_f32 v125, v125, v123
    v_cvt_pk_bf16_f32 v184, v124, v125
    v_lshlrev_b32 v124, 16, v185
    v_and_b32 v125, 0xffff0000, v185
    v_sub_f32 v124, v124, v122
    v_sub_f32 v125, v125, v122
    v_cvt_pk_bf16_f32 v185, v124, v125
    v_lshlrev_b32 v124, 16, v185
    v_and_b32 v125, 0xffff0000, v185
    v_mul_f32 v124, v124, v123
    v_mul_f32 v125, v125, v123
    v_cvt_pk_bf16_f32 v185, v124, v125
    v_lshlrev_b32 v124, 16, v186
    v_and_b32 v125, 0xffff0000, v186
    v_sub_f32 v124, v124, v122
    v_sub_f32 v125, v125, v122
    v_cvt_pk_bf16_f32 v186, v124, v125
    v_lshlrev_b32 v124, 16, v186
    v_and_b32 v125, 0xffff0000, v186
    v_mul_f32 v124, v124, v123
    v_mul_f32 v125, v125, v123
    v_cvt_pk_bf16_f32 v186, v124, v125
    v_lshlrev_b32 v124, 16, v187
    v_and_b32 v125, 0xffff0000, v187
    v_sub_f32 v124, v124, v122
    v_sub_f32 v125, v125, v122
    v_cvt_pk_bf16_f32 v187, v124, v125
    v_lshlrev_b32 v124, 16, v187
    v_and_b32 v125, 0xffff0000, v187
    v_mul_f32 v124, v124, v123
    v_mul_f32 v125, v125, v123
    v_cvt_pk_bf16_f32 v187, v124, v125
    v_add_u32 v31, 40960, v30
    ds_write_b128 v31, v[184:187]
    ds_read_b128 v[32:35], v24 offset:0
    ds_read_b128 v[36:39], v24 offset:4096
    ds_read_b64_tr_b16 v[40:41], v26 offset:8192
    ds_read_b64_tr_b16 v[42:43], v26 offset:9216
    s_waitcnt lgkmcnt(4)
    v_mfma_f32_32x32x16_bf16 v[64:79], v[56:59], v[48:51], v[64:79]
    s_add_u32 m0, s45, 49152
    s_add_u32 s46, s36, 1376256
    buffer_load_dwordx4 v4, s[8:11], s46 offen lds
    v_mfma_f32_32x32x16_bf16 v[80:95], v[56:59], v[52:55], v[80:95]
    s_add_u32 m0, s45, 57344
    s_add_u32 s46, s37, 1376256
    buffer_load_dwordx4 v4, s[8:11], s46 offen lds
    ds_read_b128 v[48:51], v25 offset:0
    ds_read_b128 v[52:55], v25 offset:4096
    ds_read_b64_tr_b16 v[56:57], v26 offset:12288
    ds_read_b64_tr_b16 v[58:59], v26 offset:13312
    s_waitcnt lgkmcnt(4)
    v_mfma_f32_32x32x16_bf16 v[64:79], v[40:43], v[32:35], v[64:79]
    v_mfma_f32_32x32x16_bf16 v[80:95], v[40:43], v[36:39], v[80:95]
    s_waitcnt lgkmcnt(0)
    v_mfma_f32_32x32x16_bf16 v[64:79], v[56:59], v[48:51], v[64:79]
    v_mfma_f32_32x32x16_bf16 v[80:95], v[56:59], v[52:55], v[80:95]
    s_waitcnt vmcnt(6) lgkmcnt(0)
    s_barrier
    v_add_u32 v22, 98304, v10
    v_add_u32 v23, 98304, v11
    v_add_u32 v24, 98304, v12
    v_add_u32 v25, 98304, v13
    v_add_u32 v26, 98304, v20
    ds_read_b128 v[32:35], v22 offset:0
    ds_read_b128 v[36:39], v22 offset:4096
    ds_read_b64_tr_b16 v[40:41], v26 offset:0
    ds_read_b64_tr_b16 v[42:43], v26 offset:1024
    ds_read_b128 v[48:51], v23 offset:0
    ds_read_b128 v[52:55], v23 offset:4096
    ds_read_b64_tr_b16 v[56:57], v26 offset:4096
    ds_read_b64_tr_b16 v[58:59], v26 offset:5120
    s_waitcnt lgkmcnt(4)
    v_mfma_f32_32x32x16_bf16 v[64:79], v[40:43], v[32:35], v[64:79]
    v_lshlrev_b32 v124, 16, v156
    v_and_b32 v125, 0xffff0000, v156
    v_sub_f32 v124, v124, v120
    v_sub_f32 v125, v125, v120
    v_cvt_pk_bf16_f32 v156, v124, v125
    v_lshlrev_b32 v124, 16, v156
    v_and_b32 v125, 0xffff0000, v156
    v_mul_f32 v124, v124, v121
    v_mul_f32 v125, v125, v121
    v_cvt_pk_bf16_f32 v156, v124, v125
    v_lshlrev_b32 v124, 16, v157
    v_and_b32 v125, 0xffff0000, v157
    v_sub_f32 v124, v124, v120
    v_sub_f32 v125, v125, v120
    v_cvt_pk_bf16_f32 v157, v124, v125
    v_lshlrev_b32 v124, 16, v157
    v_and_b32 v125, 0xffff0000, v157
    v_mul_f32 v124, v124, v121
    v_mul_f32 v125, v125, v121
    v_cvt_pk_bf16_f32 v157, v124, v125
    v_lshlrev_b32 v124, 16, v158
    v_and_b32 v125, 0xffff0000, v158
    v_sub_f32 v124, v124, v120
    v_sub_f32 v125, v125, v120
    v_cvt_pk_bf16_f32 v158, v124, v125
    v_lshlrev_b32 v124, 16, v158
    v_and_b32 v125, 0xffff0000, v158
    v_mul_f32 v124, v124, v121
    v_mul_f32 v125, v125, v121
    v_cvt_pk_bf16_f32 v158, v124, v125
    v_lshlrev_b32 v124, 16, v159
    v_and_b32 v125, 0xffff0000, v159
    v_sub_f32 v124, v124, v120
    v_sub_f32 v125, v125, v120
    v_cvt_pk_bf16_f32 v159, v124, v125
    v_lshlrev_b32 v124, 16, v159
    v_and_b32 v125, 0xffff0000, v159
    v_mul_f32 v124, v124, v121
    v_mul_f32 v125, v125, v121
    v_cvt_pk_bf16_f32 v159, v124, v125
    v_add_u32 v31, 65536, v30
    ds_write_b128 v31, v[156:159]
    v_mfma_f32_32x32x16_bf16 v[80:95], v[40:43], v[36:39], v[80:95]
    v_lshlrev_b32 v124, 16, v188
    v_and_b32 v125, 0xffff0000, v188
    v_sub_f32 v124, v124, v122
    v_sub_f32 v125, v125, v122
    v_cvt_pk_bf16_f32 v188, v124, v125
    v_lshlrev_b32 v124, 16, v188
    v_and_b32 v125, 0xffff0000, v188
    v_mul_f32 v124, v124, v123
    v_mul_f32 v125, v125, v123
    v_cvt_pk_bf16_f32 v188, v124, v125
    v_lshlrev_b32 v124, 16, v189
    v_and_b32 v125, 0xffff0000, v189
    v_sub_f32 v124, v124, v122
    v_sub_f32 v125, v125, v122
    v_cvt_pk_bf16_f32 v189, v124, v125
    v_lshlrev_b32 v124, 16, v189
    v_and_b32 v125, 0xffff0000, v189
    v_mul_f32 v124, v124, v123
    v_mul_f32 v125, v125, v123
    v_cvt_pk_bf16_f32 v189, v124, v125
    v_lshlrev_b32 v124, 16, v190
    v_and_b32 v125, 0xffff0000, v190
    v_sub_f32 v124, v124, v122
    v_sub_f32 v125, v125, v122
    v_cvt_pk_bf16_f32 v190, v124, v125
    v_lshlrev_b32 v124, 16, v190
    v_and_b32 v125, 0xffff0000, v190
    v_mul_f32 v124, v124, v123
    v_mul_f32 v125, v125, v123
    v_cvt_pk_bf16_f32 v190, v124, v125
    v_lshlrev_b32 v124, 16, v191
    v_and_b32 v125, 0xffff0000, v191
    v_sub_f32 v124, v124, v122
    v_sub_f32 v125, v125, v122
    v_cvt_pk_bf16_f32 v191, v124, v125
    v_lshlrev_b32 v124, 16, v191
    v_and_b32 v125, 0xffff0000, v191
    v_mul_f32 v124, v124, v123
    v_mul_f32 v125, v125, v123
    v_cvt_pk_bf16_f32 v191, v124, v125
    v_add_u32 v31, 73728, v30
    ds_write_b128 v31, v[188:191]
    ds_read_b128 v[32:35], v24 offset:0
    ds_read_b128 v[36:39], v24 offset:4096
    ds_read_b64_tr_b16 v[40:41], v26 offset:8192
    ds_read_b64_tr_b16 v[42:43], v26 offset:9216
    s_waitcnt lgkmcnt(4)
    v_mfma_f32_32x32x16_bf16 v[64:79], v[56:59], v[48:51], v[64:79]
    s_add_u32 m0, s45, 81920
    s_add_u32 s46, s36, 1605632
    buffer_load_dwordx4 v4, s[8:11], s46 offen lds
    v_mfma_f32_32x32x16_bf16 v[80:95], v[56:59], v[52:55], v[80:95]
    s_add_u32 m0, s45, 90112
    s_add_u32 s46, s37, 1605632
    buffer_load_dwordx4 v4, s[8:11], s46 offen lds
    ds_read_b128 v[48:51], v25 offset:0
    ds_read_b128 v[52:55], v25 offset:4096
    ds_read_b64_tr_b16 v[56:57], v26 offset:12288
    ds_read_b64_tr_b16 v[58:59], v26 offset:13312
    s_waitcnt lgkmcnt(4)
    v_mfma_f32_32x32x16_bf16 v[64:79], v[40:43], v[32:35], v[64:79]
    v_mfma_f32_32x32x16_bf16 v[80:95], v[40:43], v[36:39], v[80:95]
    s_waitcnt lgkmcnt(0)
    v_mfma_f32_32x32x16_bf16 v[64:79], v[56:59], v[48:51], v[64:79]
    v_mfma_f32_32x32x16_bf16 v[80:95], v[56:59], v[52:55], v[80:95]
    s_waitcnt vmcnt(6) lgkmcnt(0)
    s_barrier
    v_add_u32 v22, 131072, v10
    v_add_u32 v23, 131072, v11
    v_add_u32 v24, 131072, v12
    v_add_u32 v25, 131072, v13
    v_add_u32 v26, 131072, v20
    ds_read_b128 v[32:35], v22 offset:0
    ds_read_b128 v[36:39], v22 offset:4096
    ds_read_b64_tr_b16 v[40:41], v26 offset:0
    ds_read_b64_tr_b16 v[42:43], v26 offset:1024
    ds_read_b128 v[48:51], v23 offset:0
    ds_read_b128 v[52:55], v23 offset:4096
    ds_read_b64_tr_b16 v[56:57], v26 offset:4096
    ds_read_b64_tr_b16 v[58:59], v26 offset:5120
    s_waitcnt lgkmcnt(4)
    v_mfma_f32_32x32x16_bf16 v[64:79], v[40:43], v[32:35], v[64:79]
    v_mfma_f32_32x32x16_bf16 v[80:95], v[40:43], v[36:39], v[80:95]
    ds_read_b128 v[32:35], v24 offset:0
    ds_read_b128 v[36:39], v24 offset:4096
    ds_read_b64_tr_b16 v[40:41], v26 offset:8192
    ds_read_b64_tr_b16 v[42:43], v26 offset:9216
    s_waitcnt lgkmcnt(4)
    v_mfma_f32_32x32x16_bf16 v[64:79], v[56:59], v[48:51], v[64:79]
    v_mfma_f32_32x32x16_bf16 v[80:95], v[56:59], v[52:55], v[80:95]
    ds_read_b128 v[48:51], v25 offset:0
    ds_read_b128 v[52:55], v25 offset:4096
    ds_read_b64_tr_b16 v[56:57], v26 offset:12288
    ds_read_b64_tr_b16 v[58:59], v26 offset:13312
    s_waitcnt lgkmcnt(4)
    v_mfma_f32_32x32x16_bf16 v[64:79], v[40:43], v[32:35], v[64:79]
    v_mfma_f32_32x32x16_bf16 v[80:95], v[40:43], v[36:39], v[80:95]
    s_waitcnt lgkmcnt(0)
    v_mfma_f32_32x32x16_bf16 v[64:79], v[56:59], v[48:51], v[64:79]
    v_mfma_f32_32x32x16_bf16 v[80:95], v[56:59], v[52:55], v[80:95]
    s_waitcnt vmcnt(4) lgkmcnt(0)
    s_barrier
    v_add_u32 v22, 0, v10
    v_add_u32 v23, 0, v11
    v_add_u32 v24, 0, v12
    v_add_u32 v25, 0, v13
    v_add_u32 v26, 0, v20
    ds_read_b128 v[32:35], v22 offset:0
    ds_read_b128 v[36:39], v22 offset:4096
    ds_read_b64_tr_b16 v[40:41], v26 offset:0
    ds_read_b64_tr_b16 v[42:43], v26 offset:1024
    ds_read_b128 v[48:51], v23 offset:0
    ds_read_b128 v[52:55], v23 offset:4096
    ds_read_b64_tr_b16 v[56:57], v26 offset:4096
    ds_read_b64_tr_b16 v[58:59], v26 offset:5120
    s_waitcnt lgkmcnt(4)
    v_mfma_f32_32x32x16_bf16 v[64:79], v[40:43], v[32:35], v[64:79]
    v_mfma_f32_32x32x16_bf16 v[80:95], v[40:43], v[36:39], v[80:95]
    ds_read_b128 v[32:35], v24 offset:0
    ds_read_b128 v[36:39], v24 offset:4096
    ds_read_b64_tr_b16 v[40:41], v26 offset:8192
    ds_read_b64_tr_b16 v[42:43], v26 offset:9216
    s_waitcnt lgkmcnt(4)
    v_mfma_f32_32x32x16_bf16 v[64:79], v[56:59], v[48:51], v[64:79]
    v_mfma_f32_32x32x16_bf16 v[80:95], v[56:59], v[52:55], v[80:95]
    ds_read_b128 v[48:51], v25 offset:0
    ds_read_b128 v[52:55], v25 offset:4096
    ds_read_b64_tr_b16 v[56:57], v26 offset:12288
    ds_read_b64_tr_b16 v[58:59], v26 offset:13312
    s_waitcnt lgkmcnt(4)
    v_mfma_f32_32x32x16_bf16 v[64:79], v[40:43], v[32:35], v[64:79]
    v_mfma_f32_32x32x16_bf16 v[80:95], v[40:43], v[36:39], v[80:95]
    s_waitcnt lgkmcnt(0)
    v_mfma_f32_32x32x16_bf16 v[64:79], v[56:59], v[48:51], v[64:79]
    v_mfma_f32_32x32x16_bf16 v[80:95], v[56:59], v[52:55], v[80:95]
    s_waitcnt vmcnt(2) lgkmcnt(0)
    s_barrier
    v_add_u32 v22, 32768, v10
    v_add_u32 v23, 32768, v11
    v_add_u32 v24, 32768, v12
    v_add_u32 v25, 32768, v13
    v_add_u32 v26, 32768, v20
    ds_read_b128 v[32:35], v22 offset:0
    ds_read_b128 v[36:39], v22 offset:4096
    ds_read_b64_tr_b16 v[40:41], v26 offset:0
    ds_read_b64_tr_b16 v[42:43], v26 offset:1024
    ds_read_b128 v[48:51], v23 offset:0
    ds_read_b128 v[52:55], v23 offset:4096
    ds_read_b64_tr_b16 v[56:57], v26 offset:4096
    ds_read_b64_tr_b16 v[58:59], v26 offset:5120
    s_waitcnt lgkmcnt(4)
    v_mfma_f32_32x32x16_bf16 v[64:79], v[40:43], v[32:35], v[64:79]
    v_mfma_f32_32x32x16_bf16 v[80:95], v[40:43], v[36:39], v[80:95]
    ds_read_b128 v[32:35], v24 offset:0
    ds_read_b128 v[36:39], v24 offset:4096
    ds_read_b64_tr_b16 v[40:41], v26 offset:8192
    ds_read_b64_tr_b16 v[42:43], v26 offset:9216
    s_waitcnt lgkmcnt(4)
    v_mfma_f32_32x32x16_bf16 v[64:79], v[56:59], v[48:51], v[64:79]
    v_mfma_f32_32x32x16_bf16 v[80:95], v[56:59], v[52:55], v[80:95]
    ds_read_b128 v[48:51], v25 offset:0
    ds_read_b128 v[52:55], v25 offset:4096
    ds_read_b64_tr_b16 v[56:57], v26 offset:12288
    ds_read_b64_tr_b16 v[58:59], v26 offset:13312
    s_waitcnt lgkmcnt(4)
    v_mfma_f32_32x32x16_bf16 v[64:79], v[40:43], v[32:35], v[64:79]
    v_mfma_f32_32x32x16_bf16 v[80:95], v[40:43], v[36:39], v[80:95]
    s_waitcnt lgkmcnt(0)
    v_mfma_f32_32x32x16_bf16 v[64:79], v[56:59], v[48:51], v[64:79]
    v_mfma_f32_32x32x16_bf16 v[80:95], v[56:59], v[52:55], v[80:95]
    s_waitcnt vmcnt(0) lgkmcnt(0)
    s_barrier
    v_add_u32 v22, 65536, v10
    v_add_u32 v23, 65536, v11
    v_add_u32 v24, 65536, v12
    v_add_u32 v25, 65536, v13
    v_add_u32 v26, 65536, v20
    ds_read_b128 v[32:35], v22 offset:0
    ds_read_b128 v[36:39], v22 offset:4096
    ds_read_b64_tr_b16 v[40:41], v26 offset:0
    ds_read_b64_tr_b16 v[42:43], v26 offset:1024
    ds_read_b128 v[48:51], v23 offset:0
    ds_read_b128 v[52:55], v23 offset:4096
    ds_read_b64_tr_b16 v[56:57], v26 offset:4096
    ds_read_b64_tr_b16 v[58:59], v26 offset:5120
    s_waitcnt lgkmcnt(4)
    v_mfma_f32_32x32x16_bf16 v[64:79], v[40:43], v[32:35], v[64:79]
    v_mfma_f32_32x32x16_bf16 v[80:95], v[40:43], v[36:39], v[80:95]
    ds_read_b128 v[32:35], v24 offset:0
    ds_read_b128 v[36:39], v24 offset:4096
    ds_read_b64_tr_b16 v[40:41], v26 offset:8192
    ds_read_b64_tr_b16 v[42:43], v26 offset:9216
    s_waitcnt lgkmcnt(4)
    v_mfma_f32_32x32x16_bf16 v[64:79], v[56:59], v[48:51], v[64:79]
    v_mfma_f32_32x32x16_bf16 v[80:95], v[56:59], v[52:55], v[80:95]
    ds_read_b128 v[48:51], v25 offset:0
    ds_read_b128 v[52:55], v25 offset:4096
    ds_read_b64_tr_b16 v[56:57], v26 offset:12288
    ds_read_b64_tr_b16 v[58:59], v26 offset:13312
    s_waitcnt lgkmcnt(4)
    v_mfma_f32_32x32x16_bf16 v[64:79], v[40:43], v[32:35], v[64:79]
    v_mfma_f32_32x32x16_bf16 v[80:95], v[40:43], v[36:39], v[80:95]
    s_waitcnt lgkmcnt(0)
    v_mfma_f32_32x32x16_bf16 v[64:79], v[56:59], v[48:51], v[64:79]
    v_mfma_f32_32x32x16_bf16 v[80:95], v[56:59], v[52:55], v[80:95]
    s_nop 15
    v_mul_u32_u24 v17, 3584, v9
    v_lshl_add_u32 v17, v14, 3, v17
    s_mul_i32 s31, s30, 64
    v_add_u32 v17, s31, v17
    s_mul_i32 s41, s26, 3584
    s_lshl_b32 s42, s27, 1
    s_add_u32 s41, s41, s42
    s_add_u32 s42, s41, 0
    v_cvt_pk_bf16_f32 v28, v64, v65
    v_cvt_pk_bf16_f32 v29, v66, v67
    v_lshlrev_b32 v48, 16, v28
    v_and_b32 v49, 0xffff0000, v28
    v_lshlrev_b32 v50, 16, v29
    v_and_b32 v51, 0xffff0000, v29
    v_mul_f32 v52, v48, v48
    v_mul_f32 v52, 0xbdd2d3e8, v52
    v_add_f32 v52, 0xc0135761, v52
    v_mul_f32 v52, v52, v48
    v_exp_f32 v52, v52
    v_mul_f32 v53, v49, v49
    v_mul_f32 v53, 0xbdd2d3e8, v53
    v_add_f32 v53, 0xc0135761, v53
    v_mul_f32 v53, v53, v49
    v_exp_f32 v53, v53
    v_mul_f32 v54, v50, v50
    v_mul_f32 v54, 0xbdd2d3e8, v54
    v_add_f32 v54, 0xc0135761, v54
    v_mul_f32 v54, v54, v50
    v_exp_f32 v54, v54
    v_mul_f32 v55, v51, v51
    v_mul_f32 v55, 0xbdd2d3e8, v55
    v_add_f32 v55, 0xc0135761, v55
    v_mul_f32 v55, v55, v51
    v_exp_f32 v55, v55
    s_nop 0
    v_add_f32 v52, 1.0, v52
    v_add_f32 v53, 1.0, v53
    v_add_f32 v54, 1.0, v54
    v_add_f32 v55, 1.0, v55
    v_rcp_f32 v52, v52
    v_rcp_f32 v53, v53
    v_rcp_f32 v54, v54
    v_rcp_f32 v55, v55
    s_nop 0
    v_mul_f32 v48, v48, v52
    v_mul_f32 v49, v49, v53
    v_mul_f32 v50, v50, v54
    v_mul_f32 v51, v51, v55
    v_cvt_pk_bf16_f32 v28, v48, v49
    v_cvt_pk_bf16_f32 v29, v50, v51
    buffer_store_dwordx2 v[28:29], v17, s[12:15], s42 offen offset:0
    s_nop 1
    v_cvt_pk_bf16_f32 v28, v68, v69
    v_cvt_pk_bf16_f32 v29, v70, v71
    v_lshlrev_b32 v48, 16, v28
    v_and_b32 v49, 0xffff0000, v28
    v_lshlrev_b32 v50, 16, v29
    v_and_b32 v51, 0xffff0000, v29
    v_mul_f32 v52, v48, v48
    v_mul_f32 v52, 0xbdd2d3e8, v52
    v_add_f32 v52, 0xc0135761, v52
    v_mul_f32 v52, v52, v48
    v_exp_f32 v52, v52
    v_mul_f32 v53, v49, v49
    v_mul_f32 v53, 0xbdd2d3e8, v53
    v_add_f32 v53, 0xc0135761, v53
    v_mul_f32 v53, v53, v49
    v_exp_f32 v53, v53
    v_mul_f32 v54, v50, v50
    v_mul_f32 v54, 0xbdd2d3e8, v54
    v_add_f32 v54, 0xc0135761, v54
    v_mul_f32 v54, v54, v50
    v_exp_f32 v54, v54
    v_mul_f32 v55, v51, v51
    v_mul_f32 v55, 0xbdd2d3e8, v55
    v_add_f32 v55, 0xc0135761, v55
    v_mul_f32 v55, v55, v51
    v_exp_f32 v55, v55
    s_nop 0
    v_add_f32 v52, 1.0, v52
    v_add_f32 v53, 1.0, v53
    v_add_f32 v54, 1.0, v54
    v_add_f32 v55, 1.0, v55
    v_rcp_f32 v52, v52
    v_rcp_f32 v53, v53
    v_rcp_f32 v54, v54
    v_rcp_f32 v55, v55
    s_nop 0
    v_mul_f32 v48, v48, v52
    v_mul_f32 v49, v49, v53
    v_mul_f32 v50, v50, v54
    v_mul_f32 v51, v51, v55
    v_cvt_pk_bf16_f32 v28, v48, v49
    v_cvt_pk_bf16_f32 v29, v50, v51
    buffer_store_dwordx2 v[28:29], v17, s[12:15], s42 offen offset:16
    s_nop 1
    v_cvt_pk_bf16_f32 v28, v72, v73
    v_cvt_pk_bf16_f32 v29, v74, v75
    v_lshlrev_b32 v48, 16, v28
    v_and_b32 v49, 0xffff0000, v28
    v_lshlrev_b32 v50, 16, v29
    v_and_b32 v51, 0xffff0000, v29
    v_mul_f32 v52, v48, v48
    v_mul_f32 v52, 0xbdd2d3e8, v52
    v_add_f32 v52, 0xc0135761, v52
    v_mul_f32 v52, v52, v48
    v_exp_f32 v52, v52
    v_mul_f32 v53, v49, v49
    v_mul_f32 v53, 0xbdd2d3e8, v53
    v_add_f32 v53, 0xc0135761, v53
    v_mul_f32 v53, v53, v49
    v_exp_f32 v53, v53
    v_mul_f32 v54, v50, v50
    v_mul_f32 v54, 0xbdd2d3e8, v54
    v_add_f32 v54, 0xc0135761, v54
    v_mul_f32 v54, v54, v50
    v_exp_f32 v54, v54
    v_mul_f32 v55, v51, v51
    v_mul_f32 v55, 0xbdd2d3e8, v55
    v_add_f32 v55, 0xc0135761, v55
    v_mul_f32 v55, v55, v51
    v_exp_f32 v55, v55
    s_nop 0
    v_add_f32 v52, 1.0, v52
    v_add_f32 v53, 1.0, v53
    v_add_f32 v54, 1.0, v54
    v_add_f32 v55, 1.0, v55
    v_rcp_f32 v52, v52
    v_rcp_f32 v53, v53
    v_rcp_f32 v54, v54
    v_rcp_f32 v55, v55
    s_nop 0
    v_mul_f32 v48, v48, v52
    v_mul_f32 v49, v49, v53
    v_mul_f32 v50, v50, v54
    v_mul_f32 v51, v51, v55
    v_cvt_pk_bf16_f32 v28, v48, v49
    v_cvt_pk_bf16_f32 v29, v50, v51
    buffer_store_dwordx2 v[28:29], v17, s[12:15], s42 offen offset:32
    s_nop 1
    v_cvt_pk_bf16_f32 v28, v76, v77
    v_cvt_pk_bf16_f32 v29, v78, v79
    v_lshlrev_b32 v48, 16, v28
    v_and_b32 v49, 0xffff0000, v28
    v_lshlrev_b32 v50, 16, v29
    v_and_b32 v51, 0xffff0000, v29
    v_mul_f32 v52, v48, v48
    v_mul_f32 v52, 0xbdd2d3e8, v52
    v_add_f32 v52, 0xc0135761, v52
    v_mul_f32 v52, v52, v48
    v_exp_f32 v52, v52
    v_mul_f32 v53, v49, v49
    v_mul_f32 v53, 0xbdd2d3e8, v53
    v_add_f32 v53, 0xc0135761, v53
    v_mul_f32 v53, v53, v49
    v_exp_f32 v53, v53
    v_mul_f32 v54, v50, v50
    v_mul_f32 v54, 0xbdd2d3e8, v54
    v_add_f32 v54, 0xc0135761, v54
    v_mul_f32 v54, v54, v50
    v_exp_f32 v54, v54
    v_mul_f32 v55, v51, v51
    v_mul_f32 v55, 0xbdd2d3e8, v55
    v_add_f32 v55, 0xc0135761, v55
    v_mul_f32 v55, v55, v51
    v_exp_f32 v55, v55
    s_nop 0
    v_add_f32 v52, 1.0, v52
    v_add_f32 v53, 1.0, v53
    v_add_f32 v54, 1.0, v54
    v_add_f32 v55, 1.0, v55
    v_rcp_f32 v52, v52
    v_rcp_f32 v53, v53
    v_rcp_f32 v54, v54
    v_rcp_f32 v55, v55
    s_nop 0
    v_mul_f32 v48, v48, v52
    v_mul_f32 v49, v49, v53
    v_mul_f32 v50, v50, v54
    v_mul_f32 v51, v51, v55
    v_cvt_pk_bf16_f32 v28, v48, v49
    v_cvt_pk_bf16_f32 v29, v50, v51
    buffer_store_dwordx2 v[28:29], v17, s[12:15], s42 offen offset:48
    s_nop 1
    s_add_u32 s42, s41, 114688
    v_cvt_pk_bf16_f32 v28, v80, v81
    v_cvt_pk_bf16_f32 v29, v82, v83
    v_lshlrev_b32 v48, 16, v28
    v_and_b32 v49, 0xffff0000, v28
    v_lshlrev_b32 v50, 16, v29
    v_and_b32 v51, 0xffff0000, v29
    v_mul_f32 v52, v48, v48
    v_mul_f32 v52, 0xbdd2d3e8, v52
    v_add_f32 v52, 0xc0135761, v52
    v_mul_f32 v52, v52, v48
    v_exp_f32 v52, v52
    v_mul_f32 v53, v49, v49
    v_mul_f32 v53, 0xbdd2d3e8, v53
    v_add_f32 v53, 0xc0135761, v53
    v_mul_f32 v53, v53, v49
    v_exp_f32 v53, v53
    v_mul_f32 v54, v50, v50
    v_mul_f32 v54, 0xbdd2d3e8, v54
    v_add_f32 v54, 0xc0135761, v54
    v_mul_f32 v54, v54, v50
    v_exp_f32 v54, v54
    v_mul_f32 v55, v51, v51
    v_mul_f32 v55, 0xbdd2d3e8, v55
    v_add_f32 v55, 0xc0135761, v55
    v_mul_f32 v55, v55, v51
    v_exp_f32 v55, v55
    s_nop 0
    v_add_f32 v52, 1.0, v52
    v_add_f32 v53, 1.0, v53
    v_add_f32 v54, 1.0, v54
    v_add_f32 v55, 1.0, v55
    v_rcp_f32 v52, v52
    v_rcp_f32 v53, v53
    v_rcp_f32 v54, v54
    v_rcp_f32 v55, v55
    s_nop 0
    v_mul_f32 v48, v48, v52
    v_mul_f32 v49, v49, v53
    v_mul_f32 v50, v50, v54
    v_mul_f32 v51, v51, v55
    v_cvt_pk_bf16_f32 v28, v48, v49
    v_cvt_pk_bf16_f32 v29, v50, v51
    buffer_store_dwordx2 v[28:29], v17, s[12:15], s42 offen offset:0
    s_nop 1
    v_cvt_pk_bf16_f32 v28, v84, v85
    v_cvt_pk_bf16_f32 v29, v86, v87
    v_lshlrev_b32 v48, 16, v28
    v_and_b32 v49, 0xffff0000, v28
    v_lshlrev_b32 v50, 16, v29
    v_and_b32 v51, 0xffff0000, v29
    v_mul_f32 v52, v48, v48
    v_mul_f32 v52, 0xbdd2d3e8, v52
    v_add_f32 v52, 0xc0135761, v52
    v_mul_f32 v52, v52, v48
    v_exp_f32 v52, v52
    v_mul_f32 v53, v49, v49
    v_mul_f32 v53, 0xbdd2d3e8, v53
    v_add_f32 v53, 0xc0135761, v53
    v_mul_f32 v53, v53, v49
    v_exp_f32 v53, v53
    v_mul_f32 v54, v50, v50
    v_mul_f32 v54, 0xbdd2d3e8, v54
    v_add_f32 v54, 0xc0135761, v54
    v_mul_f32 v54, v54, v50
    v_exp_f32 v54, v54
    v_mul_f32 v55, v51, v51
    v_mul_f32 v55, 0xbdd2d3e8, v55
    v_add_f32 v55, 0xc0135761, v55
    v_mul_f32 v55, v55, v51
    v_exp_f32 v55, v55
    s_nop 0
    v_add_f32 v52, 1.0, v52
    v_add_f32 v53, 1.0, v53
    v_add_f32 v54, 1.0, v54
    v_add_f32 v55, 1.0, v55
    v_rcp_f32 v52, v52
    v_rcp_f32 v53, v53
    v_rcp_f32 v54, v54
    v_rcp_f32 v55, v55
    s_nop 0
    v_mul_f32 v48, v48, v52
    v_mul_f32 v49, v49, v53
    v_mul_f32 v50, v50, v54
    v_mul_f32 v51, v51, v55
    v_cvt_pk_bf16_f32 v28, v48, v49
    v_cvt_pk_bf16_f32 v29, v50, v51
    buffer_store_dwordx2 v[28:29], v17, s[12:15], s42 offen offset:16
    s_nop 1
    v_cvt_pk_bf16_f32 v28, v88, v89
    v_cvt_pk_bf16_f32 v29, v90, v91
    v_lshlrev_b32 v48, 16, v28
    v_and_b32 v49, 0xffff0000, v28
    v_lshlrev_b32 v50, 16, v29
    v_and_b32 v51, 0xffff0000, v29
    v_mul_f32 v52, v48, v48
    v_mul_f32 v52, 0xbdd2d3e8, v52
    v_add_f32 v52, 0xc0135761, v52
    v_mul_f32 v52, v52, v48
    v_exp_f32 v52, v52
    v_mul_f32 v53, v49, v49
    v_mul_f32 v53, 0xbdd2d3e8, v53
    v_add_f32 v53, 0xc0135761, v53
    v_mul_f32 v53, v53, v49
    v_exp_f32 v53, v53
    v_mul_f32 v54, v50, v50
    v_mul_f32 v54, 0xbdd2d3e8, v54
    v_add_f32 v54, 0xc0135761, v54
    v_mul_f32 v54, v54, v50
    v_exp_f32 v54, v54
    v_mul_f32 v55, v51, v51
    v_mul_f32 v55, 0xbdd2d3e8, v55
    v_add_f32 v55, 0xc0135761, v55
    v_mul_f32 v55, v55, v51
    v_exp_f32 v55, v55
    s_nop 0
    v_add_f32 v52, 1.0, v52
    v_add_f32 v53, 1.0, v53
    v_add_f32 v54, 1.0, v54
    v_add_f32 v55, 1.0, v55
    v_rcp_f32 v52, v52
    v_rcp_f32 v53, v53
    v_rcp_f32 v54, v54
    v_rcp_f32 v55, v55
    s_nop 0
    v_mul_f32 v48, v48, v52
    v_mul_f32 v49, v49, v53
    v_mul_f32 v50, v50, v54
    v_mul_f32 v51, v51, v55
    v_cvt_pk_bf16_f32 v28, v48, v49
    v_cvt_pk_bf16_f32 v29, v50, v51
    buffer_store_dwordx2 v[28:29], v17, s[12:15], s42 offen offset:32
    s_nop 1
    v_cvt_pk_bf16_f32 v28, v92, v93
    v_cvt_pk_bf16_f32 v29, v94, v95
    v_lshlrev_b32 v48, 16, v28
    v_and_b32 v49, 0xffff0000, v28
    v_lshlrev_b32 v50, 16, v29
    v_and_b32 v51, 0xffff0000, v29
    v_mul_f32 v52, v48, v48
    v_mul_f32 v52, 0xbdd2d3e8, v52
    v_add_f32 v52, 0xc0135761, v52
    v_mul_f32 v52, v52, v48
    v_exp_f32 v52, v52
    v_mul_f32 v53, v49, v49
    v_mul_f32 v53, 0xbdd2d3e8, v53
    v_add_f32 v53, 0xc0135761, v53
    v_mul_f32 v53, v53, v49
    v_exp_f32 v53, v53
    v_mul_f32 v54, v50, v50
    v_mul_f32 v54, 0xbdd2d3e8, v54
    v_add_f32 v54, 0xc0135761, v54
    v_mul_f32 v54, v54, v50
    v_exp_f32 v54, v54
    v_mul_f32 v55, v51, v51
    v_mul_f32 v55, 0xbdd2d3e8, v55
    v_add_f32 v55, 0xc0135761, v55
    v_mul_f32 v55, v55, v51
    v_exp_f32 v55, v55
    s_nop 0
    v_add_f32 v52, 1.0, v52
    v_add_f32 v53, 1.0, v53
    v_add_f32 v54, 1.0, v54
    v_add_f32 v55, 1.0, v55
    v_rcp_f32 v52, v52
    v_rcp_f32 v53, v53
    v_rcp_f32 v54, v54
    v_rcp_f32 v55, v55
    s_nop 0
    v_mul_f32 v48, v48, v52
    v_mul_f32 v49, v49, v53
    v_mul_f32 v50, v50, v54
    v_mul_f32 v51, v51, v55
    v_cvt_pk_bf16_f32 v28, v48, v49
    v_cvt_pk_bf16_f32 v29, v50, v51
    buffer_store_dwordx2 v[28:29], v17, s[12:15], s42 offen offset:48
    s_nop 1
L_end_27:
    s_endpgm
.globl k4b_lnz_kernel
.p2align 8
.type k4b_lnz_kernel,@function
k4b_lnz_kernel:
    s_cmp_ge_u32 s2, 256
    s_cbranch_scc1 L_end_28
    s_load_dwordx2 s[4:5], s[0:1], 80
    s_load_dwordx2 s[8:9], s[0:1], 80
    v_and_b32 v1, 63, v0
    v_lshrrev_b32 v2, 6, v0
    s_nop 0
    v_readfirstlane_b32 s28, v2
    s_waitcnt lgkmcnt(0)
    s_add_u32 s4, s4, 0xa00700
    s_addc_u32 s5, s5, 0
    s_mov_b32 s6, 0x6ff900
    s_mov_b32 s7, 0x00020000
    s_add_u32 s8, s8, 0x1a00000
    s_addc_u32 s9, s9, 0
    s_mov_b32 s10, 0x380000
    s_mov_b32 s11, 0x00020000
    s_lshl_b32 s24, s2, 2
    s_add_u32 s24, s24, s28
    s_mul_i32 s24, s24, 2
    s_mul_i32 s25, s24, 3584
    s_mul_i32 s26, s24, 1792
    v_lshlrev_b32 v3, 4, v1
    v_mov_b32 v4, 0x3f803f80
    v_cmp_gt_u32 s[30:31], 48, v1
    buffer_load_dwordx4 v[16:19], v3, s[4:7], s25 offen offset:0
    v_mov_b32 v20, 0
    v_mov_b32 v21, 0
    v_mov_b32 v22, 0
    v_mov_b32 v23, 0
    s_mov_b64 exec, s[30:31]
    buffer_load_dwordx4 v[20:23], v3, s[4:7], s25 offen offset:1024
    s_mov_b64 exec, -1
    s_add_u32 s25, s25, 3584
    buffer_load_dwordx4 v[24:27], v3, s[4:7], s25 offen offset:0
    v_mov_b32 v28, 0
    v_mov_b32 v29, 0
    v_mov_b32 v30, 0
    v_mov_b32 v31, 0
    s_mov_b64 exec, s[30:31]
    buffer_load_dwordx4 v[28:31], v3, s[4:7], s25 offen offset:1024
    s_mov_b64 exec, -1
    s_add_u32 s25, s25, 3584
    v_mov_b32 v6, 0
    v_mov_b32 v7, 0
    v_mov_b32 v8, 0
    v_mov_b32 v9, 0
    s_waitcnt vmcnt(2)
    v_dot2_f32_bf16 v6, v16, v4, v6
    v_dot2_f32_bf16 v7, v16, v16, v7
    v_dot2_f32_bf16 v6, v17, v4, v6
    v_dot2_f32_bf16 v7, v17, v17, v7
    v_dot2_f32_bf16 v6, v18, v4, v6
    v_dot2_f32_bf16 v7, v18, v18, v7
    v_dot2_f32_bf16 v6, v19, v4, v6
    v_dot2_f32_bf16 v7, v19, v19, v7
    v_dot2_f32_bf16 v6, v20, v4, v6
    v_dot2_f32_bf16 v7, v20, v20, v7
    v_dot2_f32_bf16 v6, v21, v4, v6
    v_dot2_f32_bf16 v7, v21, v21, v7
    v_dot2_f32_bf16 v6, v22, v4, v6
    v_dot2_f32_bf16 v7, v22, v22, v7
    v_dot2_f32_bf16 v6, v23, v4, v6
    v_dot2_f32_bf16 v7, v23, v23, v7
    s_waitcnt vmcnt(0)
    v_dot2_f32_bf16 v8, v24, v4, v8
    v_dot2_f32_bf16 v9, v24, v24, v9
    v_dot2_f32_bf16 v8, v25, v4, v8
    v_dot2_f32_bf16 v9, v25, v25, v9
    v_dot2_f32_bf16 v8, v26, v4, v8
    v_dot2_f32_bf16 v9, v26, v26, v9
    v_dot2_f32_bf16 v8, v27, v4, v8
    v_dot2_f32_bf16 v9, v27, v27, v9
    v_dot2_f32_bf16 v8, v28, v4, v8
    v_dot2_f32_bf16 v9, v28, v28, v9
    v_dot2_f32_bf16 v8, v29, v4, v8
    v_dot2_f32_bf16 v9, v29, v29, v9
    v_dot2_f32_bf16 v8, v30, v4, v8
    v_dot2_f32_bf16 v9, v30, v30, v9
    v_dot2_f32_bf16 v8, v31, v4, v8
    v_dot2_f32_bf16 v9, v31, v31, v9
    s_nop 3
    s_nop 1
    v_add_f32_dpp v6, v6, v6 quad_perm:[1,0,3,2] row_mask:0xf bank_mask:0xf
    v_add_f32_dpp v7, v7, v7 quad_perm:[1,0,3,2] row_mask:0xf bank_mask:0xf
    v_add_f32_dpp v8, v8, v8 quad_perm:[1,0,3,2] row_mask:0xf bank_mask:0xf
    v_add_f32_dpp v9, v9, v9 quad_perm:[1,0,3,2] row_mask:0xf bank_mask:0xf
    s_nop 1
    v_add_f32_dpp v6, v6, v6 quad_perm:[2,3,0,1] row_mask:0xf bank_mask:0xf
    v_add_f32_dpp v7, v7, v7 quad_perm:[2,3,0,1] row_mask:0xf bank_mask:0xf
    v_add_f32_dpp v8, v8, v8 quad_perm:[2,3,0,1] row_mask:0xf bank_mask:0xf
    v_add_f32_dpp v9, v9, v9 quad_perm:[2,3,0,1] row_mask:0xf bank_mask:0xf
    s_nop 1
    v_add_f32_dpp v6, v6, v6 row_ror:4 row_mask:0xf bank_mask:0xf
    v_add_f32_dpp v7, v7, v7 row_ror:4 row_mask:0xf bank_mask:0xf
    v_add_f32_dpp v8, v8, v8 row_ror:4 row_mask:0xf bank_mask:0xf
    v_add_f32_dpp v9, v9, v9 row_ror:4 row_mask:0xf bank_mask:0xf
    s_nop 1
    v_add_f32_dpp v6, v6, v6 row_ror:8 row_mask:0xf bank_mask:0xf
    v_add_f32_dpp v7, v7, v7 row_ror:8 row_mask:0xf bank_mask:0xf
    v_add_f32_dpp v8, v8, v8 row_ror:8 row_mask:0xf bank_mask:0xf
    v_add_f32_dpp v9, v9, v9 row_ror:8 row_mask:0xf bank_mask:0xf
    v_mov_b32 v10, v6
    v_mov_b32 v11, v7
    v_mov_b32 v12, v8
    v_mov_b32 v13, v9
    s_nop 1
    v_permlane16_swap_b32 v10, v6
    v_permlane16_swap_b32 v11, v7
    v_permlane16_swap_b32 v12, v8
    v_permlane16_swap_b32 v13, v9
    v_add_f32 v6, v6, v10
    v_add_f32 v7, v7, v11
    v_add_f32 v8, v8, v12
    v_add_f32 v9, v9, v13
    v_mov_b32 v10, v6
    v_mov_b32 v11, v7
    v_mov_b32 v12, v8
    v_mov_b32 v13, v9
    s_nop 1
    v_permlane32_swap_b32 v10, v6
    v_permlane32_swap_b32 v11, v7
    v_permlane32_swap_b32 v12, v8
    v_permlane32_swap_b32 v13, v9
    v_add_f32 v6, v6, v10
    v_add_f32 v7, v7, v11
    v_add_f32 v8, v8, v12
    v_add_f32 v9, v9, v13
    v_mul_f32 v6, 0x3a924925, v6
    v_mul_f32 v7, 0x3a924925, v7
    v_fma_f32 v7, -v6, v6, v7
    v_max_f32 v7, 0, v7
    v_cvt_pk_bf16_f32 v10, v6, v7
    v_lshlrev_b32 v6, 16, v10
    v_and_b32 v7, 0xffff0000, v10
    v_add_f32 v7, 0x3727c5ac, v7
    v_cvt_pk_bf16_f32 v10, v7, v7
    v_lshlrev_b32 v7, 16, v10
    v_sqrt_f32 v7, v7
    s_nop 0
    v_cvt_pk_bf16_f32 v10, v7, v7
    v_lshlrev_b32 v7, 16, v10
    v_rcp_f32 v7, v7
    s_nop 0
    v_lshlrev_b32 v10, 16, v16
    v_and_b32 v11, 0xffff0000, v16
    v_sub_f32 v10, v10, v6
    v_sub_f32 v11, v11, v6
    v_cvt_pk_bf16_f32 v16, v10, v11
    v_lshlrev_b32 v10, 16, v16
    v_and_b32 v11, 0xffff0000, v16
    v_mul_f32 v10, v10, v7
    v_mul_f32 v11, v11, v7
    v_cvt_pk_bf16_f32 v16, v10, v11
    v_lshlrev_b32 v10, 16, v17
    v_and_b32 v11, 0xffff0000, v17
    v_sub_f32 v10, v10, v6
    v_sub_f32 v11, v11, v6
    v_cvt_pk_bf16_f32 v17, v10, v11
    v_lshlrev_b32 v10, 16, v17
    v_and_b32 v11, 0xffff0000, v17
    v_mul_f32 v10, v10, v7
    v_mul_f32 v11, v11, v7
    v_cvt_pk_bf16_f32 v17, v10, v11
    v_lshlrev_b32 v10, 16, v18
    v_and_b32 v11, 0xffff0000, v18
    v_sub_f32 v10, v10, v6
    v_sub_f32 v11, v11, v6
    v_cvt_pk_bf16_f32 v18, v10, v11
    v_lshlrev_b32 v10, 16, v18
    v_and_b32 v11, 0xffff0000, v18
    v_mul_f32 v10, v10, v7
    v_mul_f32 v11, v11, v7
    v_cvt_pk_bf16_f32 v18, v10, v11
    v_lshlrev_b32 v10, 16, v19
    v_and_b32 v11, 0xffff0000, v19
    v_sub_f32 v10, v10, v6
    v_sub_f32 v11, v11, v6
    v_cvt_pk_bf16_f32 v19, v10, v11
    v_lshlrev_b32 v10, 16, v19
    v_and_b32 v11, 0xffff0000, v19
    v_mul_f32 v10, v10, v7
    v_mul_f32 v11, v11, v7
    v_cvt_pk_bf16_f32 v19, v10, v11
    v_lshlrev_b32 v10, 16, v20
    v_and_b32 v11, 0xffff0000, v20
    v_sub_f32 v10, v10, v6
    v_sub_f32 v11, v11, v6
    v_cvt_pk_bf16_f32 v20, v10, v11
    v_lshlrev_b32 v10, 16, v20
    v_and_b32 v11, 0xffff0000, v20
    v_mul_f32 v10, v10, v7
    v_mul_f32 v11, v11, v7
    v_cvt_pk_bf16_f32 v20, v10, v11
    v_lshlrev_b32 v10, 16, v21
    v_and_b32 v11, 0xffff0000, v21
    v_sub_f32 v10, v10, v6
    v_sub_f32 v11, v11, v6
    v_cvt_pk_bf16_f32 v21, v10, v11
    v_lshlrev_b32 v10, 16, v21
    v_and_b32 v11, 0xffff0000, v21
    v_mul_f32 v10, v10, v7
    v_mul_f32 v11, v11, v7
    v_cvt_pk_bf16_f32 v21, v10, v11
    v_lshlrev_b32 v10, 16, v22
    v_and_b32 v11, 0xffff0000, v22
    v_sub_f32 v10, v10, v6
    v_sub_f32 v11, v11, v6
    v_cvt_pk_bf16_f32 v22, v10, v11
    v_lshlrev_b32 v10, 16, v22
    v_and_b32 v11, 0xffff0000, v22
    v_mul_f32 v10, v10, v7
    v_mul_f32 v11, v11, v7
    v_cvt_pk_bf16_f32 v22, v10, v11
    v_lshlrev_b32 v10, 16, v23
    v_and_b32 v11, 0xffff0000, v23
    v_sub_f32 v10, v10, v6
    v_sub_f32 v11, v11, v6
    v_cvt_pk_bf16_f32 v23, v10, v11
    v_lshlrev_b32 v10, 16, v23
    v_and_b32 v11, 0xffff0000, v23
    v_mul_f32 v10, v10, v7
    v_mul_f32 v11, v11, v7
    v_cvt_pk_bf16_f32 v23, v10, v11
    buffer_store_dwordx4 v[16:19], v3, s[8:11], s26 offen offset:0
    s_mov_b64 exec, s[30:31]
    buffer_store_dwordx4 v[20:23], v3, s[8:11], s26 offen offset:1024
    s_mov_b64 exec, -1
    s_add_u32 s26, s26, 1792
    v_mul_f32 v8, 0x3a924925, v8
    v_mul_f32 v9, 0x3a924925, v9
    v_fma_f32 v9, -v8, v8, v9
    v_max_f32 v9, 0, v9
    v_cvt_pk_bf16_f32 v10, v8, v9
    v_lshlrev_b32 v8, 16, v10
    v_and_b32 v9, 0xffff0000, v10
    v_add_f32 v9, 0x3727c5ac, v9
    v_cvt_pk_bf16_f32 v10, v9, v9
    v_lshlrev_b32 v9, 16, v10
    v_sqrt_f32 v9, v9
    s_nop 0
    v_cvt_pk_bf16_f32 v10, v9, v9
    v_lshlrev_b32 v9, 16, v10
    v_rcp_f32 v9, v9
    s_nop 0
    v_lshlrev_b32 v10, 16, v24
    v_and_b32 v11, 0xffff0000, v24
    v_sub_f32 v10, v10, v8
    v_sub_f32 v11, v11, v8
    v_cvt_pk_bf16_f32 v24, v10, v11
    v_lshlrev_b32 v10, 16, v24
    v_and_b32 v11, 0xffff0000, v24
    v_mul_f32 v10, v10, v9
    v_mul_f32 v11, v11, v9
    v_cvt_pk_bf16_f32 v24, v10, v11
    v_lshlrev_b32 v10, 16, v25
    v_and_b32 v11, 0xffff0000, v25
    v_sub_f32 v10, v10, v8
    v_sub_f32 v11, v11, v8
    v_cvt_pk_bf16_f32 v25, v10, v11
    v_lshlrev_b32 v10, 16, v25
    v_and_b32 v11, 0xffff0000, v25
    v_mul_f32 v10, v10, v9
    v_mul_f32 v11, v11, v9
    v_cvt_pk_bf16_f32 v25, v10, v11
    v_lshlrev_b32 v10, 16, v26
    v_and_b32 v11, 0xffff0000, v26
    v_sub_f32 v10, v10, v8
    v_sub_f32 v11, v11, v8
    v_cvt_pk_bf16_f32 v26, v10, v11
    v_lshlrev_b32 v10, 16, v26
    v_and_b32 v11, 0xffff0000, v26
    v_mul_f32 v10, v10, v9
    v_mul_f32 v11, v11, v9
    v_cvt_pk_bf16_f32 v26, v10, v11
    v_lshlrev_b32 v10, 16, v27
    v_and_b32 v11, 0xffff0000, v27
    v_sub_f32 v10, v10, v8
    v_sub_f32 v11, v11, v8
    v_cvt_pk_bf16_f32 v27, v10, v11
    v_lshlrev_b32 v10, 16, v27
    v_and_b32 v11, 0xffff0000, v27
    v_mul_f32 v10, v10, v9
    v_mul_f32 v11, v11, v9
    v_cvt_pk_bf16_f32 v27, v10, v11
    v_lshlrev_b32 v10, 16, v28
    v_and_b32 v11, 0xffff0000, v28
    v_sub_f32 v10, v10, v8
    v_sub_f32 v11, v11, v8
    v_cvt_pk_bf16_f32 v28, v10, v11
    v_lshlrev_b32 v10, 16, v28
    v_and_b32 v11, 0xffff0000, v28
    v_mul_f32 v10, v10, v9
    v_mul_f32 v11, v11, v9
    v_cvt_pk_bf16_f32 v28, v10, v11
    v_lshlrev_b32 v10, 16, v29
    v_and_b32 v11, 0xffff0000, v29
    v_sub_f32 v10, v10, v8
    v_sub_f32 v11, v11, v8
    v_cvt_pk_bf16_f32 v29, v10, v11
    v_lshlrev_b32 v10, 16, v29
    v_and_b32 v11, 0xffff0000, v29
    v_mul_f32 v10, v10, v9
    v_mul_f32 v11, v11, v9
    v_cvt_pk_bf16_f32 v29, v10, v11
    v_lshlrev_b32 v10, 16, v30
    v_and_b32 v11, 0xffff0000, v30
    v_sub_f32 v10, v10, v8
    v_sub_f32 v11, v11, v8
    v_cvt_pk_bf16_f32 v30, v10, v11
    v_lshlrev_b32 v10, 16, v30
    v_and_b32 v11, 0xffff0000, v30
    v_mul_f32 v10, v10, v9
    v_mul_f32 v11, v11, v9
    v_cvt_pk_bf16_f32 v30, v10, v11
    v_lshlrev_b32 v10, 16, v31
    v_and_b32 v11, 0xffff0000, v31
    v_sub_f32 v10, v10, v8
    v_sub_f32 v11, v11, v8
    v_cvt_pk_bf16_f32 v31, v10, v11
    v_lshlrev_b32 v10, 16, v31
    v_and_b32 v11, 0xffff0000, v31
    v_mul_f32 v10, v10, v9
    v_mul_f32 v11, v11, v9
    v_cvt_pk_bf16_f32 v31, v10, v11
    buffer_store_dwordx4 v[24:27], v3, s[8:11], s26 offen offset:0
    s_mov_b64 exec, s[30:31]
    buffer_store_dwordx4 v[28:31], v3, s[8:11], s26 offen offset:1024
    s_mov_b64 exec, -1
    s_add_u32 s26, s26, 1792
L_end_28:
    s_endpgm
.globl k5_sp_kernel
.p2align 8
.type k5_sp_kernel,@function
k5_sp_kernel:
    s_cmp_ge_u32 s2, 224
    s_cbranch_scc1 L_end_29
    s_load_dwordx2 s[4:5], s[0:1], 40
    s_load_dwordx2 s[8:9], s[0:1], 80
    s_load_dwordx2 s[12:13], s[0:1], 80
    s_load_dwordx2 s[16:17], s[0:1], 80
    s_load_dwordx2 s[48:49], s[0:1], 48
    s_and_b32 s24, s2, 31
    s_lshr_b32 s25, s2, 5
    s_mul_i32 s26, s24, 64
    s_mul_i32 s27, s25, 128
    v_and_b32 v1, 63, v0
    v_lshrrev_b32 v2, 6, v0
    s_nop 0
    v_readfirstlane_b32 s28, v2
    s_waitcnt lgkmcnt(0)
    s_mov_b32 s6, 0x800000
    s_mov_b32 s7, 0x00020000
    s_add_u32 s8, s8, 0x1a00000
    s_addc_u32 s9, s9, 0
    s_mov_b32 s10, 0x380000
    s_mov_b32 s11, 0x00020000
    s_add_u32 s12, s12, 0x1200000
    s_addc_u32 s13, s13, 0
    s_mov_b32 s14, 0x380000
    s_mov_b32 s15, 0x00020000
    s_add_u32 s16, s16, 0xa00000
    s_addc_u32 s17, s17, 0
    s_mov_b32 s18, 0x700000
    s_mov_b32 s19, 0x00020000
    s_mov_b32 s50, 0x1000
    s_mov_b32 s51, 0x00020000
    s_and_b32 s29, s28, 1
    s_lshr_b32 s30, s28, 1
    v_lshrrev_b32 v5, 3, v1
    v_lshrrev_b32 v6, 4, v1
    s_lshl_b32 s31, s29, 2
    v_add_u32 v7, s31, v6
    v_and_b32 v7, 7, v7
    v_and_b32 v8, 7, v1
    v_xor_b32 v7, v7, v8
    v_mul_u32_u24 v3, 4096, v5
    v_lshl_add_u32 v3, v7, 4, v3
    v_and_b32 v8, 15, v1
    v_lshlrev_b32 v7, 2, v6
    v_xor_b32 v7, v7, v8
    v_mul_u32_u24 v4, 1792, v6
    v_lshl_add_u32 v4, v7, 4, v4
    s_lshl_b32 s31, s28, 3
    s_add_u32 s31, s31, s26
    s_mul_i32 s32, s31, 4096
    s_mul_i32 s36, s28, 7168
    s_lshl_b32 s31, s27, 1
    s_add_u32 s36, s36, s31
    s_add_u32 s37, s36, 57344
    s_lshl_b32 s45, s28, 10
    v_and_b32 v9, 31, v1
    s_mul_i32 s31, s29, 32
    v_add_u32 v9, s31, v9
    v_lshrrev_b32 v14, 5, v1
    v_bfe_u32 v15, v1, 1, 3
    v_xor_b32 v15, v15, v14
    v_lshlrev_b32 v16, 7, v9
    v_xor_b32 v17, 0, v15
    v_lshl_add_u32 v10, v17, 4, v16
    v_xor_b32 v17, 2, v15
    v_lshl_add_u32 v11, v17, 4, v16
    v_xor_b32 v17, 4, v15
    v_lshl_add_u32 v12, v17, 4, v16
    v_xor_b32 v17, 6, v15
    v_lshl_add_u32 v13, v17, 4, v16
    v_bfe_u32 v15, v1, 2, 2
    v_lshl_add_u32 v16, v14, 3, v15
    v_mul_u32_u24 v16, 256, v16
    v_bfe_u32 v17, v1, 4, 1
    v_lshlrev_b32 v17, 1, v17
    v_bfe_u32 v18, v1, 1, 1
    v_add_u32 v17, v17, v18
    s_mul_i32 s31, s30, 4
    v_add_u32 v17, s31, v17
    v_lshlrev_b32 v15, 2, v15
    v_and_b32 v18, 1, v1
    v_lshl_add_u32 v16, v18, 3, v16
    v_add_u32 v16, 8192, v16
    v_add_u32 v18, 0, v17
    v_xor_b32 v18, v18, v15
    v_lshl_add_u32 v20, v18, 4, v16
    v_mov_b32 v64, 0
    v_mov_b32 v65, 0
    v_mov_b32 v66, 0
    v_mov_b32 v67, 0
    v_mov_b32 v68, 0
    v_mov_b32 v69, 0
    v_mov_b32 v70, 0
    v_mov_b32 v71, 0
    v_mov_b32 v72, 0
    v_mov_b32 v73, 0
    v_mov_b32 v74, 0
    v_mov_b32 v75, 0
    v_mov_b32 v76, 0
    v_mov_b32 v77, 0
    v_mov_b32 v78, 0
    v_mov_b32 v79, 0
    s_add_u32 m0, s45, 0
    s_add_u32 s46, s32, 0
    buffer_load_dwordx4 v3, s[4:7], s46 offen lds
    s_add_u32 m0, s45, 8192
    s_add_u32 s46, s36, 0
    buffer_load_dwordx4 v4, s[8:11], s46 offen lds
    s_add_u32 m0, s45, 16384
    s_add_u32 s46, s37, 0
    buffer_load_dwordx4 v4, s[8:11], s46 offen lds
    s_add_u32 m0, s45, 24576
    s_add_u32 s46, s32, 128
    buffer_load_dwordx4 v3, s[4:7], s46 offen lds
    s_add_u32 m0, s45, 32768
    s_add_u32 s46, s36, 114688
    buffer_load_dwordx4 v4, s[8:11], s46 offen lds
    s_add_u32 m0, s45, 40960
    s_add_u32 s46, s37, 114688
    buffer_load_dwordx4 v4, s[8:11], s46 offen lds
    s_add_u32 m0, s45, 49152
    s_add_u32 s46, s32, 256
    buffer_load_dwordx4 v3, s[4:7], s46 offen lds
    s_add_u32 m0, s45, 57344
    s_add_u32 s46, s36, 229376
    buffer_load_dwordx4 v4, s[8:11], s46 offen lds
    s_add_u32 m0, s45, 65536
    s_add_u32 s46, s37, 229376
    buffer_load_dwordx4 v4, s[8:11], s46 offen lds
    s_add_u32 m0, s45, 73728
    s_add_u32 s46, s32, 384
    buffer_load_dwordx4 v3, s[4:7], s46 offen lds
    s_add_u32 m0, s45, 81920
    s_add_u32 s46, s36, 344064
    buffer_load_dwordx4 v4, s[8:11], s46 offen lds
    s_add_u32 m0, s45, 90112
    s_add_u32 s46, s37, 344064
    buffer_load_dwordx4 v4, s[8:11], s46 offen lds
    s_add_u32 m0, s45, 98304
    s_add_u32 s46, s32, 512
    buffer_load_dwordx4 v3, s[4:7], s46 offen lds
    s_add_u32 m0, s45, 106496
    s_add_u32 s46, s36, 458752
    buffer_load_dwordx4 v4, s[8:11], s46 offen lds
    s_add_u32 m0, s45, 114688
    s_add_u32 s46, s37, 458752
    buffer_load_dwordx4 v4, s[8:11], s46 offen lds
    s_waitcnt vmcnt(12) lgkmcnt(0)
    s_barrier
    v_add_u32 v22, 0, v10
    v_add_u32 v23, 0, v11
    v_add_u32 v24, 0, v12
    v_add_u32 v25, 0, v13
    v_add_u32 v26, 0, v20
    ds_read_b128 v[32:35], v22 offset:0
    ds_read_b64_tr_b16 v[40:41], v26 offset:0
    ds_read_b64_tr_b16 v[42:43], v26 offset:1024
    ds_read_b128 v[48:51], v23 offset:0
    ds_read_b64_tr_b16 v[56:57], v26 offset:4096
    ds_read_b64_tr_b16 v[58:59], v26 offset:5120
    s_waitcnt lgkmcnt(3)
    v_mfma_f32_32x32x16_bf16 v[64:79], v[40:43], v[32:35], v[64:79]
    s_add_u32 m0, s45, 122880
    s_add_u32 s46, s32, 640
    buffer_load_dwordx4 v3, s[4:7], s46 offen lds
    ds_read_b128 v[32:35], v24 offset:0
    ds_read_b64_tr_b16 v[40:41], v26 offset:8192
    ds_read_b64_tr_b16 v[42:43], v26 offset:9216
    s_waitcnt lgkmcnt(3)
    v_mfma_f32_32x32x16_bf16 v[64:79], v[56:59], v[48:51], v[64:79]
    s_add_u32 m0, s45, 131072
    s_add_u32 s46, s36, 573440
    buffer_load_dwordx4 v4, s[8:11], s46 offen lds
    ds_read_b128 v[48:51], v25 offset:0
    ds_read_b64_tr_b16 v[56:57], v26 offset:12288
    ds_read_b64_tr_b16 v[58:59], v26 offset:13312
    s_waitcnt lgkmcnt(3)
    v_mfma_f32_32x32x16_bf16 v[64:79], v[40:43], v[32:35], v[64:79]
    s_add_u32 m0, s45, 139264
    s_add_u32 s46, s37, 573440
    buffer_load_dwordx4 v4, s[8:11], s46 offen lds
    s_waitcnt lgkmcnt(0)
    v_mfma_f32_32x32x16_bf16 v[64:79], v[56:59], v[48:51], v[64:79]
    s_waitcnt vmcnt(12) lgkmcnt(0)
    s_barrier
    v_add_u32 v22, 24576, v10
    v_add_u32 v23, 24576, v11
    v_add_u32 v24, 24576, v12
    v_add_u32 v25, 24576, v13
    v_add_u32 v26, 24576, v20
    ds_read_b128 v[32:35], v22 offset:0
    ds_read_b64_tr_b16 v[40:41], v26 offset:0
    ds_read_b64_tr_b16 v[42:43], v26 offset:1024
    ds_read_b128 v[48:51], v23 offset:0
    ds_read_b64_tr_b16 v[56:57], v26 offset:4096
    ds_read_b64_tr_b16 v[58:59], v26 offset:5120
    s_waitcnt lgkmcnt(3)
    v_mfma_f32_32x32x16_bf16 v[64:79], v[40:43], v[32:35], v[64:79]
    s_add_u32 m0, s45, 0
    s_add_u32 s46, s32, 768
    buffer_load_dwordx4 v3, s[4:7], s46 offen lds
    ds_read_b128 v[32:35], v24 offset:0
    ds_read_b64_tr_b16 v[40:41], v26 offset:8192
    ds_read_b64_tr_b16 v[42:43], v26 offset:9216
    s_waitcnt lgkmcnt(3)
    v_mfma_f32_32x32x16_bf16 v[64:79], v[56:59], v[48:51], v[64:79]
    s_add_u32 m0, s45, 8192
    s_add_u32 s46, s36, 688128
    buffer_load_dwordx4 v4, s[8:11], s46 offen lds
    ds_read_b128 v[48:51], v25 offset:0
    ds_read_b64_tr_b16 v[56:57], v26 offset:12288
    ds_read_b64_tr_b16 v[58:59], v26 offset:13312
    s_waitcnt lgkmcnt(3)
    v_mfma_f32_32x32x16_bf16 v[64:79], v[40:43], v[32:35], v[64:79]
    s_add_u32 m0, s45, 16384
    s_add_u32 s46, s37, 688128
    buffer_load_dwordx4 v4, s[8:11], s46 offen lds
    s_waitcnt lgkmcnt(0)
    v_mfma_f32_32x32x16_bf16 v[64:79], v[56:59], v[48:51], v[64:79]
    s_waitcnt vmcnt(12) lgkmcnt(0)
    s_barrier
    v_add_u32 v22, 49152, v10
    v_add_u32 v23, 49152, v11
    v_add_u32 v24, 49152, v12
    v_add_u32 v25, 49152, v13
    v_add_u32 v26, 49152, v20
    ds_read_b128 v[32:35], v22 offset:0
    ds_read_b64_tr_b16 v[40:41], v26 offset:0
    ds_read_b64_tr_b16 v[42:43], v26 offset:1024
    ds_read_b128 v[48:51], v23 offset:0
    ds_read_b64_tr_b16 v[56:57], v26 offset:4096
    ds_read_b64_tr_b16 v[58:59], v26 offset:5120
    s_waitcnt lgkmcnt(3)
    v_mfma_f32_32x32x16_bf16 v[64:79], v[40:43], v[32:35], v[64:79]
    s_add_u32 m0, s45, 24576
    s_add_u32 s46, s32, 896
    buffer_load_dwordx4 v3, s[4:7], s46 offen lds
    ds_read_b128 v[32:35], v24 offset:0
    ds_read_b64_tr_b16 v[40:41], v26 offset:8192
    ds_read_b64_tr_b16 v[42:43], v26 offset:9216
    s_waitcnt lgkmcnt(3)
    v_mfma_f32_32x32x16_bf16 v[64:79], v[56:59], v[48:51], v[64:79]
    s_add_u32 m0, s45, 32768
    s_add_u32 s46, s36, 802816
    buffer_load_dwordx4 v4, s[8:11], s46 offen lds
    ds_read_b128 v[48:51], v25 offset:0
    ds_read_b64_tr_b16 v[56:57], v26 offset:12288
    ds_read_b64_tr_b16 v[58:59], v26 offset:13312
    s_waitcnt lgkmcnt(3)
    v_mfma_f32_32x32x16_bf16 v[64:79], v[40:43], v[32:35], v[64:79]
    s_add_u32 m0, s45, 40960
    s_add_u32 s46, s37, 802816
    buffer_load_dwordx4 v4, s[8:11], s46 offen lds
    s_waitcnt lgkmcnt(0)
    v_mfma_f32_32x32x16_bf16 v[64:79], v[56:59], v[48:51], v[64:79]
    s_waitcnt vmcnt(12) lgkmcnt(0)
    s_barrier
    v_add_u32 v22, 73728, v10
    v_add_u32 v23, 73728, v11
    v_add_u32 v24, 73728, v12
    v_add_u32 v25, 73728, v13
    v_add_u32 v26, 73728, v20
    ds_read_b128 v[32:35], v22 offset:0
    ds_read_b64_tr_b16 v[40:41], v26 offset:0
    ds_read_b64_tr_b16 v[42:43], v26 offset:1024
    ds_read_b128 v[48:51], v23 offset:0
    ds_read_b64_tr_b16 v[56:57], v26 offset:4096
    ds_read_b64_tr_b16 v[58:59], v26 offset:5120
    s_waitcnt lgkmcnt(3)
    v_mfma_f32_32x32x16_bf16 v[64:79], v[40:43], v[32:35], v[64:79]
    s_add_u32 m0, s45, 49152
    s_add_u32 s46, s32, 1024
    buffer_load_dwordx4 v3, s[4:7], s46 offen lds
    ds_read_b128 v[32:35], v24 offset:0
    ds_read_b64_tr_b16 v[40:41], v26 offset:8192
    ds_read_b64_tr_b16 v[42:43], v26 offset:9216
    s_waitcnt lgkmcnt(3)
    v_mfma_f32_32x32x16_bf16 v[64:79], v[56:59], v[48:51], v[64:79]
    s_add_u32 m0, s45, 57344
    s_add_u32 s46, s36, 917504
    buffer_load_dwordx4 v4, s[8:11], s46 offen lds
    ds_read_b128 v[48:51], v25 offset:0
    ds_read_b64_tr_b16 v[56:57], v26 offset:12288
    ds_read_b64_tr_b16 v[58:59], v26 offset:13312
    s_waitcnt lgkmcnt(3)
    v_mfma_f32_32x32x16_bf16 v[64:79], v[40:43], v[32:35], v[64:79]
    s_add_u32 m0, s45, 65536
    s_add_u32 s46, s37, 917504
    buffer_load_dwordx4 v4, s[8:11], s46 offen lds
    s_waitcnt lgkmcnt(0)
    v_mfma_f32_32x32x16_bf16 v[64:79], v[56:59], v[48:51], v[64:79]
    s_waitcnt vmcnt(12) lgkmcnt(0)
    s_barrier
    v_add_u32 v22, 98304, v10
    v_add_u32 v23, 98304, v11
    v_add_u32 v24, 98304, v12
    v_add_u32 v25, 98304, v13
    v_add_u32 v26, 98304, v20
    ds_read_b128 v[32:35], v22 offset:0
    ds_read_b64_tr_b16 v[40:41], v26 offset:0
    ds_read_b64_tr_b16 v[42:43], v26 offset:1024
    ds_read_b128 v[48:51], v23 offset:0
    ds_read_b64_tr_b16 v[56:57], v26 offset:4096
    ds_read_b64_tr_b16 v[58:59], v26 offset:5120
    s_waitcnt lgkmcnt(3)
    v_mfma_f32_32x32x16_bf16 v[64:79], v[40:43], v[32:35], v[64:79]
    s_add_u32 m0, s45, 73728
    s_add_u32 s46, s32, 1152
    buffer_load_dwordx4 v3, s[4:7], s46 offen lds
    ds_read_b128 v[32:35], v24 offset:0
    ds_read_b64_tr_b16 v[40:41], v26 offset:8192
    ds_read_b64_tr_b16 v[42:43], v26 offset:9216
    s_waitcnt lgkmcnt(3)
    v_mfma_f32_32x32x16_bf16 v[64:79], v[56:59], v[48:51], v[64:79]
    s_add_u32 m0, s45, 81920
    s_add_u32 s46, s36, 1032192
    buffer_load_dwordx4 v4, s[8:11], s46 offen lds
    ds_read_b128 v[48:51], v25 offset:0
    ds_read_b64_tr_b16 v[56:57], v26 offset:12288
    ds_read_b64_tr_b16 v[58:59], v26 offset:13312
    s_waitcnt lgkmcnt(3)
    v_mfma_f32_32x32x16_bf16 v[64:79], v[40:43], v[32:35], v[64:79]
    s_add_u32 m0, s45, 90112
    s_add_u32 s46, s37, 1032192
    buffer_load_dwordx4 v4, s[8:11], s46 offen lds
    s_waitcnt lgkmcnt(0)
    v_mfma_f32_32x32x16_bf16 v[64:79], v[56:59], v[48:51], v[64:79]
    s_waitcnt vmcnt(12) lgkmcnt(0)
    s_barrier
    v_add_u32 v22, 122880, v10
    v_add_u32 v23, 122880, v11
    v_add_u32 v24, 122880, v12
    v_add_u32 v25, 122880, v13
    v_add_u32 v26, 122880, v20
    ds_read_b128 v[32:35], v22 offset:0
    ds_read_b64_tr_b16 v[40:41], v26 offset:0
    ds_read_b64_tr_b16 v[42:43], v26 offset:1024
    ds_read_b128 v[48:51], v23 offset:0
    ds_read_b64_tr_b16 v[56:57], v26 offset:4096
    ds_read_b64_tr_b16 v[58:59], v26 offset:5120
    s_waitcnt lgkmcnt(3)
    v_mfma_f32_32x32x16_bf16 v[64:79], v[40:43], v[32:35], v[64:79]
    s_add_u32 m0, s45, 98304
    s_add_u32 s46, s32, 1280
    buffer_load_dwordx4 v3, s[4:7], s46 offen lds
    ds_read_b128 v[32:35], v24 offset:0
    ds_read_b64_tr_b16 v[40:41], v26 offset:8192
    ds_read_b64_tr_b16 v[42:43], v26 offset:9216
    s_waitcnt lgkmcnt(3)
    v_mfma_f32_32x32x16_bf16 v[64:79], v[56:59], v[48:51], v[64:79]
    s_add_u32 m0, s45, 106496
    s_add_u32 s46, s36, 1146880
    buffer_load_dwordx4 v4, s[8:11], s46 offen lds
    ds_read_b128 v[48:51], v25 offset:0
    ds_read_b64_tr_b16 v[56:57], v26 offset:12288
    ds_read_b64_tr_b16 v[58:59], v26 offset:13312
    s_waitcnt lgkmcnt(3)
    v_mfma_f32_32x32x16_bf16 v[64:79], v[40:43], v[32:35], v[64:79]
    s_add_u32 m0, s45, 114688
    s_add_u32 s46, s37, 1146880
    buffer_load_dwordx4 v4, s[8:11], s46 offen lds
    s_waitcnt lgkmcnt(0)
    v_mfma_f32_32x32x16_bf16 v[64:79], v[56:59], v[48:51], v[64:79]
    s_waitcnt vmcnt(12) lgkmcnt(0)
    s_barrier
    v_add_u32 v22, 0, v10
    v_add_u32 v23, 0, v11
    v_add_u32 v24, 0, v12
    v_add_u32 v25, 0, v13
    v_add_u32 v26, 0, v20
    ds_read_b128 v[32:35], v22 offset:0
    ds_read_b64_tr_b16 v[40:41], v26 offset:0
    ds_read_b64_tr_b16 v[42:43], v26 offset:1024
    ds_read_b128 v[48:51], v23 offset:0
    ds_read_b64_tr_b16 v[56:57], v26 offset:4096
    ds_read_b64_tr_b16 v[58:59], v26 offset:5120
    s_waitcnt lgkmcnt(3)
    v_mfma_f32_32x32x16_bf16 v[64:79], v[40:43], v[32:35], v[64:79]
    s_add_u32 m0, s45, 122880
    s_add_u32 s46, s32, 1408
    buffer_load_dwordx4 v3, s[4:7], s46 offen lds
    ds_read_b128 v[32:35], v24 offset:0
    ds_read_b64_tr_b16 v[40:41], v26 offset:8192
    ds_read_b64_tr_b16 v[42:43], v26 offset:9216
    s_waitcnt lgkmcnt(3)
    v_mfma_f32_32x32x16_bf16 v[64:79], v[56:59], v[48:51], v[64:79]
    s_add_u32 m0, s45, 131072
    s_add_u32 s46, s36, 1261568
    buffer_load_dwordx4 v4, s[8:11], s46 offen lds
    ds_read_b128 v[48:51], v25 offset:0
    ds_read_b64_tr_b16 v[56:57], v26 offset:12288
    ds_read_b64_tr_b16 v[58:59], v26 offset:13312
    s_waitcnt lgkmcnt(3)
    v_mfma_f32_32x32x16_bf16 v[64:79], v[40:43], v[32:35], v[64:79]
    s_add_u32 m0, s45, 139264
    s_add_u32 s46, s37, 1261568
    buffer_load_dwordx4 v4, s[8:11], s46 offen lds
    s_waitcnt lgkmcnt(0)
    v_mfma_f32_32x32x16_bf16 v[64:79], v[56:59], v[48:51], v[64:79]
    s_waitcnt vmcnt(12) lgkmcnt(0)
    s_barrier
    v_add_u32 v22, 24576, v10
    v_add_u32 v23, 24576, v11
    v_add_u32 v24, 24576, v12
    v_add_u32 v25, 24576, v13
    v_add_u32 v26, 24576, v20
    ds_read_b128 v[32:35], v22 offset:0
    ds_read_b64_tr_b16 v[40:41], v26 offset:0
    ds_read_b64_tr_b16 v[42:43], v26 offset:1024
    ds_read_b128 v[48:51], v23 offset:0
    ds_read_b64_tr_b16 v[56:57], v26 offset:4096
    ds_read_b64_tr_b16 v[58:59], v26 offset:5120
    s_waitcnt lgkmcnt(3)
    v_mfma_f32_32x32x16_bf16 v[64:79], v[40:43], v[32:35], v[64:79]
    s_add_u32 m0, s45, 0
    s_add_u32 s46, s32, 1536
    buffer_load_dwordx4 v3, s[4:7], s46 offen lds
    ds_read_b128 v[32:35], v24 offset:0
    ds_read_b64_tr_b16 v[40:41], v26 offset:8192
    ds_read_b64_tr_b16 v[42:43], v26 offset:9216
    s_waitcnt lgkmcnt(3)
    v_mfma_f32_32x32x16_bf16 v[64:79], v[56:59], v[48:51], v[64:79]
    s_add_u32 m0, s45, 8192
    s_add_u32 s46, s36, 1376256
    buffer_load_dwordx4 v4, s[8:11], s46 offen lds
    ds_read_b128 v[48:51], v25 offset:0
    ds_read_b64_tr_b16 v[56:57], v26 offset:12288
    ds_read_b64_tr_b16 v[58:59], v26 offset:13312
    s_waitcnt lgkmcnt(3)
    v_mfma_f32_32x32x16_bf16 v[64:79], v[40:43], v[32:35], v[64:79]
    s_add_u32 m0, s45, 16384
    s_add_u32 s46, s37, 1376256
    buffer_load_dwordx4 v4, s[8:11], s46 offen lds
    s_waitcnt lgkmcnt(0)
    v_mfma_f32_32x32x16_bf16 v[64:79], v[56:59], v[48:51], v[64:79]
    s_waitcnt vmcnt(12) lgkmcnt(0)
    s_barrier
    v_add_u32 v22, 49152, v10
    v_add_u32 v23, 49152, v11
    v_add_u32 v24, 49152, v12
    v_add_u32 v25, 49152, v13
    v_add_u32 v26, 49152, v20
    ds_read_b128 v[32:35], v22 offset:0
    ds_read_b64_tr_b16 v[40:41], v26 offset:0
    ds_read_b64_tr_b16 v[42:43], v26 offset:1024
    ds_read_b128 v[48:51], v23 offset:0
    ds_read_b64_tr_b16 v[56:57], v26 offset:4096
    ds_read_b64_tr_b16 v[58:59], v26 offset:5120
    s_waitcnt lgkmcnt(3)
    v_mfma_f32_32x32x16_bf16 v[64:79], v[40:43], v[32:35], v[64:79]
    s_add_u32 m0, s45, 24576
    s_add_u32 s46, s32, 1664
    buffer_load_dwordx4 v3, s[4:7], s46 offen lds
    ds_read_b128 v[32:35], v24 offset:0
    ds_read_b64_tr_b16 v[40:41], v26 offset:8192
    ds_read_b64_tr_b16 v[42:43], v26 offset:9216
    s_waitcnt lgkmcnt(3)
    v_mfma_f32_32x32x16_bf16 v[64:79], v[56:59], v[48:51], v[64:79]
    s_add_u32 m0, s45, 32768
    s_add_u32 s46, s36, 1490944
    buffer_load_dwordx4 v4, s[8:11], s46 offen lds
    ds_read_b128 v[48:51], v25 offset:0
    ds_read_b64_tr_b16 v[56:57], v26 offset:12288
    ds_read_b64_tr_b16 v[58:59], v26 offset:13312
    s_waitcnt lgkmcnt(3)
    v_mfma_f32_32x32x16_bf16 v[64:79], v[40:43], v[32:35], v[64:79]
    s_add_u32 m0, s45, 40960
    s_add_u32 s46, s37, 1490944
    buffer_load_dwordx4 v4, s[8:11], s46 offen lds
    s_waitcnt lgkmcnt(0)
    v_mfma_f32_32x32x16_bf16 v[64:79], v[56:59], v[48:51], v[64:79]
    s_waitcnt vmcnt(12) lgkmcnt(0)
    s_barrier
    v_add_u32 v22, 73728, v10
    v_add_u32 v23, 73728, v11
    v_add_u32 v24, 73728, v12
    v_add_u32 v25, 73728, v13
    v_add_u32 v26, 73728, v20
    ds_read_b128 v[32:35], v22 offset:0
    ds_read_b64_tr_b16 v[40:41], v26 offset:0
    ds_read_b64_tr_b16 v[42:43], v26 offset:1024
    ds_read_b128 v[48:51], v23 offset:0
    ds_read_b64_tr_b16 v[56:57], v26 offset:4096
    ds_read_b64_tr_b16 v[58:59], v26 offset:5120
    s_waitcnt lgkmcnt(3)
    v_mfma_f32_32x32x16_bf16 v[64:79], v[40:43], v[32:35], v[64:79]
    s_add_u32 m0, s45, 49152
    s_add_u32 s46, s32, 1792
    buffer_load_dwordx4 v3, s[4:7], s46 offen lds
    ds_read_b128 v[32:35], v24 offset:0
    ds_read_b64_tr_b16 v[40:41], v26 offset:8192
    ds_read_b64_tr_b16 v[42:43], v26 offset:9216
    s_waitcnt lgkmcnt(3)
    v_mfma_f32_32x32x16_bf16 v[64:79], v[56:59], v[48:51], v[64:79]
    s_add_u32 m0, s45, 57344
    s_add_u32 s46, s36, 1605632
    buffer_load_dwordx4 v4, s[8:11], s46 offen lds
    ds_read_b128 v[48:51], v25 offset:0
    ds_read_b64_tr_b16 v[56:57], v26 offset:12288
    ds_read_b64_tr_b16 v[58:59], v26 offset:13312
    s_waitcnt lgkmcnt(3)
    v_mfma_f32_32x32x16_bf16 v[64:79], v[40:43], v[32:35], v[64:79]
    s_add_u32 m0, s45, 65536
    s_add_u32 s46, s37, 1605632
    buffer_load_dwordx4 v4, s[8:11], s46 offen lds
    s_waitcnt lgkmcnt(0)
    v_mfma_f32_32x32x16_bf16 v[64:79], v[56:59], v[48:51], v[64:79]
    s_waitcnt vmcnt(12) lgkmcnt(0)
    s_barrier
    v_add_u32 v22, 98304, v10
    v_add_u32 v23, 98304, v11
    v_add_u32 v24, 98304, v12
    v_add_u32 v25, 98304, v13
    v_add_u32 v26, 98304, v20
    ds_read_b128 v[32:35], v22 offset:0
    ds_read_b64_tr_b16 v[40:41], v26 offset:0
    ds_read_b64_tr_b16 v[42:43], v26 offset:1024
    ds_read_b128 v[48:51], v23 offset:0
    ds_read_b64_tr_b16 v[56:57], v26 offset:4096
    ds_read_b64_tr_b16 v[58:59], v26 offset:5120
    s_waitcnt lgkmcnt(3)
    v_mfma_f32_32x32x16_bf16 v[64:79], v[40:43], v[32:35], v[64:79]
    s_add_u32 m0, s45, 73728
    s_add_u32 s46, s32, 1920
    buffer_load_dwordx4 v3, s[4:7], s46 offen lds
    ds_read_b128 v[32:35], v24 offset:0
    ds_read_b64_tr_b16 v[40:41], v26 offset:8192
    ds_read_b64_tr_b16 v[42:43], v26 offset:9216
    s_waitcnt lgkmcnt(3)
    v_mfma_f32_32x32x16_bf16 v[64:79], v[56:59], v[48:51], v[64:79]
    s_add_u32 m0, s45, 81920
    s_add_u32 s46, s36, 1720320
    buffer_load_dwordx4 v4, s[8:11], s46 offen lds
    ds_read_b128 v[48:51], v25 offset:0
    ds_read_b64_tr_b16 v[56:57], v26 offset:12288
    ds_read_b64_tr_b16 v[58:59], v26 offset:13312
    s_waitcnt lgkmcnt(3)
    v_mfma_f32_32x32x16_bf16 v[64:79], v[40:43], v[32:35], v[64:79]
    s_add_u32 m0, s45, 90112
    s_add_u32 s46, s37, 1720320
    buffer_load_dwordx4 v4, s[8:11], s46 offen lds
    s_waitcnt lgkmcnt(0)
    v_mfma_f32_32x32x16_bf16 v[64:79], v[56:59], v[48:51], v[64:79]
    s_waitcnt vmcnt(12) lgkmcnt(0)
    s_barrier
    v_add_u32 v22, 122880, v10
    v_add_u32 v23, 122880, v11
    v_add_u32 v24, 122880, v12
    v_add_u32 v25, 122880, v13
    v_add_u32 v26, 122880, v20
    ds_read_b128 v[32:35], v22 offset:0
    ds_read_b64_tr_b16 v[40:41], v26 offset:0
    ds_read_b64_tr_b16 v[42:43], v26 offset:1024
    ds_read_b128 v[48:51], v23 offset:0
    ds_read_b64_tr_b16 v[56:57], v26 offset:4096
    ds_read_b64_tr_b16 v[58:59], v26 offset:5120
    s_waitcnt lgkmcnt(3)
    v_mfma_f32_32x32x16_bf16 v[64:79], v[40:43], v[32:35], v[64:79]
    s_add_u32 m0, s45, 98304
    s_add_u32 s46, s32, 2048
    buffer_load_dwordx4 v3, s[4:7], s46 offen lds
    ds_read_b128 v[32:35], v24 offset:0
    ds_read_b64_tr_b16 v[40:41], v26 offset:8192
    ds_read_b64_tr_b16 v[42:43], v26 offset:9216
    s_waitcnt lgkmcnt(3)
    v_mfma_f32_32x32x16_bf16 v[64:79], v[56:59], v[48:51], v[64:79]
    s_add_u32 m0, s45, 106496
    s_add_u32 s46, s36, 1835008
    buffer_load_dwordx4 v4, s[8:11], s46 offen lds
    ds_read_b128 v[48:51], v25 offset:0
    ds_read_b64_tr_b16 v[56:57], v26 offset:12288
    ds_read_b64_tr_b16 v[58:59], v26 offset:13312
    s_waitcnt lgkmcnt(3)
    v_mfma_f32_32x32x16_bf16 v[64:79], v[40:43], v[32:35], v[64:79]
    s_add_u32 m0, s45, 114688
    s_add_u32 s46, s37, 1835008
    buffer_load_dwordx4 v4, s[8:11], s46 offen lds
    s_waitcnt lgkmcnt(0)
    v_mfma_f32_32x32x16_bf16 v[64:79], v[56:59], v[48:51], v[64:79]
    s_waitcnt vmcnt(12) lgkmcnt(0)
    s_barrier
    v_add_u32 v22, 0, v10
    v_add_u32 v23, 0, v11
    v_add_u32 v24, 0, v12
    v_add_u32 v25, 0, v13
    v_add_u32 v26, 0, v20
    ds_read_b128 v[32:35], v22 offset:0
    ds_read_b64_tr_b16 v[40:41], v26 offset:0
    ds_read_b64_tr_b16 v[42:43], v26 offset:1024
    ds_read_b128 v[48:51], v23 offset:0
    ds_read_b64_tr_b16 v[56:57], v26 offset:4096
    ds_read_b64_tr_b16 v[58:59], v26 offset:5120
    s_waitcnt lgkmcnt(3)
    v_mfma_f32_32x32x16_bf16 v[64:79], v[40:43], v[32:35], v[64:79]
    s_add_u32 m0, s45, 122880
    s_add_u32 s46, s32, 2176
    buffer_load_dwordx4 v3, s[4:7], s46 offen lds
    ds_read_b128 v[32:35], v24 offset:0
    ds_read_b64_tr_b16 v[40:41], v26 offset:8192
    ds_read_b64_tr_b16 v[42:43], v26 offset:9216
    s_waitcnt lgkmcnt(3)
    v_mfma_f32_32x32x16_bf16 v[64:79], v[56:59], v[48:51], v[64:79]
    s_add_u32 m0, s45, 131072
    s_add_u32 s46, s36, 1949696
    buffer_load_dwordx4 v4, s[8:11], s46 offen lds
    ds_read_b128 v[48:51], v25 offset:0
    ds_read_b64_tr_b16 v[56:57], v26 offset:12288
    ds_read_b64_tr_b16 v[58:59], v26 offset:13312
    s_waitcnt lgkmcnt(3)
    v_mfma_f32_32x32x16_bf16 v[64:79], v[40:43], v[32:35], v[64:79]
    s_add_u32 m0, s45, 139264
    s_add_u32 s46, s37, 1949696
    buffer_load_dwordx4 v4, s[8:11], s46 offen lds
    s_waitcnt lgkmcnt(0)
    v_mfma_f32_32x32x16_bf16 v[64:79], v[56:59], v[48:51], v[64:79]
    s_waitcnt vmcnt(12) lgkmcnt(0)
    s_barrier
    v_add_u32 v22, 24576, v10
    v_add_u32 v23, 24576, v11
    v_add_u32 v24, 24576, v12
    v_add_u32 v25, 24576, v13
    v_add_u32 v26, 24576, v20
    ds_read_b128 v[32:35], v22 offset:0
    ds_read_b64_tr_b16 v[40:41], v26 offset:0
    ds_read_b64_tr_b16 v[42:43], v26 offset:1024
    ds_read_b128 v[48:51], v23 offset:0
    ds_read_b64_tr_b16 v[56:57], v26 offset:4096
    ds_read_b64_tr_b16 v[58:59], v26 offset:5120
    s_waitcnt lgkmcnt(3)
    v_mfma_f32_32x32x16_bf16 v[64:79], v[40:43], v[32:35], v[64:79]
    s_add_u32 m0, s45, 0
    s_add_u32 s46, s32, 2304
    buffer_load_dwordx4 v3, s[4:7], s46 offen lds
    ds_read_b128 v[32:35], v24 offset:0
    ds_read_b64_tr_b16 v[40:41], v26 offset:8192
    ds_read_b64_tr_b16 v[42:43], v26 offset:9216
    s_waitcnt lgkmcnt(3)
    v_mfma_f32_32x32x16_bf16 v[64:79], v[56:59], v[48:51], v[64:79]
    s_add_u32 m0, s45, 8192
    s_add_u32 s46, s36, 2064384
    buffer_load_dwordx4 v4, s[8:11], s46 offen lds
    ds_read_b128 v[48:51], v25 offset:0
    ds_read_b64_tr_b16 v[56:57], v26 offset:12288
    ds_read_b64_tr_b16 v[58:59], v26 offset:13312
    s_waitcnt lgkmcnt(3)
    v_mfma_f32_32x32x16_bf16 v[64:79], v[40:43], v[32:35], v[64:79]
    s_add_u32 m0, s45, 16384
    s_add_u32 s46, s37, 2064384
    buffer_load_dwordx4 v4, s[8:11], s46 offen lds
    s_waitcnt lgkmcnt(0)
    v_mfma_f32_32x32x16_bf16 v[64:79], v[56:59], v[48:51], v[64:79]
    s_waitcnt vmcnt(12) lgkmcnt(0)
    s_barrier
    v_add_u32 v22, 49152, v10
    v_add_u32 v23, 49152, v11
    v_add_u32 v24, 49152, v12
    v_add_u32 v25, 49152, v13
    v_add_u32 v26, 49152, v20
    ds_read_b128 v[32:35], v22 offset:0
    ds_read_b64_tr_b16 v[40:41], v26 offset:0
    ds_read_b64_tr_b16 v[42:43], v26 offset:1024
    ds_read_b128 v[48:51], v23 offset:0
    ds_read_b64_tr_b16 v[56:57], v26 offset:4096
    ds_read_b64_tr_b16 v[58:59], v26 offset:5120
    s_waitcnt lgkmcnt(3)
    v_mfma_f32_32x32x16_bf16 v[64:79], v[40:43], v[32:35], v[64:79]
    s_add_u32 m0, s45, 24576
    s_add_u32 s46, s32, 2432
    buffer_load_dwordx4 v3, s[4:7], s46 offen lds
    ds_read_b128 v[32:35], v24 offset:0
    ds_read_b64_tr_b16 v[40:41], v26 offset:8192
    ds_read_b64_tr_b16 v[42:43], v26 offset:9216
    s_waitcnt lgkmcnt(3)
    v_mfma_f32_32x32x16_bf16 v[64:79], v[56:59], v[48:51], v[64:79]
    s_add_u32 m0, s45, 32768
    s_add_u32 s46, s36, 2179072
    buffer_load_dwordx4 v4, s[8:11], s46 offen lds
    ds_read_b128 v[48:51], v25 offset:0
    ds_read_b64_tr_b16 v[56:57], v26 offset:12288
    ds_read_b64_tr_b16 v[58:59], v26 offset:13312
    s_waitcnt lgkmcnt(3)
    v_mfma_f32_32x32x16_bf16 v[64:79], v[40:43], v[32:35], v[64:79]
    s_add_u32 m0, s45, 40960
    s_add_u32 s46, s37, 2179072
    buffer_load_dwordx4 v4, s[8:11], s46 offen lds
    s_waitcnt lgkmcnt(0)
    v_mfma_f32_32x32x16_bf16 v[64:79], v[56:59], v[48:51], v[64:79]
    s_waitcnt vmcnt(12) lgkmcnt(0)
    s_barrier
    v_add_u32 v22, 73728, v10
    v_add_u32 v23, 73728, v11
    v_add_u32 v24, 73728, v12
    v_add_u32 v25, 73728, v13
    v_add_u32 v26, 73728, v20
    ds_read_b128 v[32:35], v22 offset:0
    ds_read_b64_tr_b16 v[40:41], v26 offset:0
    ds_read_b64_tr_b16 v[42:43], v26 offset:1024
    ds_read_b128 v[48:51], v23 offset:0
    ds_read_b64_tr_b16 v[56:57], v26 offset:4096
    ds_read_b64_tr_b16 v[58:59], v26 offset:5120
    s_waitcnt lgkmcnt(3)
    v_mfma_f32_32x32x16_bf16 v[64:79], v[40:43], v[32:35], v[64:79]
    s_add_u32 m0, s45, 49152
    s_add_u32 s46, s32, 2560
    buffer_load_dwordx4 v3, s[4:7], s46 offen lds
    ds_read_b128 v[32:35], v24 offset:0
    ds_read_b64_tr_b16 v[40:41], v26 offset:8192
    ds_read_b64_tr_b16 v[42:43], v26 offset:9216
    s_waitcnt lgkmcnt(3)
    v_mfma_f32_32x32x16_bf16 v[64:79], v[56:59], v[48:51], v[64:79]
    s_add_u32 m0, s45, 57344
    s_add_u32 s46, s36, 2293760
    buffer_load_dwordx4 v4, s[8:11], s46 offen lds
    ds_read_b128 v[48:51], v25 offset:0
    ds_read_b64_tr_b16 v[56:57], v26 offset:12288
    ds_read_b64_tr_b16 v[58:59], v26 offset:13312
    s_waitcnt lgkmcnt(3)
    v_mfma_f32_32x32x16_bf16 v[64:79], v[40:43], v[32:35], v[64:79]
    s_add_u32 m0, s45, 65536
    s_add_u32 s46, s37, 2293760
    buffer_load_dwordx4 v4, s[8:11], s46 offen lds
    s_waitcnt lgkmcnt(0)
    v_mfma_f32_32x32x16_bf16 v[64:79], v[56:59], v[48:51], v[64:79]
    s_waitcnt vmcnt(12) lgkmcnt(0)
    s_barrier
    v_add_u32 v22, 98304, v10
    v_add_u32 v23, 98304, v11
    v_add_u32 v24, 98304, v12
    v_add_u32 v25, 98304, v13
    v_add_u32 v26, 98304, v20
    ds_read_b128 v[32:35], v22 offset:0
    ds_read_b64_tr_b16 v[40:41], v26 offset:0
    ds_read_b64_tr_b16 v[42:43], v26 offset:1024
    ds_read_b128 v[48:51], v23 offset:0
    ds_read_b64_tr_b16 v[56:57], v26 offset:4096
    ds_read_b64_tr_b16 v[58:59], v26 offset:5120
    s_waitcnt lgkmcnt(3)
    v_mfma_f32_32x32x16_bf16 v[64:79], v[40:43], v[32:35], v[64:79]
    s_add_u32 m0, s45, 73728
    s_add_u32 s46, s32, 2688
    buffer_load_dwordx4 v3, s[4:7], s46 offen lds
    ds_read_b128 v[32:35], v24 offset:0
    ds_read_b64_tr_b16 v[40:41], v26 offset:8192
    ds_read_b64_tr_b16 v[42:43], v26 offset:9216
    s_waitcnt lgkmcnt(3)
    v_mfma_f32_32x32x16_bf16 v[64:79], v[56:59], v[48:51], v[64:79]
    s_add_u32 m0, s45, 81920
    s_add_u32 s46, s36, 2408448
    buffer_load_dwordx4 v4, s[8:11], s46 offen lds
    ds_read_b128 v[48:51], v25 offset:0
    ds_read_b64_tr_b16 v[56:57], v26 offset:12288
    ds_read_b64_tr_b16 v[58:59], v26 offset:13312
    s_waitcnt lgkmcnt(3)
    v_mfma_f32_32x32x16_bf16 v[64:79], v[40:43], v[32:35], v[64:79]
    s_add_u32 m0, s45, 90112
    s_add_u32 s46, s37, 2408448
    buffer_load_dwordx4 v4, s[8:11], s46 offen lds
    s_waitcnt lgkmcnt(0)
    v_mfma_f32_32x32x16_bf16 v[64:79], v[56:59], v[48:51], v[64:79]
    s_waitcnt vmcnt(12) lgkmcnt(0)
    s_barrier
    v_add_u32 v22, 122880, v10
    v_add_u32 v23, 122880, v11
    v_add_u32 v24, 122880, v12
    v_add_u32 v25, 122880, v13
    v_add_u32 v26, 122880, v20
    ds_read_b128 v[32:35], v22 offset:0
    ds_read_b64_tr_b16 v[40:41], v26 offset:0
    ds_read_b64_tr_b16 v[42:43], v26 offset:1024
    ds_read_b128 v[48:51], v23 offset:0
    ds_read_b64_tr_b16 v[56:57], v26 offset:4096
    ds_read_b64_tr_b16 v[58:59], v26 offset:5120
    s_waitcnt lgkmcnt(3)
    v_mfma_f32_32x32x16_bf16 v[64:79], v[40:43], v[32:35], v[64:79]
    s_add_u32 m0, s45, 98304
    s_add_u32 s46, s32, 2816
    buffer_load_dwordx4 v3, s[4:7], s46 offen lds
    ds_read_b128 v[32:35], v24 offset:0
    ds_read_b64_tr_b16 v[40:41], v26 offset:8192
    ds_read_b64_tr_b16 v[42:43], v26 offset:9216
    s_waitcnt lgkmcnt(3)
    v_mfma_f32_32x32x16_bf16 v[64:79], v[56:59], v[48:51], v[64:79]
    s_add_u32 m0, s45, 106496
    s_add_u32 s46, s36, 2523136
    buffer_load_dwordx4 v4, s[8:11], s46 offen lds
    ds_read_b128 v[48:51], v25 offset:0
    ds_read_b64_tr_b16 v[56:57], v26 offset:12288
    ds_read_b64_tr_b16 v[58:59], v26 offset:13312
    s_waitcnt lgkmcnt(3)
    v_mfma_f32_32x32x16_bf16 v[64:79], v[40:43], v[32:35], v[64:79]
    s_add_u32 m0, s45, 114688
    s_add_u32 s46, s37, 2523136
    buffer_load_dwordx4 v4, s[8:11], s46 offen lds
    s_waitcnt lgkmcnt(0)
    v_mfma_f32_32x32x16_bf16 v[64:79], v[56:59], v[48:51], v[64:79]
    s_waitcnt vmcnt(12) lgkmcnt(0)
    s_barrier
    v_add_u32 v22, 0, v10
    v_add_u32 v23, 0, v11
    v_add_u32 v24, 0, v12
    v_add_u32 v25, 0, v13
    v_add_u32 v26, 0, v20
    ds_read_b128 v[32:35], v22 offset:0
    ds_read_b64_tr_b16 v[40:41], v26 offset:0
    ds_read_b64_tr_b16 v[42:43], v26 offset:1024
    ds_read_b128 v[48:51], v23 offset:0
    ds_read_b64_tr_b16 v[56:57], v26 offset:4096
    ds_read_b64_tr_b16 v[58:59], v26 offset:5120
    s_waitcnt lgkmcnt(3)
    v_mfma_f32_32x32x16_bf16 v[64:79], v[40:43], v[32:35], v[64:79]
    s_add_u32 m0, s45, 122880
    s_add_u32 s46, s32, 2944
    buffer_load_dwordx4 v3, s[4:7], s46 offen lds
    ds_read_b128 v[32:35], v24 offset:0
    ds_read_b64_tr_b16 v[40:41], v26 offset:8192
    ds_read_b64_tr_b16 v[42:43], v26 offset:9216
    s_waitcnt lgkmcnt(3)
    v_mfma_f32_32x32x16_bf16 v[64:79], v[56:59], v[48:51], v[64:79]
    s_add_u32 m0, s45, 131072
    s_add_u32 s46, s36, 2637824
    buffer_load_dwordx4 v4, s[8:11], s46 offen lds
    ds_read_b128 v[48:51], v25 offset:0
    ds_read_b64_tr_b16 v[56:57], v26 offset:12288
    ds_read_b64_tr_b16 v[58:59], v26 offset:13312
    s_waitcnt lgkmcnt(3)
    v_mfma_f32_32x32x16_bf16 v[64:79], v[40:43], v[32:35], v[64:79]
    s_add_u32 m0, s45, 139264
    s_add_u32 s46, s37, 2637824
    buffer_load_dwordx4 v4, s[8:11], s46 offen lds
    s_waitcnt lgkmcnt(0)
    v_mfma_f32_32x32x16_bf16 v[64:79], v[56:59], v[48:51], v[64:79]
    s_waitcnt vmcnt(12) lgkmcnt(0)
    s_barrier
    v_add_u32 v22, 24576, v10
    v_add_u32 v23, 24576, v11
    v_add_u32 v24, 24576, v12
    v_add_u32 v25, 24576, v13
    v_add_u32 v26, 24576, v20
    ds_read_b128 v[32:35], v22 offset:0
    ds_read_b64_tr_b16 v[40:41], v26 offset:0
    ds_read_b64_tr_b16 v[42:43], v26 offset:1024
    ds_read_b128 v[48:51], v23 offset:0
    ds_read_b64_tr_b16 v[56:57], v26 offset:4096
    ds_read_b64_tr_b16 v[58:59], v26 offset:5120
    s_waitcnt lgkmcnt(3)
    v_mfma_f32_32x32x16_bf16 v[64:79], v[40:43], v[32:35], v[64:79]
    s_add_u32 m0, s45, 0
    s_add_u32 s46, s32, 3072
    buffer_load_dwordx4 v3, s[4:7], s46 offen lds
    ds_read_b128 v[32:35], v24 offset:0
    ds_read_b64_tr_b16 v[40:41], v26 offset:8192
    ds_read_b64_tr_b16 v[42:43], v26 offset:9216
    s_waitcnt lgkmcnt(3)
    v_mfma_f32_32x32x16_bf16 v[64:79], v[56:59], v[48:51], v[64:79]
    s_add_u32 m0, s45, 8192
    s_add_u32 s46, s36, 2752512
    buffer_load_dwordx4 v4, s[8:11], s46 offen lds
    ds_read_b128 v[48:51], v25 offset:0
    ds_read_b64_tr_b16 v[56:57], v26 offset:12288
    ds_read_b64_tr_b16 v[58:59], v26 offset:13312
    s_waitcnt lgkmcnt(3)
    v_mfma_f32_32x32x16_bf16 v[64:79], v[40:43], v[32:35], v[64:79]
    s_add_u32 m0, s45, 16384
    s_add_u32 s46, s37, 2752512
    buffer_load_dwordx4 v4, s[8:11], s46 offen lds
    s_waitcnt lgkmcnt(0)
    v_mfma_f32_32x32x16_bf16 v[64:79], v[56:59], v[48:51], v[64:79]
    s_waitcnt vmcnt(12) lgkmcnt(0)
    s_barrier
    v_add_u32 v22, 49152, v10
    v_add_u32 v23, 49152, v11
    v_add_u32 v24, 49152, v12
    v_add_u32 v25, 49152, v13
    v_add_u32 v26, 49152, v20
    ds_read_b128 v[32:35], v22 offset:0
    ds_read_b64_tr_b16 v[40:41], v26 offset:0
    ds_read_b64_tr_b16 v[42:43], v26 offset:1024
    ds_read_b128 v[48:51], v23 offset:0
    ds_read_b64_tr_b16 v[56:57], v26 offset:4096
    ds_read_b64_tr_b16 v[58:59], v26 offset:5120
    s_waitcnt lgkmcnt(3)
    v_mfma_f32_32x32x16_bf16 v[64:79], v[40:43], v[32:35], v[64:79]
    s_add_u32 m0, s45, 24576
    s_add_u32 s46, s32, 3200
    buffer_load_dwordx4 v3, s[4:7], s46 offen lds
    ds_read_b128 v[32:35], v24 offset:0
    ds_read_b64_tr_b16 v[40:41], v26 offset:8192
    ds_read_b64_tr_b16 v[42:43], v26 offset:9216
    s_waitcnt lgkmcnt(3)
    v_mfma_f32_32x32x16_bf16 v[64:79], v[56:59], v[48:51], v[64:79]
    s_add_u32 m0, s45, 32768
    s_add_u32 s46, s36, 2867200
    buffer_load_dwordx4 v4, s[8:11], s46 offen lds
    ds_read_b128 v[48:51], v25 offset:0
    ds_read_b64_tr_b16 v[56:57], v26 offset:12288
    ds_read_b64_tr_b16 v[58:59], v26 offset:13312
    s_waitcnt lgkmcnt(3)
    v_mfma_f32_32x32x16_bf16 v[64:79], v[40:43], v[32:35], v[64:79]
    s_add_u32 m0, s45, 40960
    s_add_u32 s46, s37, 2867200
    buffer_load_dwordx4 v4, s[8:11], s46 offen lds
    s_waitcnt lgkmcnt(0)
    v_mfma_f32_32x32x16_bf16 v[64:79], v[56:59], v[48:51], v[64:79]
    s_waitcnt vmcnt(12) lgkmcnt(0)
    s_barrier
    v_add_u32 v22, 73728, v10
    v_add_u32 v23, 73728, v11
    v_add_u32 v24, 73728, v12
    v_add_u32 v25, 73728, v13
    v_add_u32 v26, 73728, v20
    ds_read_b128 v[32:35], v22 offset:0
    ds_read_b64_tr_b16 v[40:41], v26 offset:0
    ds_read_b64_tr_b16 v[42:43], v26 offset:1024
    ds_read_b128 v[48:51], v23 offset:0
    ds_read_b64_tr_b16 v[56:57], v26 offset:4096
    ds_read_b64_tr_b16 v[58:59], v26 offset:5120
    s_waitcnt lgkmcnt(3)
    v_mfma_f32_32x32x16_bf16 v[64:79], v[40:43], v[32:35], v[64:79]
    s_add_u32 m0, s45, 49152
    s_add_u32 s46, s32, 3328
    buffer_load_dwordx4 v3, s[4:7], s46 offen lds
    ds_read_b128 v[32:35], v24 offset:0
    ds_read_b64_tr_b16 v[40:41], v26 offset:8192
    ds_read_b64_tr_b16 v[42:43], v26 offset:9216
    s_waitcnt lgkmcnt(3)
    v_mfma_f32_32x32x16_bf16 v[64:79], v[56:59], v[48:51], v[64:79]
    s_add_u32 m0, s45, 57344
    s_add_u32 s46, s36, 2981888
    buffer_load_dwordx4 v4, s[8:11], s46 offen lds
    ds_read_b128 v[48:51], v25 offset:0
    ds_read_b64_tr_b16 v[56:57], v26 offset:12288
    ds_read_b64_tr_b16 v[58:59], v26 offset:13312
    s_waitcnt lgkmcnt(3)
    v_mfma_f32_32x32x16_bf16 v[64:79], v[40:43], v[32:35], v[64:79]
    s_add_u32 m0, s45, 65536
    s_add_u32 s46, s37, 2981888
    buffer_load_dwordx4 v4, s[8:11], s46 offen lds
    s_waitcnt lgkmcnt(0)
    v_mfma_f32_32x32x16_bf16 v[64:79], v[56:59], v[48:51], v[64:79]
    s_waitcnt vmcnt(12) lgkmcnt(0)
    s_barrier
    v_add_u32 v22, 98304, v10
    v_add_u32 v23, 98304, v11
    v_add_u32 v24, 98304, v12
    v_add_u32 v25, 98304, v13
    v_add_u32 v26, 98304, v20
    ds_read_b128 v[32:35], v22 offset:0
    ds_read_b64_tr_b16 v[40:41], v26 offset:0
    ds_read_b64_tr_b16 v[42:43], v26 offset:1024
    ds_read_b128 v[48:51], v23 offset:0
    ds_read_b64_tr_b16 v[56:57], v26 offset:4096
    ds_read_b64_tr_b16 v[58:59], v26 offset:5120
    s_waitcnt lgkmcnt(3)
    v_mfma_f32_32x32x16_bf16 v[64:79], v[40:43], v[32:35], v[64:79]
    s_add_u32 m0, s45, 73728
    s_add_u32 s46, s32, 3456
    buffer_load_dwordx4 v3, s[4:7], s46 offen lds
    ds_read_b128 v[32:35], v24 offset:0
    ds_read_b64_tr_b16 v[40:41], v26 offset:8192
    ds_read_b64_tr_b16 v[42:43], v26 offset:9216
    s_waitcnt lgkmcnt(3)
    v_mfma_f32_32x32x16_bf16 v[64:79], v[56:59], v[48:51], v[64:79]
    s_add_u32 m0, s45, 81920
    s_add_u32 s46, s36, 3096576
    buffer_load_dwordx4 v4, s[8:11], s46 offen lds
    ds_read_b128 v[48:51], v25 offset:0
    ds_read_b64_tr_b16 v[56:57], v26 offset:12288
    ds_read_b64_tr_b16 v[58:59], v26 offset:13312
    s_waitcnt lgkmcnt(3)
    v_mfma_f32_32x32x16_bf16 v[64:79], v[40:43], v[32:35], v[64:79]
    s_add_u32 m0, s45, 90112
    s_add_u32 s46, s37, 3096576
    buffer_load_dwordx4 v4, s[8:11], s46 offen lds
    s_waitcnt lgkmcnt(0)
    v_mfma_f32_32x32x16_bf16 v[64:79], v[56:59], v[48:51], v[64:79]
    s_waitcnt vmcnt(12) lgkmcnt(0)
    s_barrier
    v_add_u32 v22, 122880, v10
    v_add_u32 v23, 122880, v11
    v_add_u32 v24, 122880, v12
    v_add_u32 v25, 122880, v13
    v_add_u32 v26, 122880, v20
    ds_read_b128 v[32:35], v22 offset:0
    ds_read_b64_tr_b16 v[40:41], v26 offset:0
    ds_read_b64_tr_b16 v[42:43], v26 offset:1024
    ds_read_b128 v[48:51], v23 offset:0
    ds_read_b64_tr_b16 v[56:57], v26 offset:4096
    ds_read_b64_tr_b16 v[58:59], v26 offset:5120
    s_waitcnt lgkmcnt(3)
    v_mfma_f32_32x32x16_bf16 v[64:79], v[40:43], v[32:35], v[64:79]
    s_add_u32 m0, s45, 98304
    s_add_u32 s46, s32, 3584
    buffer_load_dwordx4 v3, s[4:7], s46 offen lds
    ds_read_b128 v[32:35], v24 offset:0
    ds_read_b64_tr_b16 v[40:41], v26 offset:8192
    ds_read_b64_tr_b16 v[42:43], v26 offset:9216
    s_waitcnt lgkmcnt(3)
    v_mfma_f32_32x32x16_bf16 v[64:79], v[56:59], v[48:51], v[64:79]
    s_add_u32 m0, s45, 106496
    s_add_u32 s46, s36, 3211264
    buffer_load_dwordx4 v4, s[8:11], s46 offen lds
    ds_read_b128 v[48:51], v25 offset:0
    ds_read_b64_tr_b16 v[56:57], v26 offset:12288
    ds_read_b64_tr_b16 v[58:59], v26 offset:13312
    s_waitcnt lgkmcnt(3)
    v_mfma_f32_32x32x16_bf16 v[64:79], v[40:43], v[32:35], v[64:79]
    s_add_u32 m0, s45, 114688
    s_add_u32 s46, s37, 3211264
    buffer_load_dwordx4 v4, s[8:11], s46 offen lds
    s_waitcnt lgkmcnt(0)
    v_mfma_f32_32x32x16_bf16 v[64:79], v[56:59], v[48:51], v[64:79]
    s_waitcnt vmcnt(12) lgkmcnt(0)
    s_barrier
    v_add_u32 v22, 0, v10
    v_add_u32 v23, 0, v11
    v_add_u32 v24, 0, v12
    v_add_u32 v25, 0, v13
    v_add_u32 v26, 0, v20
    ds_read_b128 v[32:35], v22 offset:0
    ds_read_b64_tr_b16 v[40:41], v26 offset:0
    ds_read_b64_tr_b16 v[42:43], v26 offset:1024
    ds_read_b128 v[48:51], v23 offset:0
    ds_read_b64_tr_b16 v[56:57], v26 offset:4096
    ds_read_b64_tr_b16 v[58:59], v26 offset:5120
    s_waitcnt lgkmcnt(3)
    v_mfma_f32_32x32x16_bf16 v[64:79], v[40:43], v[32:35], v[64:79]
    s_add_u32 m0, s45, 122880
    s_add_u32 s46, s32, 3712
    buffer_load_dwordx4 v3, s[4:7], s46 offen lds
    ds_read_b128 v[32:35], v24 offset:0
    ds_read_b64_tr_b16 v[40:41], v26 offset:8192
    ds_read_b64_tr_b16 v[42:43], v26 offset:9216
    s_waitcnt lgkmcnt(3)
    v_mfma_f32_32x32x16_bf16 v[64:79], v[56:59], v[48:51], v[64:79]
    s_add_u32 m0, s45, 131072
    s_add_u32 s46, s36, 3325952
    buffer_load_dwordx4 v4, s[8:11], s46 offen lds
    ds_read_b128 v[48:51], v25 offset:0
    ds_read_b64_tr_b16 v[56:57], v26 offset:12288
    ds_read_b64_tr_b16 v[58:59], v26 offset:13312
    s_waitcnt lgkmcnt(3)
    v_mfma_f32_32x32x16_bf16 v[64:79], v[40:43], v[32:35], v[64:79]
    s_add_u32 m0, s45, 139264
    s_add_u32 s46, s37, 3325952
    buffer_load_dwordx4 v4, s[8:11], s46 offen lds
    s_waitcnt lgkmcnt(0)
    v_mfma_f32_32x32x16_bf16 v[64:79], v[56:59], v[48:51], v[64:79]
    s_waitcnt vmcnt(12) lgkmcnt(0)
    s_barrier
    v_add_u32 v22, 24576, v10
    v_add_u32 v23, 24576, v11
    v_add_u32 v24, 24576, v12
    v_add_u32 v25, 24576, v13
    v_add_u32 v26, 24576, v20
    ds_read_b128 v[32:35], v22 offset:0
    ds_read_b64_tr_b16 v[40:41], v26 offset:0
    ds_read_b64_tr_b16 v[42:43], v26 offset:1024
    ds_read_b128 v[48:51], v23 offset:0
    ds_read_b64_tr_b16 v[56:57], v26 offset:4096
    ds_read_b64_tr_b16 v[58:59], v26 offset:5120
    s_waitcnt lgkmcnt(3)
    v_mfma_f32_32x32x16_bf16 v[64:79], v[40:43], v[32:35], v[64:79]
    s_add_u32 m0, s45, 0
    s_add_u32 s46, s32, 3840
    buffer_load_dwordx4 v3, s[4:7], s46 offen lds
    ds_read_b128 v[32:35], v24 offset:0
    ds_read_b64_tr_b16 v[40:41], v26 offset:8192
    ds_read_b64_tr_b16 v[42:43], v26 offset:9216
    s_waitcnt lgkmcnt(3)
    v_mfma_f32_32x32x16_bf16 v[64:79], v[56:59], v[48:51], v[64:79]
    s_add_u32 m0, s45, 8192
    s_add_u32 s46, s36, 3440640
    buffer_load_dwordx4 v4, s[8:11], s46 offen lds
    ds_read_b128 v[48:51], v25 offset:0
    ds_read_b64_tr_b16 v[56:57], v26 offset:12288
    ds_read_b64_tr_b16 v[58:59], v26 offset:13312
    s_waitcnt lgkmcnt(3)
    v_mfma_f32_32x32x16_bf16 v[64:79], v[40:43], v[32:35], v[64:79]
    s_add_u32 m0, s45, 16384
    s_add_u32 s46, s37, 3440640
    buffer_load_dwordx4 v4, s[8:11], s46 offen lds
    s_waitcnt lgkmcnt(0)
    v_mfma_f32_32x32x16_bf16 v[64:79], v[56:59], v[48:51], v[64:79]
    s_waitcnt vmcnt(12) lgkmcnt(0)
    s_barrier
    v_add_u32 v22, 49152, v10
    v_add_u32 v23, 49152, v11
    v_add_u32 v24, 49152, v12
    v_add_u32 v25, 49152, v13
    v_add_u32 v26, 49152, v20
    ds_read_b128 v[32:35], v22 offset:0
    ds_read_b64_tr_b16 v[40:41], v26 offset:0
    ds_read_b64_tr_b16 v[42:43], v26 offset:1024
    ds_read_b128 v[48:51], v23 offset:0
    ds_read_b64_tr_b16 v[56:57], v26 offset:4096
    ds_read_b64_tr_b16 v[58:59], v26 offset:5120
    s_waitcnt lgkmcnt(3)
    v_mfma_f32_32x32x16_bf16 v[64:79], v[40:43], v[32:35], v[64:79]
    s_add_u32 m0, s45, 24576
    s_add_u32 s46, s32, 3968
    buffer_load_dwordx4 v3, s[4:7], s46 offen lds
    ds_read_b128 v[32:35], v24 offset:0
    ds_read_b64_tr_b16 v[40:41], v26 offset:8192
    ds_read_b64_tr_b16 v[42:43], v26 offset:9216
    s_waitcnt lgkmcnt(3)
    v_mfma_f32_32x32x16_bf16 v[64:79], v[56:59], v[48:51], v[64:79]
    s_add_u32 m0, s45, 32768
    s_add_u32 s46, s36, 3555328
    buffer_load_dwordx4 v4, s[8:11], s46 offen lds
    ds_read_b128 v[48:51], v25 offset:0
    ds_read_b64_tr_b16 v[56:57], v26 offset:12288
    ds_read_b64_tr_b16 v[58:59], v26 offset:13312
    s_waitcnt lgkmcnt(3)
    v_mfma_f32_32x32x16_bf16 v[64:79], v[40:43], v[32:35], v[64:79]
    s_add_u32 m0, s45, 40960
    s_add_u32 s46, s37, 3555328
    buffer_load_dwordx4 v4, s[8:11], s46 offen lds
    s_waitcnt lgkmcnt(0)
    v_mfma_f32_32x32x16_bf16 v[64:79], v[56:59], v[48:51], v[64:79]
    s_waitcnt vmcnt(12) lgkmcnt(0)
    s_barrier
    v_add_u32 v22, 73728, v10
    v_add_u32 v23, 73728, v11
    v_add_u32 v24, 73728, v12
    v_add_u32 v25, 73728, v13
    v_add_u32 v26, 73728, v20
    ds_read_b128 v[32:35], v22 offset:0
    ds_read_b64_tr_b16 v[40:41], v26 offset:0
    ds_read_b64_tr_b16 v[42:43], v26 offset:1024
    ds_read_b128 v[48:51], v23 offset:0
    ds_read_b64_tr_b16 v[56:57], v26 offset:4096
    ds_read_b64_tr_b16 v[58:59], v26 offset:5120
    s_waitcnt lgkmcnt(3)
    v_mfma_f32_32x32x16_bf16 v[64:79], v[40:43], v[32:35], v[64:79]
    ds_read_b128 v[32:35], v24 offset:0
    ds_read_b64_tr_b16 v[40:41], v26 offset:8192
    ds_read_b64_tr_b16 v[42:43], v26 offset:9216
    s_waitcnt lgkmcnt(3)
    v_mfma_f32_32x32x16_bf16 v[64:79], v[56:59], v[48:51], v[64:79]
    ds_read_b128 v[48:51], v25 offset:0
    ds_read_b64_tr_b16 v[56:57], v26 offset:12288
    ds_read_b64_tr_b16 v[58:59], v26 offset:13312
    s_waitcnt lgkmcnt(3)
    v_mfma_f32_32x32x16_bf16 v[64:79], v[40:43], v[32:35], v[64:79]
    s_waitcnt lgkmcnt(0)
    v_mfma_f32_32x32x16_bf16 v[64:79], v[56:59], v[48:51], v[64:79]
    s_waitcnt vmcnt(9) lgkmcnt(0)
    s_barrier
    v_add_u32 v22, 98304, v10
    v_add_u32 v23, 98304, v11
    v_add_u32 v24, 98304, v12
    v_add_u32 v25, 98304, v13
    v_add_u32 v26, 98304, v20
    ds_read_b128 v[32:35], v22 offset:0
    ds_read_b64_tr_b16 v[40:41], v26 offset:0
    ds_read_b64_tr_b16 v[42:43], v26 offset:1024
    ds_read_b128 v[48:51], v23 offset:0
    ds_read_b64_tr_b16 v[56:57], v26 offset:4096
    ds_read_b64_tr_b16 v[58:59], v26 offset:5120
    s_waitcnt lgkmcnt(3)
    v_mfma_f32_32x32x16_bf16 v[64:79], v[40:43], v[32:35], v[64:79]
    ds_read_b128 v[32:35], v24 offset:0
    ds_read_b64_tr_b16 v[40:41], v26 offset:8192
    ds_read_b64_tr_b16 v[42:43], v26 offset:9216
    s_waitcnt lgkmcnt(3)
    v_mfma_f32_32x32x16_bf16 v[64:79], v[56:59], v[48:51], v[64:79]
    ds_read_b128 v[48:51], v25 offset:0
    ds_read_b64_tr_b16 v[56:57], v26 offset:12288
    ds_read_b64_tr_b16 v[58:59], v26 offset:13312
    s_waitcnt lgkmcnt(3)
    v_mfma_f32_32x32x16_bf16 v[64:79], v[40:43], v[32:35], v[64:79]
    s_waitcnt lgkmcnt(0)
    v_mfma_f32_32x32x16_bf16 v[64:79], v[56:59], v[48:51], v[64:79]
    s_waitcnt vmcnt(6) lgkmcnt(0)
    s_barrier
    v_add_u32 v22, 122880, v10
    v_add_u32 v23, 122880, v11
    v_add_u32 v24, 122880, v12
    v_add_u32 v25, 122880, v13
    v_add_u32 v26, 122880, v20
    ds_read_b128 v[32:35], v22 offset:0
    ds_read_b64_tr_b16 v[40:41], v26 offset:0
    ds_read_b64_tr_b16 v[42:43], v26 offset:1024
    ds_read_b128 v[48:51], v23 offset:0
    ds_read_b64_tr_b16 v[56:57], v26 offset:4096
    ds_read_b64_tr_b16 v[58:59], v26 offset:5120
    s_waitcnt lgkmcnt(3)
    v_mfma_f32_32x32x16_bf16 v[64:79], v[40:43], v[32:35], v[64:79]
    ds_read_b128 v[32:35], v24 offset:0
    ds_read_b64_tr_b16 v[40:41], v26 offset:8192
    ds_read_b64_tr_b16 v[42:43], v26 offset:9216
    s_waitcnt lgkmcnt(3)
    v_mfma_f32_32x32x16_bf16 v[64:79], v[56:59], v[48:51], v[64:79]
    ds_read_b128 v[48:51], v25 offset:0
    ds_read_b64_tr_b16 v[56:57], v26 offset:12288
    ds_read_b64_tr_b16 v[58:59], v26 offset:13312
    s_waitcnt lgkmcnt(3)
    v_mfma_f32_32x32x16_bf16 v[64:79], v[40:43], v[32:35], v[64:79]
    s_waitcnt lgkmcnt(0)
    v_mfma_f32_32x32x16_bf16 v[64:79], v[56:59], v[48:51], v[64:79]
    s_waitcnt vmcnt(3) lgkmcnt(0)
    s_barrier
    v_add_u32 v22, 0, v10
    v_add_u32 v23, 0, v11
    v_add_u32 v24, 0, v12
    v_add_u32 v25, 0, v13
    v_add_u32 v26, 0, v20
    ds_read_b128 v[32:35], v22 offset:0
    ds_read_b64_tr_b16 v[40:41], v26 offset:0
    ds_read_b64_tr_b16 v[42:43], v26 offset:1024
    ds_read_b128 v[48:51], v23 offset:0
    ds_read_b64_tr_b16 v[56:57], v26 offset:4096
    ds_read_b64_tr_b16 v[58:59], v26 offset:5120
    s_waitcnt lgkmcnt(3)
    v_mfma_f32_32x32x16_bf16 v[64:79], v[40:43], v[32:35], v[64:79]
    ds_read_b128 v[32:35], v24 offset:0
    ds_read_b64_tr_b16 v[40:41], v26 offset:8192
    ds_read_b64_tr_b16 v[42:43], v26 offset:9216
    s_waitcnt lgkmcnt(3)
    v_mfma_f32_32x32x16_bf16 v[64:79], v[56:59], v[48:51], v[64:79]
    ds_read_b128 v[48:51], v25 offset:0
    ds_read_b64_tr_b16 v[56:57], v26 offset:12288
    ds_read_b64_tr_b16 v[58:59], v26 offset:13312
    s_waitcnt lgkmcnt(3)
    v_mfma_f32_32x32x16_bf16 v[64:79], v[40:43], v[32:35], v[64:79]
    s_waitcnt lgkmcnt(0)
    v_mfma_f32_32x32x16_bf16 v[64:79], v[56:59], v[48:51], v[64:79]
    s_waitcnt vmcnt(0) lgkmcnt(0)
    s_barrier
    v_mul_u32_u24 v18, 3584, v9
    v_lshl_add_u32 v18, v14, 3, v18
    s_mul_i32 s31, s30, 64
    v_add_u32 v18, s31, v18
    s_mul_i32 s43, s26, 3584
    s_lshl_b32 s42, s27, 1
    s_add_u32 s43, s43, s42
    v_add_u32 v19, s26, v9
    v_lshlrev_b32 v19, 1, v19
    buffer_load_ushort v116, v19, s[48:51], 0 offen offset:0
    s_add_u32 s44, s43, 0
    buffer_load_dwordx2 v[96:97], v18, s[16:19], s44 offen offset:0
    buffer_load_dwordx2 v[98:99], v18, s[16:19], s44 offen offset:16
    buffer_load_dwordx2 v[100:101], v18, s[16:19], s44 offen offset:32
    buffer_load_dwordx2 v[102:103], v18, s[16:19], s44 offen offset:48
    v_add_u32 v22, 24576, v10
    v_add_u32 v23, 24576, v11
    v_add_u32 v24, 24576, v12
    v_add_u32 v25, 24576, v13
    v_add_u32 v26, 24576, v20
    ds_read_b128 v[32:35], v22 offset:0
    ds_read_b64_tr_b16 v[40:41], v26 offset:0
    ds_read_b64_tr_b16 v[42:43], v26 offset:1024
    ds_read_b128 v[48:51], v23 offset:0
    ds_read_b64_tr_b16 v[56:57], v26 offset:4096
    ds_read_b64_tr_b16 v[58:59], v26 offset:5120
    s_waitcnt lgkmcnt(3)
    v_mfma_f32_32x32x16_bf16 v[64:79], v[40:43], v[32:35], v[64:79]
    ds_read_b128 v[32:35], v24 offset:0
    ds_read_b64_tr_b16 v[40:41], v26 offset:8192
    ds_read_b64_tr_b16 v[42:43], v26 offset:9216
    s_waitcnt lgkmcnt(3)
    v_mfma_f32_32x32x16_bf16 v[64:79], v[56:59], v[48:51], v[64:79]
    ds_read_b128 v[48:51], v25 offset:0
    ds_read_b64_tr_b16 v[56:57], v26 offset:12288
    ds_read_b64_tr_b16 v[58:59], v26 offset:13312
    s_waitcnt lgkmcnt(3)
    v_mfma_f32_32x32x16_bf16 v[64:79], v[40:43], v[32:35], v[64:79]
    s_waitcnt lgkmcnt(0)
    v_mfma_f32_32x32x16_bf16 v[64:79], v[56:59], v[48:51], v[64:79]
    s_nop 15
    v_mul_u32_u24 v17, 1792, v9
    v_lshl_add_u32 v17, v14, 3, v17
    s_mul_i32 s31, s30, 64
    v_add_u32 v17, s31, v17
    s_mul_i32 s41, s26, 1792
    s_lshl_b32 s42, s27, 1
    s_add_u32 s41, s41, s42
    s_waitcnt vmcnt(0)
    s_add_u32 s42, s41, 0
    v_lshlrev_b32 v116, 16, v116
    v_cvt_pk_bf16_f32 v28, v64, v65
    v_cvt_pk_bf16_f32 v29, v66, v67
    v_lshlrev_b32 v48, 16, v28
    v_and_b32 v49, 0xffff0000, v28
    v_lshlrev_b32 v50, 16, v29
    v_and_b32 v51, 0xffff0000, v29
    v_add_f32 v48, v48, v116
    v_add_f32 v49, v49, v116
    v_add_f32 v50, v50, v116
    v_add_f32 v51, v51, v116
    v_cvt_pk_bf16_f32 v28, v48, v49
    v_cvt_pk_bf16_f32 v29, v50, v51
    v_lshlrev_b32 v48, 16, v28
    v_and_b32 v49, 0xffff0000, v28
    v_lshlrev_b32 v50, 16, v29
    v_and_b32 v51, 0xffff0000, v29
    v_lshlrev_b32 v52, 16, v96
    v_and_b32 v53, 0xffff0000, v96
    v_lshlrev_b32 v54, 16, v97
    v_and_b32 v55, 0xffff0000, v97
    v_mul_f32 v48, v48, v52
    v_mul_f32 v49, v49, v53
    v_mul_f32 v50, v50, v54
    v_mul_f32 v51, v51, v55
    v_cvt_pk_bf16_f32 v28, v48, v49
    v_cvt_pk_bf16_f32 v29, v50, v51
    buffer_store_dwordx2 v[28:29], v17, s[12:15], s42 offen offset:0
    s_nop 1
    v_cvt_pk_bf16_f32 v28, v68, v69
    v_cvt_pk_bf16_f32 v29, v70, v71
    v_lshlrev_b32 v48, 16, v28
    v_and_b32 v49, 0xffff0000, v28
    v_lshlrev_b32 v50, 16, v29
    v_and_b32 v51, 0xffff0000, v29
    v_add_f32 v48, v48, v116
    v_add_f32 v49, v49, v116
    v_add_f32 v50, v50, v116
    v_add_f32 v51, v51, v116
    v_cvt_pk_bf16_f32 v28, v48, v49
    v_cvt_pk_bf16_f32 v29, v50, v51
    v_lshlrev_b32 v48, 16, v28
    v_and_b32 v49, 0xffff0000, v28
    v_lshlrev_b32 v50, 16, v29
    v_and_b32 v51, 0xffff0000, v29
    v_lshlrev_b32 v52, 16, v98
    v_and_b32 v53, 0xffff0000, v98
    v_lshlrev_b32 v54, 16, v99
    v_and_b32 v55, 0xffff0000, v99
    v_mul_f32 v48, v48, v52
    v_mul_f32 v49, v49, v53
    v_mul_f32 v50, v50, v54
    v_mul_f32 v51, v51, v55
    v_cvt_pk_bf16_f32 v28, v48, v49
    v_cvt_pk_bf16_f32 v29, v50, v51
    buffer_store_dwordx2 v[28:29], v17, s[12:15], s42 offen offset:16
    s_nop 1
    v_cvt_pk_bf16_f32 v28, v72, v73
    v_cvt_pk_bf16_f32 v29, v74, v75
    v_lshlrev_b32 v48, 16, v28
    v_and_b32 v49, 0xffff0000, v28
    v_lshlrev_b32 v50, 16, v29
    v_and_b32 v51, 0xffff0000, v29
    v_add_f32 v48, v48, v116
    v_add_f32 v49, v49, v116
    v_add_f32 v50, v50, v116
    v_add_f32 v51, v51, v116
    v_cvt_pk_bf16_f32 v28, v48, v49
    v_cvt_pk_bf16_f32 v29, v50, v51
    v_lshlrev_b32 v48, 16, v28
    v_and_b32 v49, 0xffff0000, v28
    v_lshlrev_b32 v50, 16, v29
    v_and_b32 v51, 0xffff0000, v29
    v_lshlrev_b32 v52, 16, v100
    v_and_b32 v53, 0xffff0000, v100
    v_lshlrev_b32 v54, 16, v101
    v_and_b32 v55, 0xffff0000, v101
    v_mul_f32 v48, v48, v52
    v_mul_f32 v49, v49, v53
    v_mul_f32 v50, v50, v54
    v_mul_f32 v51, v51, v55
    v_cvt_pk_bf16_f32 v28, v48, v49
    v_cvt_pk_bf16_f32 v29, v50, v51
    buffer_store_dwordx2 v[28:29], v17, s[12:15], s42 offen offset:32
    s_nop 1
    v_cvt_pk_bf16_f32 v28, v76, v77
    v_cvt_pk_bf16_f32 v29, v78, v79
    v_lshlrev_b32 v48, 16, v28
    v_and_b32 v49, 0xffff0000, v28
    v_lshlrev_b32 v50, 16, v29
    v_and_b32 v51, 0xffff0000, v29
    v_add_f32 v48, v48, v116
    v_add_f32 v49, v49, v116
    v_add_f32 v50, v50, v116
    v_add_f32 v51, v51, v116
    v_cvt_pk_bf16_f32 v28, v48, v49
    v_cvt_pk_bf16_f32 v29, v50, v51
    v_lshlrev_b32 v48, 16, v28
    v_and_b32 v49, 0xffff0000, v28
    v_lshlrev_b32 v50, 16, v29
    v_and_b32 v51, 0xffff0000, v29
    v_lshlrev_b32 v52, 16, v102
    v_and_b32 v53, 0xffff0000, v102
    v_lshlrev_b32 v54, 16, v103
    v_and_b32 v55, 0xffff0000, v103
    v_mul_f32 v48, v48, v52
    v_mul_f32 v49, v49, v53
    v_mul_f32 v50, v50, v54
    v_mul_f32 v51, v51, v55
    v_cvt_pk_bf16_f32 v28, v48, v49
    v_cvt_pk_bf16_f32 v29, v50, v51
    buffer_store_dwordx2 v[28:29], v17, s[12:15], s42 offen offset:48
    s_nop 1
L_end_29:
    s_endpgm
.globl k6_out_kernel
.p2align 8
.type k6_out_kernel,@function
k6_out_kernel:
    s_cmp_ge_u32 s2, 256
    s_cbranch_scc1 L_end_30
    s_load_dwordx2 s[4:5], s[0:1], 80
    s_load_dwordx2 s[8:9], s[0:1], 56
    s_load_dwordx2 s[12:13], s[0:1], 64
    s_load_dwordx2 s[16:17], s[0:1], 80
    s_and_b32 s24, s2, 31
    s_lshr_b32 s25, s2, 5
    s_mul_i32 s26, s24, 64
    s_mul_i32 s27, s25, 64
    v_and_b32 v1, 63, v0
    v_lshrrev_b32 v2, 6, v0
    s_nop 0
    v_readfirstlane_b32 s28, v2
    s_waitcnt lgkmcnt(0)
    s_add_u32 s4, s4, 0x1200000
    s_addc_u32 s5, s5, 0
    s_mov_b32 s6, 0x380000
    s_mov_b32 s7, 0x00020000
    s_mov_b32 s10, 0xe0000
    s_mov_b32 s11, 0x00020000
    s_mov_b32 s14, 0x200000
    s_mov_b32 s15, 0x00020000
    s_add_u32 s16, s16, 0x800000
    s_addc_u32 s17, s17, 0
    s_mov_b32 s18, 0x200000
    s_mov_b32 s19, 0x00020000
    s_and_b32 s29, s28, 1
    s_lshr_b32 s30, s28, 1
    v_lshrrev_b32 v5, 3, v1
    v_lshrrev_b32 v6, 4, v1
    s_lshl_b32 s31, s29, 2
    v_add_u32 v7, s31, v6
    v_and_b32 v7, 7, v7
    v_and_b32 v8, 7, v1
    v_xor_b32 v7, v7, v8
    v_mul_u32_u24 v3, 1792, v5
    v_lshl_add_u32 v3, v7, 4, v3
    v_bfe_u32 v7, v1, 4, 1
    v_lshlrev_b32 v7, 2, v7
    v_xor_b32 v7, v7, v8
    v_mul_u32_u24 v4, 1024, v5
    v_lshl_add_u32 v4, v7, 4, v4
    s_lshl_b32 s31, s28, 3
    s_add_u32 s31, s31, s26
    s_mul_i32 s32, s31, 1792
    s_add_u32 s33, s32, 57344
    s_mul_i32 s36, s28, 8192
    s_lshl_b32 s31, s27, 1
    s_add_u32 s36, s36, s31
    s_add_u32 s37, s36, 32768
    s_lshl_b32 s45, s28, 10
    v_and_b32 v9, 31, v1
    s_mul_i32 s31, s29, 32
    v_add_u32 v9, s31, v9
    v_lshrrev_b32 v14, 5, v1
    v_bfe_u32 v15, v1, 1, 3
    v_xor_b32 v15, v15, v14
    v_lshlrev_b32 v16, 7, v9
    v_xor_b32 v17, 0, v15
    v_lshl_add_u32 v10, v17, 4, v16
    v_xor_b32 v17, 2, v15
    v_lshl_add_u32 v11, v17, 4, v16
    v_xor_b32 v17, 4, v15
    v_lshl_add_u32 v12, v17, 4, v16
    v_xor_b32 v17, 6, v15
    v_lshl_add_u32 v13, v17, 4, v16
    v_bfe_u32 v15, v1, 2, 2
    v_lshl_add_u32 v16, v14, 3, v15
    v_mul_u32_u24 v16, 128, v16
    v_bfe_u32 v17, v1, 4, 1
    v_lshlrev_b32 v17, 1, v17
    v_bfe_u32 v18, v1, 1, 1
    v_add_u32 v17, v17, v18
    s_mul_i32 s31, s30, 4
    v_add_u32 v17, s31, v17
    v_bfe_u32 v15, v1, 3, 1
    v_lshlrev_b32 v15, 2, v15
    v_and_b32 v18, 1, v1
    v_lshl_add_u32 v16, v18, 3, v16
    v_add_u32 v16, 8192, v16
    v_add_u32 v18, 0, v17
    v_xor_b32 v18, v18, v15
    v_lshl_add_u32 v20, v18, 4, v16
    v_mov_b32 v64, 0
    v_mov_b32 v65, 0
    v_mov_b32 v66, 0
    v_mov_b32 v67, 0
    v_mov_b32 v68, 0
    v_mov_b32 v69, 0
    v_mov_b32 v70, 0
    v_mov_b32 v71, 0
    v_mov_b32 v72, 0
    v_mov_b32 v73, 0
    v_mov_b32 v74, 0
    v_mov_b32 v75, 0
    v_mov_b32 v76, 0
    v_mov_b32 v77, 0
    v_mov_b32 v78, 0
    v_mov_b32 v79, 0
    s_add_u32 m0, s45, 0
    s_add_u32 s46, s32, 0
    buffer_load_dwordx4 v3, s[4:7], s46 offen lds
    s_add_u32 m0, s45, 4096
    s_add_u32 s46, s33, 0
    buffer_load_dwordx4 v3, s[4:7], s46 offen lds
    s_add_u32 m0, s45, 8192
    s_add_u32 s46, s36, 0
    buffer_load_dwordx4 v4, s[8:11], s46 offen lds
    s_add_u32 m0, s45, 12288
    s_add_u32 s46, s37, 0
    buffer_load_dwordx4 v4, s[8:11], s46 offen lds
    s_add_u32 m0, s45, 16384
    s_add_u32 s46, s32, 128
    buffer_load_dwordx4 v3, s[4:7], s46 offen lds
    s_add_u32 m0, s45, 20480
    s_add_u32 s46, s33, 128
    buffer_load_dwordx4 v3, s[4:7], s46 offen lds
    s_add_u32 m0, s45, 24576
    s_add_u32 s46, s36, 65536
    buffer_load_dwordx4 v4, s[8:11], s46 offen lds
    s_add_u32 m0, s45, 28672
    s_add_u32 s46, s37, 65536
    buffer_load_dwordx4 v4, s[8:11], s46 offen lds
    s_add_u32 m0, s45, 32768
    s_add_u32 s46, s32, 256
    buffer_load_dwordx4 v3, s[4:7], s46 offen lds
    s_add_u32 m0, s45, 36864
    s_add_u32 s46, s33, 256
    buffer_load_dwordx4 v3, s[4:7], s46 offen lds
    s_add_u32 m0, s45, 40960
    s_add_u32 s46, s36, 131072
    buffer_load_dwordx4 v4, s[8:11], s46 offen lds
    s_add_u32 m0, s45, 45056
    s_add_u32 s46, s37, 131072
    buffer_load_dwordx4 v4, s[8:11], s46 offen lds
    s_add_u32 m0, s45, 49152
    s_add_u32 s46, s32, 384
    buffer_load_dwordx4 v3, s[4:7], s46 offen lds
    s_add_u32 m0, s45, 53248
    s_add_u32 s46, s33, 384
    buffer_load_dwordx4 v3, s[4:7], s46 offen lds
    s_add_u32 m0, s45, 57344
    s_add_u32 s46, s36, 196608
    buffer_load_dwordx4 v4, s[8:11], s46 offen lds
    s_add_u32 m0, s45, 61440
    s_add_u32 s46, s37, 196608
    buffer_load_dwordx4 v4, s[8:11], s46 offen lds
    s_add_u32 m0, s45, 65536
    s_add_u32 s46, s32, 512
    buffer_load_dwordx4 v3, s[4:7], s46 offen lds
    s_add_u32 m0, s45, 69632
    s_add_u32 s46, s33, 512
    buffer_load_dwordx4 v3, s[4:7], s46 offen lds
    s_add_u32 m0, s45, 73728
    s_add_u32 s46, s36, 262144
    buffer_load_dwordx4 v4, s[8:11], s46 offen lds
    s_add_u32 m0, s45, 77824
    s_add_u32 s46, s37, 262144
    buffer_load_dwordx4 v4, s[8:11], s46 offen lds
    s_add_u32 m0, s45, 81920
    s_add_u32 s46, s32, 640
    buffer_load_dwordx4 v3, s[4:7], s46 offen lds
    s_add_u32 m0, s45, 86016
    s_add_u32 s46, s33, 640
    buffer_load_dwordx4 v3, s[4:7], s46 offen lds
    s_add_u32 m0, s45, 90112
    s_add_u32 s46, s36, 327680
    buffer_load_dwordx4 v4, s[8:11], s46 offen lds
    s_add_u32 m0, s45, 94208
    s_add_u32 s46, s37, 327680
    buffer_load_dwordx4 v4, s[8:11], s46 offen lds
    s_add_u32 m0, s45, 98304
    s_add_u32 s46, s32, 768
    buffer_load_dwordx4 v3, s[4:7], s46 offen lds
    s_add_u32 m0, s45, 102400
    s_add_u32 s46, s33, 768
    buffer_load_dwordx4 v3, s[4:7], s46 offen lds
    s_add_u32 m0, s45, 106496
    s_add_u32 s46, s36, 393216
    buffer_load_dwordx4 v4, s[8:11], s46 offen lds
    s_add_u32 m0, s45, 110592
    s_add_u32 s46, s37, 393216
    buffer_load_dwordx4 v4, s[8:11], s46 offen lds
    s_waitcnt vmcnt(24) lgkmcnt(0)
    s_barrier
    v_add_u32 v22, 0, v10
    v_add_u32 v23, 0, v11
    v_add_u32 v24, 0, v12
    v_add_u32 v25, 0, v13
    v_add_u32 v26, 0, v20
    ds_read_b128 v[32:35], v22 offset:0
    ds_read_b64_tr_b16 v[40:41], v26 offset:0
    ds_read_b64_tr_b16 v[42:43], v26 offset:512
    ds_read_b128 v[48:51], v23 offset:0
    ds_read_b64_tr_b16 v[56:57], v26 offset:2048
    ds_read_b64_tr_b16 v[58:59], v26 offset:2560
    s_waitcnt lgkmcnt(3)
    v_mfma_f32_32x32x16_bf16 v[64:79], v[40:43], v[32:35], v[64:79]
    s_add_u32 m0, s45, 114688
    s_add_u32 s46, s32, 896
    buffer_load_dwordx4 v3, s[4:7], s46 offen lds
    ds_read_b128 v[32:35], v24 offset:0
    ds_read_b64_tr_b16 v[40:41], v26 offset:4096
    ds_read_b64_tr_b16 v[42:43], v26 offset:4608
    s_waitcnt lgkmcnt(3)
    v_mfma_f32_32x32x16_bf16 v[64:79], v[56:59], v[48:51], v[64:79]
    s_add_u32 m0, s45, 118784
    s_add_u32 s46, s33, 896
    buffer_load_dwordx4 v3, s[4:7], s46 offen lds
    ds_read_b128 v[48:51], v25 offset:0
    ds_read_b64_tr_b16 v[56:57], v26 offset:6144
    ds_read_b64_tr_b16 v[58:59], v26 offset:6656
    s_waitcnt lgkmcnt(3)
    v_mfma_f32_32x32x16_bf16 v[64:79], v[40:43], v[32:35], v[64:79]
    s_add_u32 m0, s45, 122880
    s_add_u32 s46, s36, 458752
    buffer_load_dwordx4 v4, s[8:11], s46 offen lds
    s_waitcnt lgkmcnt(0)
    v_mfma_f32_32x32x16_bf16 v[64:79], v[56:59], v[48:51], v[64:79]
    s_add_u32 m0, s45, 126976
    s_add_u32 s46, s37, 458752
    buffer_load_dwordx4 v4, s[8:11], s46 offen lds
    s_waitcnt vmcnt(24) lgkmcnt(0)
    s_barrier
    v_add_u32 v22, 16384, v10
    v_add_u32 v23, 16384, v11
    v_add_u32 v24, 16384, v12
    v_add_u32 v25, 16384, v13
    v_add_u32 v26, 16384, v20
    ds_read_b128 v[32:35], v22 offset:0
    ds_read_b64_tr_b16 v[40:41], v26 offset:0
    ds_read_b64_tr_b16 v[42:43], v26 offset:512
    ds_read_b128 v[48:51], v23 offset:0
    ds_read_b64_tr_b16 v[56:57], v26 offset:2048
    ds_read_b64_tr_b16 v[58:59], v26 offset:2560
    s_waitcnt lgkmcnt(3)
    v_mfma_f32_32x32x16_bf16 v[64:79], v[40:43], v[32:35], v[64:79]
    s_add_u32 m0, s45, 0
    s_add_u32 s46, s32, 1024
    buffer_load_dwordx4 v3, s[4:7], s46 offen lds
    ds_read_b128 v[32:35], v24 offset:0
    ds_read_b64_tr_b16 v[40:41], v26 offset:4096
    ds_read_b64_tr_b16 v[42:43], v26 offset:4608
    s_waitcnt lgkmcnt(3)
    v_mfma_f32_32x32x16_bf16 v[64:79], v[56:59], v[48:51], v[64:79]
    s_add_u32 m0, s45, 4096
    s_add_u32 s46, s33, 1024
    buffer_load_dwordx4 v3, s[4:7], s46 offen lds
    ds_read_b128 v[48:51], v25 offset:0
    ds_read_b64_tr_b16 v[56:57], v26 offset:6144
    ds_read_b64_tr_b16 v[58:59], v26 offset:6656
    s_waitcnt lgkmcnt(3)
    v_mfma_f32_32x32x16_bf16 v[64:79], v[40:43], v[32:35], v[64:79]
    s_add_u32 m0, s45, 8192
    s_add_u32 s46, s36, 524288
    buffer_load_dwordx4 v4, s[8:11], s46 offen lds
    s_waitcnt lgkmcnt(0)
    v_mfma_f32_32x32x16_bf16 v[64:79], v[56:59], v[48:51], v[64:79]
    s_add_u32 m0, s45, 12288
    s_add_u32 s46, s37, 524288
    buffer_load_dwordx4 v4, s[8:11], s46 offen lds
    s_waitcnt vmcnt(24) lgkmcnt(0)
    s_barrier
    v_add_u32 v22, 32768, v10
    v_add_u32 v23, 32768, v11
    v_add_u32 v24, 32768, v12
    v_add_u32 v25, 32768, v13
    v_add_u32 v26, 32768, v20
    ds_read_b128 v[32:35], v22 offset:0
    ds_read_b64_tr_b16 v[40:41], v26 offset:0
    ds_read_b64_tr_b16 v[42:43], v26 offset:512
    ds_read_b128 v[48:51], v23 offset:0
    ds_read_b64_tr_b16 v[56:57], v26 offset:2048
    ds_read_b64_tr_b16 v[58:59], v26 offset:2560
    s_waitcnt lgkmcnt(3)
    v_mfma_f32_32x32x16_bf16 v[64:79], v[40:43], v[32:35], v[64:79]
    s_add_u32 m0, s45, 16384
    s_add_u32 s46, s32, 1152
    buffer_load_dwordx4 v3, s[4:7], s46 offen lds
    ds_read_b128 v[32:35], v24 offset:0
    ds_read_b64_tr_b16 v[40:41], v26 offset:4096
    ds_read_b64_tr_b16 v[42:43], v26 offset:4608
    s_waitcnt lgkmcnt(3)
    v_mfma_f32_32x32x16_bf16 v[64:79], v[56:59], v[48:51], v[64:79]
    s_add_u32 m0, s45, 20480
    s_add_u32 s46, s33, 1152
    buffer_load_dwordx4 v3, s[4:7], s46 offen lds
    ds_read_b128 v[48:51], v25 offset:0
    ds_read_b64_tr_b16 v[56:57], v26 offset:6144
    ds_read_b64_tr_b16 v[58:59], v26 offset:6656
    s_waitcnt lgkmcnt(3)
    v_mfma_f32_32x32x16_bf16 v[64:79], v[40:43], v[32:35], v[64:79]
    s_add_u32 m0, s45, 24576
    s_add_u32 s46, s36, 589824
    buffer_load_dwordx4 v4, s[8:11], s46 offen lds
    s_waitcnt lgkmcnt(0)
    v_mfma_f32_32x32x16_bf16 v[64:79], v[56:59], v[48:51], v[64:79]
    s_add_u32 m0, s45, 28672
    s_add_u32 s46, s37, 589824
    buffer_load_dwordx4 v4, s[8:11], s46 offen lds
    s_waitcnt vmcnt(24) lgkmcnt(0)
    s_barrier
    v_add_u32 v22, 49152, v10
    v_add_u32 v23, 49152, v11
    v_add_u32 v24, 49152, v12
    v_add_u32 v25, 49152, v13
    v_add_u32 v26, 49152, v20
    ds_read_b128 v[32:35], v22 offset:0
    ds_read_b64_tr_b16 v[40:41], v26 offset:0
    ds_read_b64_tr_b16 v[42:43], v26 offset:512
    ds_read_b128 v[48:51], v23 offset:0
    ds_read_b64_tr_b16 v[56:57], v26 offset:2048
    ds_read_b64_tr_b16 v[58:59], v26 offset:2560
    s_waitcnt lgkmcnt(3)
    v_mfma_f32_32x32x16_bf16 v[64:79], v[40:43], v[32:35], v[64:79]
    s_add_u32 m0, s45, 32768
    s_add_u32 s46, s32, 1280
    buffer_load_dwordx4 v3, s[4:7], s46 offen lds
    ds_read_b128 v[32:35], v24 offset:0
    ds_read_b64_tr_b16 v[40:41], v26 offset:4096
    ds_read_b64_tr_b16 v[42:43], v26 offset:4608
    s_waitcnt lgkmcnt(3)
    v_mfma_f32_32x32x16_bf16 v[64:79], v[56:59], v[48:51], v[64:79]
    s_add_u32 m0, s45, 36864
    s_add_u32 s46, s33, 1280
    buffer_load_dwordx4 v3, s[4:7], s46 offen lds
    ds_read_b128 v[48:51], v25 offset:0
    ds_read_b64_tr_b16 v[56:57], v26 offset:6144
    ds_read_b64_tr_b16 v[58:59], v26 offset:6656
    s_waitcnt lgkmcnt(3)
    v_mfma_f32_32x32x16_bf16 v[64:79], v[40:43], v[32:35], v[64:79]
    s_add_u32 m0, s45, 40960
    s_add_u32 s46, s36, 655360
    buffer_load_dwordx4 v4, s[8:11], s46 offen lds
    s_waitcnt lgkmcnt(0)
    v_mfma_f32_32x32x16_bf16 v[64:79], v[56:59], v[48:51], v[64:79]
    s_add_u32 m0, s45, 45056
    s_add_u32 s46, s37, 655360
    buffer_load_dwordx4 v4, s[8:11], s46 offen lds
    s_waitcnt vmcnt(24) lgkmcnt(0)
    s_barrier
    v_add_u32 v22, 65536, v10
    v_add_u32 v23, 65536, v11
    v_add_u32 v24, 65536, v12
    v_add_u32 v25, 65536, v13
    v_add_u32 v26, 65536, v20
    ds_read_b128 v[32:35], v22 offset:0
    ds_read_b64_tr_b16 v[40:41], v26 offset:0
    ds_read_b64_tr_b16 v[42:43], v26 offset:512
    ds_read_b128 v[48:51], v23 offset:0
    ds_read_b64_tr_b16 v[56:57], v26 offset:2048
    ds_read_b64_tr_b16 v[58:59], v26 offset:2560
    s_waitcnt lgkmcnt(3)
    v_mfma_f32_32x32x16_bf16 v[64:79], v[40:43], v[32:35], v[64:79]
    s_add_u32 m0, s45, 49152
    s_add_u32 s46, s32, 1408
    buffer_load_dwordx4 v3, s[4:7], s46 offen lds
    ds_read_b128 v[32:35], v24 offset:0
    ds_read_b64_tr_b16 v[40:41], v26 offset:4096
    ds_read_b64_tr_b16 v[42:43], v26 offset:4608
    s_waitcnt lgkmcnt(3)
    v_mfma_f32_32x32x16_bf16 v[64:79], v[56:59], v[48:51], v[64:79]
    s_add_u32 m0, s45, 53248
    s_add_u32 s46, s33, 1408
    buffer_load_dwordx4 v3, s[4:7], s46 offen lds
    ds_read_b128 v[48:51], v25 offset:0
    ds_read_b64_tr_b16 v[56:57], v26 offset:6144
    ds_read_b64_tr_b16 v[58:59], v26 offset:6656
    s_waitcnt lgkmcnt(3)
    v_mfma_f32_32x32x16_bf16 v[64:79], v[40:43], v[32:35], v[64:79]
    s_add_u32 m0, s45, 57344
    s_add_u32 s46, s36, 720896
    buffer_load_dwordx4 v4, s[8:11], s46 offen lds
    s_waitcnt lgkmcnt(0)
    v_mfma_f32_32x32x16_bf16 v[64:79], v[56:59], v[48:51], v[64:79]
    s_add_u32 m0, s45, 61440
    s_add_u32 s46, s37, 720896
    buffer_load_dwordx4 v4, s[8:11], s46 offen lds
    s_waitcnt vmcnt(24) lgkmcnt(0)
    s_barrier
    v_add_u32 v22, 81920, v10
    v_add_u32 v23, 81920, v11
    v_add_u32 v24, 81920, v12
    v_add_u32 v25, 81920, v13
    v_add_u32 v26, 81920, v20
    ds_read_b128 v[32:35], v22 offset:0
    ds_read_b64_tr_b16 v[40:41], v26 offset:0
    ds_read_b64_tr_b16 v[42:43], v26 offset:512
    ds_read_b128 v[48:51], v23 offset:0
    ds_read_b64_tr_b16 v[56:57], v26 offset:2048
    ds_read_b64_tr_b16 v[58:59], v26 offset:2560
    s_waitcnt lgkmcnt(3)
    v_mfma_f32_32x32x16_bf16 v[64:79], v[40:43], v[32:35], v[64:79]
    s_add_u32 m0, s45, 65536
    s_add_u32 s46, s32, 1536
    buffer_load_dwordx4 v3, s[4:7], s46 offen lds
    ds_read_b128 v[32:35], v24 offset:0
    ds_read_b64_tr_b16 v[40:41], v26 offset:4096
    ds_read_b64_tr_b16 v[42:43], v26 offset:4608
    s_waitcnt lgkmcnt(3)
    v_mfma_f32_32x32x16_bf16 v[64:79], v[56:59], v[48:51], v[64:79]
    s_add_u32 m0, s45, 69632
    s_add_u32 s46, s33, 1536
    buffer_load_dwordx4 v3, s[4:7], s46 offen lds
    ds_read_b128 v[48:51], v25 offset:0
    ds_read_b64_tr_b16 v[56:57], v26 offset:6144
    ds_read_b64_tr_b16 v[58:59], v26 offset:6656
    s_waitcnt lgkmcnt(3)
    v_mfma_f32_32x32x16_bf16 v[64:79], v[40:43], v[32:35], v[64:79]
    s_add_u32 m0, s45, 73728
    s_add_u32 s46, s36, 786432
    buffer_load_dwordx4 v4, s[8:11], s46 offen lds
    s_waitcnt lgkmcnt(0)
    v_mfma_f32_32x32x16_bf16 v[64:79], v[56:59], v[48:51], v[64:79]
    s_add_u32 m0, s45, 77824
    s_add_u32 s46, s37, 786432
    buffer_load_dwordx4 v4, s[8:11], s46 offen lds
    s_waitcnt vmcnt(24) lgkmcnt(0)
    s_barrier
    v_add_u32 v22, 98304, v10
    v_add_u32 v23, 98304, v11
    v_add_u32 v24, 98304, v12
    v_add_u32 v25, 98304, v13
    v_add_u32 v26, 98304, v20
    ds_read_b128 v[32:35], v22 offset:0
    ds_read_b64_tr_b16 v[40:41], v26 offset:0
    ds_read_b64_tr_b16 v[42:43], v26 offset:512
    ds_read_b128 v[48:51], v23 offset:0
    ds_read_b64_tr_b16 v[56:57], v26 offset:2048
    ds_read_b64_tr_b16 v[58:59], v26 offset:2560
    s_waitcnt lgkmcnt(3)
    v_mfma_f32_32x32x16_bf16 v[64:79], v[40:43], v[32:35], v[64:79]
    s_add_u32 m0, s45, 81920
    s_add_u32 s46, s32, 1664
    buffer_load_dwordx4 v3, s[4:7], s46 offen lds
    ds_read_b128 v[32:35], v24 offset:0
    ds_read_b64_tr_b16 v[40:41], v26 offset:4096
    ds_read_b64_tr_b16 v[42:43], v26 offset:4608
    s_waitcnt lgkmcnt(3)
    v_mfma_f32_32x32x16_bf16 v[64:79], v[56:59], v[48:51], v[64:79]
    s_add_u32 m0, s45, 86016
    s_add_u32 s46, s33, 1664
    buffer_load_dwordx4 v3, s[4:7], s46 offen lds
    ds_read_b128 v[48:51], v25 offset:0
    ds_read_b64_tr_b16 v[56:57], v26 offset:6144
    ds_read_b64_tr_b16 v[58:59], v26 offset:6656
    s_waitcnt lgkmcnt(3)
    v_mfma_f32_32x32x16_bf16 v[64:79], v[40:43], v[32:35], v[64:79]
    s_add_u32 m0, s45, 90112
    s_add_u32 s46, s36, 851968
    buffer_load_dwordx4 v4, s[8:11], s46 offen lds
    s_waitcnt lgkmcnt(0)
    v_mfma_f32_32x32x16_bf16 v[64:79], v[56:59], v[48:51], v[64:79]
    s_add_u32 m0, s45, 94208
    s_add_u32 s46, s37, 851968
    buffer_load_dwordx4 v4, s[8:11], s46 offen lds
    s_waitcnt vmcnt(24) lgkmcnt(0)
    s_barrier
    v_add_u32 v22, 114688, v10
    v_add_u32 v23, 114688, v11
    v_add_u32 v24, 114688, v12
    v_add_u32 v25, 114688, v13
    v_add_u32 v26, 114688, v20
    ds_read_b128 v[32:35], v22 offset:0
    ds_read_b64_tr_b16 v[40:41], v26 offset:0
    ds_read_b64_tr_b16 v[42:43], v26 offset:512
    ds_read_b128 v[48:51], v23 offset:0
    ds_read_b64_tr_b16 v[56:57], v26 offset:2048
    ds_read_b64_tr_b16 v[58:59], v26 offset:2560
    s_waitcnt lgkmcnt(3)
    v_mfma_f32_32x32x16_bf16 v[64:79], v[40:43], v[32:35], v[64:79]
    ds_read_b128 v[32:35], v24 offset:0
    ds_read_b64_tr_b16 v[40:41], v26 offset:4096
    ds_read_b64_tr_b16 v[42:43], v26 offset:4608
    s_waitcnt lgkmcnt(3)
    v_mfma_f32_32x32x16_bf16 v[64:79], v[56:59], v[48:51], v[64:79]
    ds_read_b128 v[48:51], v25 offset:0
    ds_read_b64_tr_b16 v[56:57], v26 offset:6144
    ds_read_b64_tr_b16 v[58:59], v26 offset:6656
    s_waitcnt lgkmcnt(3)
    v_mfma_f32_32x32x16_bf16 v[64:79], v[40:43], v[32:35], v[64:79]
    s_waitcnt lgkmcnt(0)
    v_mfma_f32_32x32x16_bf16 v[64:79], v[56:59], v[48:51], v[64:79]
    s_waitcnt vmcnt(20) lgkmcnt(0)
    s_barrier
    v_add_u32 v22, 0, v10
    v_add_u32 v23, 0, v11
    v_add_u32 v24, 0, v12
    v_add_u32 v25, 0, v13
    v_add_u32 v26, 0, v20
    ds_read_b128 v[32:35], v22 offset:0
    ds_read_b64_tr_b16 v[40:41], v26 offset:0
    ds_read_b64_tr_b16 v[42:43], v26 offset:512
    ds_read_b128 v[48:51], v23 offset:0
    ds_read_b64_tr_b16 v[56:57], v26 offset:2048
    ds_read_b64_tr_b16 v[58:59], v26 offset:2560
    s_waitcnt lgkmcnt(3)
    v_mfma_f32_32x32x16_bf16 v[64:79], v[40:43], v[32:35], v[64:79]
    ds_read_b128 v[32:35], v24 offset:0
    ds_read_b64_tr_b16 v[40:41], v26 offset:4096
    ds_read_b64_tr_b16 v[42:43], v26 offset:4608
    s_waitcnt lgkmcnt(3)
    v_mfma_f32_32x32x16_bf16 v[64:79], v[56:59], v[48:51], v[64:79]
    ds_read_b128 v[48:51], v25 offset:0
    ds_read_b64_tr_b16 v[56:57], v26 offset:6144
    ds_read_b64_tr_b16 v[58:59], v26 offset:6656
    s_waitcnt lgkmcnt(3)
    v_mfma_f32_32x32x16_bf16 v[64:79], v[40:43], v[32:35], v[64:79]
    s_waitcnt lgkmcnt(0)
    v_mfma_f32_32x32x16_bf16 v[64:79], v[56:59], v[48:51], v[64:79]
    s_waitcnt vmcnt(16) lgkmcnt(0)
    s_barrier
    v_add_u32 v22, 16384, v10
    v_add_u32 v23, 16384, v11
    v_add_u32 v24, 16384, v12
    v_add_u32 v25, 16384, v13
    v_add_u32 v26, 16384, v20
    ds_read_b128 v[32:35], v22 offset:0
    ds_read_b64_tr_b16 v[40:41], v26 offset:0
    ds_read_b64_tr_b16 v[42:43], v26 offset:512
    ds_read_b128 v[48:51], v23 offset:0
    ds_read_b64_tr_b16 v[56:57], v26 offset:2048
    ds_read_b64_tr_b16 v[58:59], v26 offset:2560
    s_waitcnt lgkmcnt(3)
    v_mfma_f32_32x32x16_bf16 v[64:79], v[40:43], v[32:35], v[64:79]
    ds_read_b128 v[32:35], v24 offset:0
    ds_read_b64_tr_b16 v[40:41], v26 offset:4096
    ds_read_b64_tr_b16 v[42:43], v26 offset:4608
    s_waitcnt lgkmcnt(3)
    v_mfma_f32_32x32x16_bf16 v[64:79], v[56:59], v[48:51], v[64:79]
    ds_read_b128 v[48:51], v25 offset:0
    ds_read_b64_tr_b16 v[56:57], v26 offset:6144
    ds_read_b64_tr_b16 v[58:59], v26 offset:6656
    s_waitcnt lgkmcnt(3)
    v_mfma_f32_32x32x16_bf16 v[64:79], v[40:43], v[32:35], v[64:79]
    s_waitcnt lgkmcnt(0)
    v_mfma_f32_32x32x16_bf16 v[64:79], v[56:59], v[48:51], v[64:79]
    s_waitcnt vmcnt(12) lgkmcnt(0)
    s_barrier
    v_add_u32 v22, 32768, v10
    v_add_u32 v23, 32768, v11
    v_add_u32 v24, 32768, v12
    v_add_u32 v25, 32768, v13
    v_add_u32 v26, 32768, v20
    ds_read_b128 v[32:35], v22 offset:0
    ds_read_b64_tr_b16 v[40:41], v26 offset:0
    ds_read_b64_tr_b16 v[42:43], v26 offset:512
    ds_read_b128 v[48:51], v23 offset:0
    ds_read_b64_tr_b16 v[56:57], v26 offset:2048
    ds_read_b64_tr_b16 v[58:59], v26 offset:2560
    s_waitcnt lgkmcnt(3)
    v_mfma_f32_32x32x16_bf16 v[64:79], v[40:43], v[32:35], v[64:79]
    ds_read_b128 v[32:35], v24 offset:0
    ds_read_b64_tr_b16 v[40:41], v26 offset:4096
    ds_read_b64_tr_b16 v[42:43], v26 offset:4608
    s_waitcnt lgkmcnt(3)
    v_mfma_f32_32x32x16_bf16 v[64:79], v[56:59], v[48:51], v[64:79]
    ds_read_b128 v[48:51], v25 offset:0
    ds_read_b64_tr_b16 v[56:57], v26 offset:6144
    ds_read_b64_tr_b16 v[58:59], v26 offset:6656
    s_waitcnt lgkmcnt(3)
    v_mfma_f32_32x32x16_bf16 v[64:79], v[40:43], v[32:35], v[64:79]
    s_waitcnt lgkmcnt(0)
    v_mfma_f32_32x32x16_bf16 v[64:79], v[56:59], v[48:51], v[64:79]
    s_waitcnt vmcnt(8) lgkmcnt(0)
    s_barrier
    v_add_u32 v22, 49152, v10
    v_add_u32 v23, 49152, v11
    v_add_u32 v24, 49152, v12
    v_add_u32 v25, 49152, v13
    v_add_u32 v26, 49152, v20
    ds_read_b128 v[32:35], v22 offset:0
    ds_read_b64_tr_b16 v[40:41], v26 offset:0
    ds_read_b64_tr_b16 v[42:43], v26 offset:512
    ds_read_b128 v[48:51], v23 offset:0
    ds_read_b64_tr_b16 v[56:57], v26 offset:2048
    ds_read_b64_tr_b16 v[58:59], v26 offset:2560
    s_waitcnt lgkmcnt(3)
    v_mfma_f32_32x32x16_bf16 v[64:79], v[40:43], v[32:35], v[64:79]
    ds_read_b128 v[32:35], v24 offset:0
    ds_read_b64_tr_b16 v[40:41], v26 offset:4096
    ds_read_b64_tr_b16 v[42:43], v26 offset:4608
    s_waitcnt lgkmcnt(3)
    v_mfma_f32_32x32x16_bf16 v[64:79], v[56:59], v[48:51], v[64:79]
    ds_read_b128 v[48:51], v25 offset:0
    ds_read_b64_tr_b16 v[56:57], v26 offset:6144
    ds_read_b64_tr_b16 v[58:59], v26 offset:6656
    s_waitcnt lgkmcnt(3)
    v_mfma_f32_32x32x16_bf16 v[64:79], v[40:43], v[32:35], v[64:79]
    s_waitcnt lgkmcnt(0)
    v_mfma_f32_32x32x16_bf16 v[64:79], v[56:59], v[48:51], v[64:79]
    s_waitcnt vmcnt(4) lgkmcnt(0)
    s_barrier
    v_add_u32 v22, 65536, v10
    v_add_u32 v23, 65536, v11
    v_add_u32 v24, 65536, v12
    v_add_u32 v25, 65536, v13
    v_add_u32 v26, 65536, v20
    ds_read_b128 v[32:35], v22 offset:0
    ds_read_b64_tr_b16 v[40:41], v26 offset:0
    ds_read_b64_tr_b16 v[42:43], v26 offset:512
    ds_read_b128 v[48:51], v23 offset:0
    ds_read_b64_tr_b16 v[56:57], v26 offset:2048
    ds_read_b64_tr_b16 v[58:59], v26 offset:2560
    s_waitcnt lgkmcnt(3)
    v_mfma_f32_32x32x16_bf16 v[64:79], v[40:43], v[32:35], v[64:79]
    ds_read_b128 v[32:35], v24 offset:0
    ds_read_b64_tr_b16 v[40:41], v26 offset:4096
    ds_read_b64_tr_b16 v[42:43], v26 offset:4608
    s_waitcnt lgkmcnt(3)
    v_mfma_f32_32x32x16_bf16 v[64:79], v[56:59], v[48:51], v[64:79]
    ds_read_b128 v[48:51], v25 offset:0
    ds_read_b64_tr_b16 v[56:57], v26 offset:6144
    ds_read_b64_tr_b16 v[58:59], v26 offset:6656
    s_waitcnt lgkmcnt(3)
    v_mfma_f32_32x32x16_bf16 v[64:79], v[40:43], v[32:35], v[64:79]
    s_waitcnt lgkmcnt(0)
    v_mfma_f32_32x32x16_bf16 v[64:79], v[56:59], v[48:51], v[64:79]
    s_waitcnt vmcnt(0) lgkmcnt(0)
    s_barrier
    v_mul_u32_u24 v18, 1024, v9
    v_lshl_add_u32 v18, v14, 3, v18
    s_mul_i32 s31, s30, 64
    v_add_u32 v18, s31, v18
    s_mul_i32 s43, s26, 1024
    s_lshl_b32 s42, s27, 1
    s_add_u32 s43, s43, s42
    s_add_u32 s44, s43, 0
    buffer_load_dwordx2 v[96:97], v18, s[16:19], s44 offen offset:0
    buffer_load_dwordx2 v[98:99], v18, s[16:19], s44 offen offset:16
    buffer_load_dwordx2 v[100:101], v18, s[16:19], s44 offen offset:32
    buffer_load_dwordx2 v[102:103], v18, s[16:19], s44 offen offset:48
    v_add_u32 v22, 81920, v10
    v_add_u32 v23, 81920, v11
    v_add_u32 v24, 81920, v12
    v_add_u32 v25, 81920, v13
    v_add_u32 v26, 81920, v20
    ds_read_b128 v[32:35], v22 offset:0
    ds_read_b64_tr_b16 v[40:41], v26 offset:0
    ds_read_b64_tr_b16 v[42:43], v26 offset:512
    ds_read_b128 v[48:51], v23 offset:0
    ds_read_b64_tr_b16 v[56:57], v26 offset:2048
    ds_read_b64_tr_b16 v[58:59], v26 offset:2560
    s_waitcnt lgkmcnt(3)
    v_mfma_f32_32x32x16_bf16 v[64:79], v[40:43], v[32:35], v[64:79]
    ds_read_b128 v[32:35], v24 offset:0
    ds_read_b64_tr_b16 v[40:41], v26 offset:4096
    ds_read_b64_tr_b16 v[42:43], v26 offset:4608
    s_waitcnt lgkmcnt(3)
    v_mfma_f32_32x32x16_bf16 v[64:79], v[56:59], v[48:51], v[64:79]
    ds_read_b128 v[48:51], v25 offset:0
    ds_read_b64_tr_b16 v[56:57], v26 offset:6144
    ds_read_b64_tr_b16 v[58:59], v26 offset:6656
    s_waitcnt lgkmcnt(3)
    v_mfma_f32_32x32x16_bf16 v[64:79], v[40:43], v[32:35], v[64:79]
    s_waitcnt lgkmcnt(0)
    v_mfma_f32_32x32x16_bf16 v[64:79], v[56:59], v[48:51], v[64:79]
    s_nop 15
    v_mul_u32_u24 v17, 1024, v9
    v_lshl_add_u32 v17, v14, 3, v17
    s_mul_i32 s31, s30, 64
    v_add_u32 v17, s31, v17
    s_mul_i32 s41, s26, 1024
    s_lshl_b32 s42, s27, 1
    s_add_u32 s41, s41, s42
    s_waitcnt vmcnt(0)
    s_add_u32 s42, s41, 0
    v_cvt_pk_bf16_f32 v28, v64, v65
    v_cvt_pk_bf16_f32 v29, v66, v67
    v_lshlrev_b32 v48, 16, v28
    v_and_b32 v49, 0xffff0000, v28
    v_lshlrev_b32 v50, 16, v29
    v_and_b32 v51, 0xffff0000, v29
    v_lshlrev_b32 v52, 16, v96
    v_and_b32 v53, 0xffff0000, v96
    v_lshlrev_b32 v54, 16, v97
    v_and_b32 v55, 0xffff0000, v97
    v_add_f32 v48, v48, v52
    v_add_f32 v49, v49, v53
    v_add_f32 v50, v50, v54
    v_add_f32 v51, v51, v55
    v_cvt_pk_bf16_f32 v28, v48, v49
    v_cvt_pk_bf16_f32 v29, v50, v51
    buffer_store_dwordx2 v[28:29], v17, s[12:15], s42 offen offset:0
    s_nop 1
    v_cvt_pk_bf16_f32 v28, v68, v69
    v_cvt_pk_bf16_f32 v29, v70, v71
    v_lshlrev_b32 v48, 16, v28
    v_and_b32 v49, 0xffff0000, v28
    v_lshlrev_b32 v50, 16, v29
    v_and_b32 v51, 0xffff0000, v29
    v_lshlrev_b32 v52, 16, v98
    v_and_b32 v53, 0xffff0000, v98
    v_lshlrev_b32 v54, 16, v99
    v_and_b32 v55, 0xffff0000, v99
    v_add_f32 v48, v48, v52
    v_add_f32 v49, v49, v53
    v_add_f32 v50, v50, v54
    v_add_f32 v51, v51, v55
    v_cvt_pk_bf16_f32 v28, v48, v49
    v_cvt_pk_bf16_f32 v29, v50, v51
    buffer_store_dwordx2 v[28:29], v17, s[12:15], s42 offen offset:16
    s_nop 1
    v_cvt_pk_bf16_f32 v28, v72, v73
    v_cvt_pk_bf16_f32 v29, v74, v75
    v_lshlrev_b32 v48, 16, v28
    v_and_b32 v49, 0xffff0000, v28
    v_lshlrev_b32 v50, 16, v29
    v_and_b32 v51, 0xffff0000, v29
    v_lshlrev_b32 v52, 16, v100
    v_and_b32 v53, 0xffff0000, v100
    v_lshlrev_b32 v54, 16, v101
    v_and_b32 v55, 0xffff0000, v101
    v_add_f32 v48, v48, v52
    v_add_f32 v49, v49, v53
    v_add_f32 v50, v50, v54
    v_add_f32 v51, v51, v55
    v_cvt_pk_bf16_f32 v28, v48, v49
    v_cvt_pk_bf16_f32 v29, v50, v51
    buffer_store_dwordx2 v[28:29], v17, s[12:15], s42 offen offset:32
    s_nop 1
    v_cvt_pk_bf16_f32 v28, v76, v77
    v_cvt_pk_bf16_f32 v29, v78, v79
    v_lshlrev_b32 v48, 16, v28
    v_and_b32 v49, 0xffff0000, v28
    v_lshlrev_b32 v50, 16, v29
    v_and_b32 v51, 0xffff0000, v29
    v_lshlrev_b32 v52, 16, v102
    v_and_b32 v53, 0xffff0000, v102
    v_lshlrev_b32 v54, 16, v103
    v_and_b32 v55, 0xffff0000, v103
    v_add_f32 v48, v48, v52
    v_add_f32 v49, v49, v53
    v_add_f32 v50, v50, v54
    v_add_f32 v51, v51, v55
    v_cvt_pk_bf16_f32 v28, v48, v49
    v_cvt_pk_bf16_f32 v29, v50, v51
    buffer_store_dwordx2 v[28:29], v17, s[12:15], s42 offen offset:48
    s_nop 1
L_end_30:
    s_endpgm
.section .rodata,"a"
.p2align 6
.amdhsa_kernel k1_qkv_kernel
  .amdhsa_next_free_vgpr 192
  .amdhsa_next_free_sgpr 96
  .amdhsa_accum_offset 192
  .amdhsa_group_segment_fixed_size 0
  .amdhsa_kernarg_size 88
  .amdhsa_user_sgpr_count 2
  .amdhsa_user_sgpr_kernarg_segment_ptr 1
  .amdhsa_system_sgpr_workgroup_id_x 1
.end_amdhsa_kernel
.text
.section .rodata,"a"
.p2align 6
.amdhsa_kernel k2_attn_kernel
  .amdhsa_next_free_vgpr 128
  .amdhsa_next_free_sgpr 96
  .amdhsa_accum_offset 128
  .amdhsa_group_segment_fixed_size 0
  .amdhsa_kernarg_size 88
  .amdhsa_user_sgpr_count 2
  .amdhsa_user_sgpr_kernarg_segment_ptr 1
  .amdhsa_system_sgpr_workgroup_id_x 1
.end_amdhsa_kernel
.text
.section .rodata,"a"
.p2align 6
.amdhsa_kernel k3_wo_kernel
  .amdhsa_next_free_vgpr 128
  .amdhsa_next_free_sgpr 96
  .amdhsa_accum_offset 128
  .amdhsa_group_segment_fixed_size 0
  .amdhsa_kernarg_size 88
  .amdhsa_user_sgpr_count 2
  .amdhsa_user_sgpr_kernarg_segment_ptr 1
  .amdhsa_system_sgpr_workgroup_id_x 1
.end_amdhsa_kernel
.text
.section .rodata,"a"
.p2align 6
.amdhsa_kernel k4_win_kernel
  .amdhsa_next_free_vgpr 192
  .amdhsa_next_free_sgpr 96
  .amdhsa_accum_offset 192
  .amdhsa_group_segment_fixed_size 0
  .amdhsa_kernarg_size 88
  .amdhsa_user_sgpr_count 2
  .amdhsa_user_sgpr_kernarg_segment_ptr 1
  .amdhsa_system_sgpr_workgroup_id_x 1
.end_amdhsa_kernel
.text
.section .rodata,"a"
.p2align 6
.amdhsa_kernel k4b_lnz_kernel
  .amdhsa_next_free_vgpr 40
  .amdhsa_next_free_sgpr 96
  .amdhsa_accum_offset 40
  .amdhsa_group_segment_fixed_size 0
  .amdhsa_kernarg_size 88
  .amdhsa_user_sgpr_count 2
  .amdhsa_user_sgpr_kernarg_segment_ptr 1
  .amdhsa_system_sgpr_workgroup_id_x 1
.end_amdhsa_kernel
.text
.section .rodata,"a"
.p2align 6
.amdhsa_kernel k5_sp_kernel
  .amdhsa_next_free_vgpr 128
  .amdhsa_next_free_sgpr 96
  .amdhsa_accum_offset 128
  .amdhsa_group_segment_fixed_size 0
  .amdhsa_kernarg_size 88
  .amdhsa_user_sgpr_count 2
  .amdhsa_user_sgpr_kernarg_segment_ptr 1
  .amdhsa_system_sgpr_workgroup_id_x 1
.end_amdhsa_kernel
.text
.section .rodata,"a"
.p2align 6
.amdhsa_kernel k6_out_kernel
  .amdhsa_next_free_vgpr 128
  .amdhsa_next_free_sgpr 96
  .amdhsa_accum_offset 128
  .amdhsa_group_segment_fixed_size 0
  .amdhsa_kernarg_size 88
  .amdhsa_user_sgpr_count 2
  .amdhsa_user_sgpr_kernarg_segment_ptr 1
  .amdhsa_system_sgpr_workgroup_id_x 1
.end_amdhsa_kernel
.text
```
